```python
import torch

def _softmax(x, axis=-1):
    return torch.softmax(x, dim=axis)
def _gelu(x):
    return torch.nn.functional.gelu(x, approximate="tanh")
def _silu(x):
    return torch.nn.functional.silu(x)
def _sigmoid(x):
    return torch.sigmoid(x)
def _layernorm(x, axis=-1, eps=1e-5):
    m = x.mean(dim=axis, keepdim=True)
    v = x.var(dim=axis, keepdim=True, unbiased=False)
    return (x - m) / torch.sqrt(v + eps)
def _scatter_add(tgt, idx, src, axis=0):
    return tgt.clone().index_add_(axis, idx, src)
def _segment_sum(src, seg, n):
    out = torch.zeros((n,) + src.shape[1:], dtype=src.dtype)
    return out.index_add_(0, seg, src)
def _pad(x, pw):
    flat = tuple(v for pair in reversed(pw) for v in pair)
    return torch.nn.functional.pad(x, flat)

kernel_name = 'recurrent_scan__ssm_conv_s4d__glu_gated_glu__prompt'

def setup_inputs():

    _w = (lambda a: (lambda t: t.to(torch.bfloat16) if t.is_floating_point() else t)(torch.as_tensor(a)))
    def _A_setup():
        Bsz, L, D, N = 1, 2048, 640, 128
        return {
            "u": _w((lambda *s: torch.randn(*s, dtype=torch.bfloat16) * 0.05)(Bsz, L, D)),
            "log_A_real": _w((lambda *s: torch.randn(*s, dtype=torch.bfloat16) * 6.4)(D, N) * 0.5),
            "A_imag": _w((lambda *s: torch.randn(*s, dtype=torch.bfloat16) * 0.05)(D, N) * 3.14),
            "C_real": _w((lambda *s: torch.randn(*s, dtype=torch.bfloat16) * 0.05)(D, N) / N ** 0.5),
            "C_imag": _w((lambda *s: torch.randn(*s, dtype=torch.bfloat16) * 0.05)(D, N) / N ** 0.5),
            "log_dt": _w((lambda *s: torch.randn(*s, dtype=torch.bfloat16) * 0.05)(D) * 0.5 - 4.0),
            "D_skip": _w((lambda *s: torch.randn(*s, dtype=torch.bfloat16) * 0.05)(D)),
        }
    _A_in = _A_setup()

    def _B_setup():
        B, S, D, F = 1, 2048, 640, 1728
        return {
            "x": _w((lambda *s: torch.randn(*s, dtype=torch.bfloat16) * 0.05)(B, S, D)),
            "w_gate": _w((lambda *s: torch.randn(*s, dtype=torch.bfloat16) * 0.05)(D, F)),
            "w_up": _w((lambda *s: torch.randn(*s, dtype=torch.bfloat16) * 0.05)(D, F)),
            "w_down": _w((lambda *s: torch.randn(*s, dtype=torch.bfloat16) * 0.05)(F, D)),
        }
    _B_in = _B_setup()

    return {
        "A_u": _A_in["u"],
        "A_log_A_real": _A_in["log_A_real"],
        "A_A_imag": _A_in["A_imag"],
        "A_C_real": _A_in["C_real"],
        "A_C_imag": _A_in["C_imag"],
        "A_log_dt": _A_in["log_dt"],
        "A_D_skip": _A_in["D_skip"],
        "B_x": _B_in["x"],
        "B_w_gate": _B_in["w_gate"],
        "B_w_up": _B_in["w_up"],
        "B_w_down": _B_in["w_down"],
    }

def reference(A_u, A_log_A_real, A_A_imag, A_C_real, A_C_imag, A_log_dt, A_D_skip, B_x, B_w_gate, B_w_up, B_w_down):
    def _A_ref(u, log_A_real, A_imag, C_real, C_imag, log_dt, D_skip):
        L = u.shape[1]
        dt = torch.exp(log_dt)
        A = -torch.exp(log_A_real) + 1j * A_imag
        C = (C_real + 1j * C_imag) * dt[:, None]
        pos = (lambda x, dt: x.to(dt))(torch.arange(L), log_dt.dtype)
        P = torch.exp((A * dt[:, None])[:, :, None] * pos[None, None, :])
        K = 2.0 * torch.einsum("dn,dnl->dl", C, P).real
        L2 = 2 * L
        u_t = (lambda x, *d: x.permute(*d))(u, 0, 2, 1)
        Kf = (lambda x, *a, **k: torch.fft.rfft(x.float(), *a, **k))(K, L2)
        Uf = (lambda x, *a, **k: torch.fft.rfft(x.float(), *a, **k))(u_t, L2)
        y = (lambda x, *a, **k: torch.fft.irfft(x, *a, **k).to(torch.bfloat16))(Uf * Kf[None, :, :], L2)[:, :, :L]
        y = (lambda x, *d: x.permute(*d))(y, 0, 2, 1)
        return y + u * D_skip[None, None, :]

    def _B_ref(x, w_gate, w_up, w_down):
        g = torch.einsum("bsd,df->bsf", x, w_gate)
        u = torch.einsum("bsd,df->bsf", x, w_up)
        h = _sigmoid(g) * u
        return torch.einsum("bsf,fd->bsd", h, w_down)

    x = A_u
    xn = _layernorm(x, axis=-1)
    s = _A_ref(xn, A_log_A_real, A_A_imag, A_C_real, A_C_imag, A_log_dt, A_D_skip)
    g = _silu(_B_ref(xn, B_w_gate, B_w_up, B_w_down))
    return x + s * g
```

```asm
; @launch grid=(256,1,1) block=(256,1,1) lds=163840
.amdgcn_target "amdgcn-amd-amdhsa--gfx950"
.text
.globl recurrent_scan__ssm_conv_s4d__glu_gated_glu__prompt_kernel
.p2align 12
.p2align 8
.type recurrent_scan__ssm_conv_s4d__glu_gated_glu__prompt_kernel,@function
recurrent_scan__ssm_conv_s4d__glu_gated_glu__prompt_kernel:
    s_cmp_ge_u32 s2, 256
    s_cbranch_scc1 L_end
    s_load_dwordx16 s[16:31], s[0:1], 0
    s_load_dwordx8 s[32:39], s[0:1], 64
    s_load_dwordx4 s[40:43], s[0:1], 96
    s_getpc_b64 s[8:9]
    v_lshrrev_b32 v1, 6, v0
    s_and_b32 s4, s2, 7
    s_lshr_b32 s5, s2, 3
    v_readfirstlane_b32 s3, v1
    v_and_b32 v0, 63, v0
    s_lshl_b32 s10, s5, 2
    s_add_u32 s10, s10, s3
    s_mov_b64 exec, 15
    v_lshl_add_u32 v1, v0, 7, s10
    v_lshlrev_b32_e64 v1, 7, v1
    v_min_u32 v1, 0xc830, v1
    global_load_dword v255, v1, s[8:9]
    s_mov_b64 exec, -1
    v_lshrrev_b32 v4, 5, v0
    v_and_b32_e64 v5, 31, v0
    v_mul_u32_u24 v6, 1280, v4
    v_lshl_add_u32 v2, v5, 4, v6
    v_lshl_add_u32 v3, v5, 3, v6
    s_lshl_b32 s12, s4, 5
    s_add_u32 s12, s12, s5
    s_lshl_b32 s13, s12, 3
    s_lshl_b32 s8, s3, 1
    s_add_u32 s13, s13, s8
    s_mul_i32 s85, s13, 1280
    s_and_b32 s8, s4, 3
    s_mul_i32 s8, s8, 27
    s_add_u32 s8, s8, s5
    s_lshr_b32 s69, s8, 2
    s_and_b32 s68, s8, 3
    s_and_b32 s8, s4, 4
    s_add_u32 s68, s68, s8
    s_mul_i32 s74, s68, 327680
    s_mul_i32 s8, s3, 81920
    s_add_u32 s74, s74, s8
    s_lshl_b32 s75, s69, 7
    s_mul_i32 s8, s3, 55296
    s_add_u32 s75, s75, s8
    s_lshl_b32 s76, s3, 13
    s_lshl_b32 s77, s3, 12
    s_add_u32 s77, s77, 32768
    v_lshrrev_b32 v4, 3, v0
    v_and_b32 v5, 7, v0
    v_lshrrev_b32 v6, 4, v0
    v_xor_b32_e64 v6, v6, v5
    v_mul_u32_u24 v7, 1280, v4
    v_lshl_add_u32 v26, v6, 4, v7
    v_xor_b32_e64 v6, 4, v6
    v_lshl_add_u32 v27, v6, 4, v7
    v_add_u32 v27, 9216, v27
    v_add_u32 v28, 18432, v26
    v_add_u32 v29, 18432, v27
    v_and_b32 v6, 2, v4
    v_xor_b32 v6, v6, v5
    v_mul_u32_u24 v7, 3456, v4
    v_lshl_add_u32 v30, v6, 4, v7
    v_xor_b32_e64 v6, 4, v6
    v_lshl_add_u32 v31, v6, 4, v7
    v_add_u32 v31, 26624, v31
    s_mov_b32 s46, 2621440
    s_mov_b32 s47, 0x20000
    s_mov_b32 s50, 2211840
    s_mov_b32 s51, 0x20000
    s_mov_b32 s54, 2213888
    s_mov_b32 s55, 0x20000
    s_mov_b32 s70, s74
    s_mov_b32 s72, s75
    s_add_u32 m0, s77, 0
    s_waitcnt lgkmcnt(0)
    s_mov_b32 s44, s16
    s_and_b32 s45, s17, 0xffff
    buffer_load_dwordx4 v[48:51], v2, s[44:47], s85 offen
    buffer_load_dwordx4 v[52:55], v2, s[44:47], s85 offen offset:512
    buffer_load_dwordx2 v[56:57], v3, s[44:47], s85 offen offset:1024
    s_mov_b32 s48, s32
    s_and_b32 s49, s33, 0xffff
    s_sub_u32 s52, s34, 2048
    s_subb_u32 s53, s35, 0
    s_and_b32 s53, s53, 0xffff
    s_load_dword s7, s[42:43], 0
    s_cmp_ge_u32 s5, 27
    s_cbranch_scc1 L_S
    s_mov_b32 s6, 0xffff0000
    s_mov_b32 s100, 0x20000
    s_mul_i32 s15, s4, 40
    s_add_u32 s15, s15, s5
    s_sub_u32 s10, s5, 27
    s_cselect_b32 s10, 0, s10
    s_lshl_b32 s11, s10, 1
    s_cmp_eq_u32 s10, 4
    s_subb_u32 s11, s11, 0
    s_add_u32 s15, s15, s11
    s_lshl_b32 s32, s15, 2
    s_load_dword s78, s[26:27], s32
    s_load_dword s79, s[28:29], s32
    s_lshl_b32 s32, s15, 1
    s_lshr_b32 s33, s3, 1
    s_add_u32 s32, s32, s33
    s_lshl_b32 s32, s32, 8
    v_lshl_add_u32 v35, v0, 2, s32
    s_lshl_b32 s32, s15, 2
    s_nop 0
    global_load_dword v36, v35, s[18:19]
    global_load_dword v37, v35, s[20:21]
    global_load_dword v38, v35, s[22:23]
    global_load_dword v39, v35, s[24:25]
    buffer_load_dwordx4 v30, s[48:51], s72 offen lds
    buffer_load_dwordx4 v31, s[48:51], s72 offen offset:1024 lds
    buffer_load_dwordx4 v30, s[52:55], s72 offen offset:2048 lds
    buffer_load_dwordx4 v31, s[52:55], s72 offen offset:3072 lds
    s_add_u32 m0, s76, 0
    s_nop 0
    buffer_load_dwordx4 v26, s[44:47], s70 offen offset:0 lds
    s_add_u32 s72, s72, 221184
    buffer_load_dwordx4 v27, s[44:47], s70 offen offset:1024 lds
    s_mov_b64 exec, 0
    s_call_b64 s[84:85], L_hdG
    s_branch L_hopG
L_hdG:
    s_cmp_eq_u32 s3, 0
    s_cbranch_scc1 Lst_538
    s_cmp_eq_u32 s3, 1
    s_cbranch_scc1 Lst_1098
    s_cmp_eq_u32 s3, 2
    s_cbranch_scc1 Lst_1657
    s_branch Lst_2213
L_hopback:
    s_setpc_b64 s[84:85]
L_hopG:
    s_mov_b64 exec, -1
    s_add_u32 s71, s70, 40960
    s_mov_b32 s56, s42
    s_and_b32 s57, s43, 0xffff
    s_mov_b32 s58, 15040512
    s_mov_b32 s59, 0x20000
    s_mov_b32 s60, s38
    s_and_b32 s61, s39, 0xffff
    s_mov_b32 s62, 2621440
    s_mov_b32 s63, 0x20000
    s_mov_b32 s64, s36
    s_and_b32 s65, s37, 0xffff
    s_mov_b32 s66, 2211840
    s_mov_b32 s67, 0x20000
    s_lshr_b32 s8, s3, 1
    s_and_b32 s9, s3, 1
    buffer_load_dwordx4 v28, s[44:47], s70 offen offset:2048 lds
    v_and_b32 v4, 15, v0
    v_lshrrev_b32 v5, 4, v0
    v_lshrrev_b32 v6, 1, v4
    v_xor_b32 v6, v6, v5
    s_lshl_b32 s10, s8, 2
    v_xor_b32 v6, s10, v6
    v_lshlrev_b32 v6, 4, v6
    v_lshl_add_u32 v6, v4, 7, v6
    s_lshl_b32 s10, s8, 14
    v_add_u32 v20, s10, v6
    v_xor_b32_e64 v21, 64, v20
    v_bfe_u32 v4, v0, 2, 2
    v_bfe_u32 v6, v0, 4, 1
    v_bfe_u32 v7, v0, 1, 1
    v_and_b32_e64 v8, 2, v4
    buffer_load_dwordx4 v29, s[44:47], s70 offen offset:3072 lds
    v_xor_b32 v7, v7, v8
    v_lshlrev_b32 v8, 2, v6
    v_xor_b32 v7, v7, v8
    s_lshl_b32 s10, s9, 2
    v_xor_b32 v7, s10, v7
    v_lshlrev_b32 v7, 4, v7
    v_and_b32_e64 v8, 1, v0
    v_lshl_add_u32 v7, v8, 3, v7
    v_lshl_add_u32 v7, v4, 7, v7
    v_lshl_add_u32 v7, v6, 10, v7
    v_lshrrev_b32_e64 v8, 5, v0
    v_lshl_add_u32 v7, v8, 12, v7
    s_lshl_b32 s10, s8, 13
    s_add_u32 s10, s10, 32768
    v_add_u32 v22, s10, v7
    s_add_u32 m0, s76, 4096
    v_xor_b32_e64 v23, 32, v22
    v_xor_b32 v24, 0x2000, v22
    v_xor_b32 v25, 0x2000, v23
    v_lshrrev_b32 v4, 4, v0
    v_xor_b32 v4, v4, v0
    v_and_b32 v4, 2, v4
    v_cmp_eq_u32 vcc, 0, v4
    v_mov_b32 v4, 0x3f803f80
    v_and_b32 v5, 1, v0
    v_cndmask_b32 v44, 0, v4, vcc
    v_mul_u32_u24 v5, 0xaaaa, v5
    v_mov_b32 v45, v44
    v_mov_b32 v46, v44
    v_mov_b32_e64 v47, v44
    buffer_load_dwordx4 v26, s[44:47], s71 offen offset:0 lds
    v_add_u32 v119, 0x4444, v5
    v_mov_b32 v120, 0
    v_mov_b32 v121, 0
    v_mov_b32 v122, 0
    v_mov_b32 v123, 0
    v_mov_b32 v124, 0
    v_mov_b32 v125, 0
    v_mov_b32 v126, 0
    v_mov_b32 v127, 0
    s_mul_i32 s14, s4, 27
    s_add_u32 s14, s14, s5
    s_lshr_b32 s85, s14, 2
    s_and_b32 s33, s14, 3
    s_mul_i32 s85, s85, 40960
    s_mul_i32 s33, s33, 320
    s_add_u32 s70, s70, 128
    s_add_u32 s85, s85, s33
    s_lshl_b32 s33, s3, 6
    s_lshl_b32 s86, s3, 10
    s_cmp_lt_u32 s3, 2
    s_cselect_b32 s87, s85, 2211840
    v_add_u32_e64 v14, s33, v0
    v_mul_u32_u24 v5, 3277, v14
    v_lshrrev_b32_e64 v5, 16, v5
    v_mul_u32_u24 v5, 960, v5
    v_lshl_add_u32 v14, v14, 4, v5
    s_add_u32 s33, s33, 256
    v_add_u32_e64 v15, s33, v0
    v_mul_u32_u24 v5, 3277, v15
    v_lshrrev_b32_e64 v5, 16, v5
    v_mul_u32_u24 v5, 960, v5
    v_lshl_add_u32 v15, v15, 4, v5
    buffer_load_dwordx4 v27, s[44:47], s71 offen offset:1024 lds
    s_add_u32 s33, s33, 256
    v_add_u32_e64 v16, s33, v0
    v_mul_u32_u24 v5, 3277, v16
    v_lshrrev_b32_e64 v5, 16, v5
    v_mul_u32_u24 v5, 960, v5
    v_lshl_add_u32 v16, v16, 4, v5
    s_add_u32 s33, s33, 256
    s_lshl_b32 s80, s4, 2
    s_lshr_b32 s8, s5, 3
    s_add_u32 s80, s80, s8
    s_add_u32 s81, s5, s8
    s_and_b32 s81, s81, 7
    s_mul_i32 s82, s3, 13
    s_mul_i32 s83, s81, 54
    buffer_load_dwordx4 v28, s[44:47], s71 offen offset:2048 lds
    s_add_u32 s83, s83, s82
    s_mul_i32 s83, s83, 5120
    s_add_u32 s83, s83, 3047424
    v_lshlrev_b32 v1, 4, v0
    s_lshl_b32 s8, s68, 1
    s_lshr_b32 s9, s3, 1
    s_add_u32 s8, s8, s9
    s_lshl_b32 s8, s8, 5
    s_add_u32 s8, s8, s69
    s_lshl_b32 s8, s8, 1
    s_and_b32 s9, s3, 1
    s_add_u32 s8, s8, s9
    s_lshl_b32 s8, s8, 7
    s_add_u32 s39, s8, 73728
    s_lshl_b32 s8, s12, 7
    buffer_load_dwordx4 v29, s[44:47], s71 offen offset:3072 lds
    s_add_u32 s8, s8, 8192
    v_mov_b32_e64 v4, s8
    s_lshl_b32 s8, s12, 7
    s_add_u32 s8, s8, 204800
    v_writelane_b32 v4, s8, 1
    s_and_b32 s10, s14, 3
    s_lshl_b32 s10, s10, 8
    s_and_b32 s9, s14, 0xfc
    s_add_u32 s10, s10, s9
    s_lshl_b32 s10, s10, 5
    s_add_u32 s10, s10, 40960
    v_writelane_b32 v4, s10, 3
    v_writelane_b32 v4, s39, 4
    buffer_load_dword v17, v4, s[56:59], 0 offen
    s_waitcnt vmcnt(17)
    v_lshlrev_b32 v60, 16, v48
    s_add_u32 m0, s77, 49152
    v_and_b32 v61, s6, v48
    v_lshlrev_b32 v62, 16, v49
    v_and_b32 v63, s6, v49
    v_lshlrev_b32 v64, 16, v50
    v_and_b32 v65, s6, v50
    v_lshlrev_b32 v66, 16, v51
    v_and_b32 v67, s6, v51
    v_lshlrev_b32 v68, 16, v52
    v_and_b32 v69, s6, v52
    v_lshlrev_b32 v70, 16, v53
    v_and_b32 v71, s6, v53
    v_lshlrev_b32 v72, 16, v54
    v_and_b32 v73, s6, v54
    v_lshlrev_b32 v74, 16, v55
    v_and_b32 v75, s6, v55
    v_lshlrev_b32 v76, 16, v56
    v_and_b32 v77, s6, v56
    v_lshlrev_b32 v78, 16, v57
    v_and_b32_e64 v79, s6, v57
    v_pk_add_f32 v[80:81], v[60:61], v[62:63]
    v_pk_add_f32 v[82:83], v[64:65], v[66:67]
    v_pk_add_f32 v[84:85], v[68:69], v[70:71]
    v_pk_add_f32 v[86:87], v[72:73], v[74:75]
    v_pk_add_f32 v[88:89], v[76:77], v[78:79]
    v_pk_add_f32 v[80:81], v[80:81], v[82:83]
    v_pk_add_f32 v[84:85], v[84:85], v[86:87]
    v_pk_add_f32 v[80:81], v[80:81], v[88:89]
    v_pk_add_f32 v[80:81], v[80:81], v[84:85]
    buffer_load_dwordx4 v30, s[48:51], s72 offen lds
    v_add_f32 v10, v80, v81
    s_nop 1
    v_add_f32_dpp v10, v10, v10 row_ror:8 row_mask:0xf bank_mask:0xf
    s_nop 1
    v_add_f32_dpp v10, v10, v10 row_ror:4 row_mask:0xf bank_mask:0xf
    s_nop 1
    v_add_f32_dpp v10, v10, v10 row_ror:2 row_mask:0xf bank_mask:0xf
    s_nop 1
    v_add_f32_dpp v10, v10, v10 row_ror:1 row_mask:0xf bank_mask:0xf
    v_mov_b32 v11, v10
    s_nop 1
    v_permlane16_swap_b32 v11, v10
    v_add_f32_e64 v10, v10, v11
    v_mul_f32 v10, 0x3acccccd, v10
    v_cvt_pk_bf16_f32 v8, v10, v10
    v_lshlrev_b32 v8, 16, v8
    v_sub_f32 v10, v10, v8
    v_pk_add_f32 v[60:61], v[60:61], v[8:9] op_sel_hi:[1,0] neg_lo:[0,1] neg_hi:[0,1]
    v_pk_add_f32 v[62:63], v[62:63], v[8:9] op_sel_hi:[1,0] neg_lo:[0,1] neg_hi:[0,1]
    v_pk_add_f32 v[64:65], v[64:65], v[8:9] op_sel_hi:[1,0] neg_lo:[0,1] neg_hi:[0,1]
    v_pk_add_f32 v[66:67], v[66:67], v[8:9] op_sel_hi:[1,0] neg_lo:[0,1] neg_hi:[0,1]
    v_pk_add_f32 v[68:69], v[68:69], v[8:9] op_sel_hi:[1,0] neg_lo:[0,1] neg_hi:[0,1]
    v_pk_add_f32 v[70:71], v[70:71], v[8:9] op_sel_hi:[1,0] neg_lo:[0,1] neg_hi:[0,1]
    v_pk_add_f32 v[72:73], v[72:73], v[8:9] op_sel_hi:[1,0] neg_lo:[0,1] neg_hi:[0,1]
    v_pk_add_f32 v[74:75], v[74:75], v[8:9] op_sel_hi:[1,0] neg_lo:[0,1] neg_hi:[0,1]
    v_pk_add_f32 v[76:77], v[76:77], v[8:9] op_sel_hi:[1,0] neg_lo:[0,1] neg_hi:[0,1]
    v_pk_add_f32 v[78:79], v[78:79], v[8:9] op_sel_hi:[1,0] neg_lo:[0,1] neg_hi:[0,1]
    v_pk_mul_f32 v[80:81], v[60:61], v[60:61]
    v_pk_mul_f32 v[82:83], v[62:63], v[62:63]
    v_pk_fma_f32 v[80:81], v[64:65], v[64:65], v[80:81]
    v_pk_fma_f32 v[82:83], v[66:67], v[66:67], v[82:83]
    v_pk_fma_f32 v[80:81], v[68:69], v[68:69], v[80:81]
    v_pk_fma_f32 v[82:83], v[70:71], v[70:71], v[82:83]
    buffer_load_dwordx4 v31, s[48:51], s72 offen offset:1024 lds
    v_pk_fma_f32 v[80:81], v[72:73], v[72:73], v[80:81]
    v_pk_fma_f32 v[82:83], v[74:75], v[74:75], v[82:83]
    v_pk_fma_f32 v[80:81], v[76:77], v[76:77], v[80:81]
    v_pk_fma_f32 v[82:83], v[78:79], v[78:79], v[82:83]
    v_pk_add_f32 v[80:81], v[80:81], v[82:83]
    v_add_f32 v12, v80, v81
    s_nop 1
    v_add_f32_dpp v12, v12, v12 row_ror:8 row_mask:0xf bank_mask:0xf
    v_cvt_pk_bf16_f32 v48, v60, v61
    v_cvt_pk_bf16_f32 v49, v62, v63
    v_add_f32_dpp v12, v12, v12 row_ror:4 row_mask:0xf bank_mask:0xf
    v_cvt_pk_bf16_f32 v50, v64, v65
    v_cvt_pk_bf16_f32 v51, v66, v67
    v_add_f32_dpp v12, v12, v12 row_ror:2 row_mask:0xf bank_mask:0xf
    v_cvt_pk_bf16_f32 v52, v68, v69
    v_cvt_pk_bf16_f32 v53, v70, v71
    v_add_f32_dpp v12, v12, v12 row_ror:1 row_mask:0xf bank_mask:0xf
    v_cvt_pk_bf16_f32 v54, v72, v73
    v_cvt_pk_bf16_f32 v55, v74, v75
    v_mov_b32_e64 v11, v12
    v_cvt_pk_bf16_f32 v56, v76, v77
    v_cvt_pk_bf16_f32 v57, v78, v79
    v_permlane16_swap_b32 v11, v12
    v_lshlrev_b32 v60, 16, v48
    v_and_b32 v61, s6, v48
    v_add_f32 v12, v12, v11
    v_lshlrev_b32 v62, 16, v49
    v_and_b32 v63, s6, v49
    v_lshlrev_b32_e64 v64, 16, v50
    buffer_load_dwordx4 v30, s[52:55], s72 offen offset:2048 lds
    v_and_b32 v65, s6, v50
    v_lshlrev_b32 v66, 16, v51
    v_and_b32 v67, s6, v51
    v_lshlrev_b32 v68, 16, v52
    v_and_b32 v69, s6, v52
    v_lshlrev_b32 v70, 16, v53
    v_and_b32 v71, s6, v53
    v_lshlrev_b32 v72, 16, v54
    v_and_b32 v73, s6, v54
    v_lshlrev_b32 v74, 16, v55
    v_and_b32 v75, s6, v55
    v_lshlrev_b32 v76, 16, v56
    v_and_b32 v77, s6, v56
    v_lshlrev_b32 v78, 16, v57
    v_and_b32_e64 v79, s6, v57
    v_mul_f32 v12, 0x3acccccd, v12
    v_fma_f32 v12, -v10, v10, v12
    v_max_f32_e64 v12, 0, v12
    v_cvt_pk_bf16_f32 v12, v12, v12
    v_lshlrev_b32_e64 v12, 16, v12
    v_add_f32 v12, 0x3727c5ac, v12
    v_cvt_pk_bf16_f32 v12, v12, v12
    v_lshlrev_b32 v12, 16, v12
    v_sqrt_f32 v12, v12
    v_lshrrev_b32_e64 v4, 5, v0
    v_cvt_pk_bf16_f32 v12, v12, v12
    v_lshlrev_b32 v9, 16, v12
    v_rcp_f32 v12, v9
    buffer_load_dwordx4 v31, s[52:55], s72 offen offset:3072 lds
    s_mul_i32 s8, s3, 2688
    s_add_u32 s8, s8, 147456
    v_lshl_add_u32 v4, v4, 6, s8
    v_add_u32 v2, v2, v4
    v_add_u32 v3, v3, v4
    v_pk_mul_f32 v[60:61], v[60:61], v[12:13] op_sel_hi:[1,0]
    v_pk_mul_f32 v[62:63], v[62:63], v[12:13] op_sel_hi:[1,0]
    v_pk_mul_f32 v[64:65], v[64:65], v[12:13] op_sel_hi:[1,0]
    v_pk_mul_f32 v[66:67], v[66:67], v[12:13] op_sel_hi:[1,0]
    v_pk_mul_f32 v[68:69], v[68:69], v[12:13] op_sel_hi:[1,0]
    v_pk_mul_f32 v[70:71], v[70:71], v[12:13] op_sel_hi:[1,0]
    v_pk_mul_f32 v[72:73], v[72:73], v[12:13] op_sel_hi:[1,0]
    v_pk_mul_f32 v[74:75], v[74:75], v[12:13] op_sel_hi:[1,0]
    v_pk_mul_f32 v[76:77], v[76:77], v[12:13] op_sel_hi:[1,0]
    v_pk_mul_f32 v[78:79], v[78:79], v[12:13] op_sel_hi:[1,0]
    v_cvt_pk_bf16_f32 v48, v60, v61
    v_cvt_pk_bf16_f32 v49, v62, v63
    v_cvt_pk_bf16_f32 v50, v64, v65
    v_cvt_pk_bf16_f32 v51, v66, v67
    v_cvt_pk_bf16_f32 v52, v68, v69
    v_cvt_pk_bf16_f32 v53, v70, v71
    v_cvt_pk_bf16_f32 v54, v72, v73
    v_cvt_pk_bf16_f32 v55, v74, v75
    v_cvt_pk_bf16_f32 v56, v76, v77
    v_cvt_pk_bf16_f32 v57, v78, v79
    ds_write_b128 v2, v[48:51]
    ds_write_b128 v2, v[52:55] offset:512
    ds_write_b64 v3, v[56:57] offset:1024
    v_lshrrev_b32 v8, 16, v8
    v_or_b32 v8, v8, v9
    v_lshrrev_b32 v4, 5, v0
    s_lshl_b32 s8, s3, 3
    s_add_u32 s8, s8, 158208
    v_lshl_add_u32 v4, v4, 2, s8
    ds_write_b32 v4, v8
    s_add_u32 m0, s76, 49152
    s_nop 0
    buffer_load_dwordx4 v26, s[44:47], s70 offen offset:0 lds
    v_bfe_u32 v4, v0, 2, 2
    v_mul_u32_u24 v4, 1344, v4
    v_and_b32 v5, 3, v0
    v_lshl_add_u32 v4, v5, 3, v4
    v_lshrrev_b32_e64 v5, 4, v0
    v_lshl_add_u32 v4, v5, 5, v4
    s_lshl_b32 s8, s3, 7
    s_add_u32 s8, s8, 147456
    v_add_u32 v4, s8, v4
    v_and_b32 v6, 1, v0
    v_lshlrev_b32 v6, 4, v6
    v_add_u32 v6, 158208, v6
    s_waitcnt lgkmcnt(0)
    s_barrier
    ds_read_b64_tr_b16 v[48:49], v4 offset:0
    ds_read_b64_tr_b16 v[50:51], v4 offset:5376
    ds_read_b64_tr_b16 v[52:53], v4 offset:512
    ds_read_b64_tr_b16 v[54:55], v4 offset:5888
    ds_read_b64_tr_b16 v[56:57], v4 offset:1024
    ds_read_b64_tr_b16 v[58:59], v4 offset:6400
    ds_read_b128 v[60:63], v6
    s_mul_i32 s7, s7, 0x9e3779b1
    s_add_u32 s7, s7, 0x7f4a7c15
    s_add_u32 s72, s72, 221184
    buffer_load_dwordx4 v27, s[44:47], s70 offen offset:1024 lds
    v_lshlrev_b32_e64 v4, 4, v0
    s_mul_i32 s8, s12, 10368
    s_lshl_b32 s9, s3, 10
    s_add_u32 s8, s8, s9
    s_add_u32 s8, s8, 393216
    s_add_u32 s9, s8, 4096
    s_add_u32 s10, s8, 8192
    s_cmp_lt_u32 s3, 2
    s_cselect_b32 s10, s10, 15040512
    s_waitcnt lgkmcnt(0)
    buffer_store_dwordx4 v[48:51], v4, s[56:59], s8 offen sc1
    buffer_store_dwordx4 v[52:55], v4, s[56:59], s9 offen sc1
    buffer_store_dwordx4 v[56:59], v4, s[56:59], s10 offen sc1
    s_lshl_b32 s8, s12, 7
    s_add_u32 s8, s8, 360448
    s_cmp_eq_u32 s3, 2
    s_cselect_b32 s8, s8, 15040512
    s_mov_b64 exec, 0xff
    buffer_store_dwordx4 v[60:63], v4, s[56:59], s8 offen sc1
    s_mov_b64 exec, -1
    s_waitcnt vmcnt(11)
    s_barrier
    s_nop 0
    ds_read_b64_tr_b16 a[184:185], v22 offset:0
    ds_read_b64_tr_b16 a[186:187], v22 offset:512
    ds_read_b64_tr_b16 a[200:201], v24 offset:0
    ds_read_b64_tr_b16 a[202:203], v24 offset:512
    ds_read_b128 v[48:51], v20 offset:0
    ds_read_b128 v[52:55], v21 offset:0
    ds_read_b64_tr_b16 a[188:189], v23 offset:0
    ds_read_b64_tr_b16 a[190:191], v23 offset:512
    ds_read_b64_tr_b16 a[204:205], v25 offset:0
    ds_read_b64_tr_b16 a[206:207], v25 offset:512
    ds_read_b64_tr_b16 a[192:193], v22 offset:2048
    ds_read_b64_tr_b16 a[194:195], v22 offset:2560
    ds_read_b64_tr_b16 a[208:209], v24 offset:2048
    ds_read_b64_tr_b16 a[210:211], v24 offset:2560
    ds_read_b64_tr_b16 a[196:197], v23 offset:2048
    ds_read_b64_tr_b16 a[198:199], v23 offset:2560
    ds_read_b64_tr_b16 a[212:213], v25 offset:2048
    ds_read_b64_tr_b16 a[214:215], v25 offset:2560
    ds_read_b128 v[56:59], v20 offset:2048
    ds_read_b128 v[60:63], v21 offset:2048
    v_add_u32 v22, 49152, v22
    v_add_u32 v23, 49152, v23
    v_add_u32 v24, 49152, v24
    v_add_u32 v25, 49152, v25
    s_waitcnt lgkmcnt(8)
    v_mfma_f32_16x16x32_bf16 v[128:131], a[184:187], v[48:51], 0
    ds_read_b128 v[64:67], v20 offset:4096
    s_add_u32 s71, s70, 40960
    v_mfma_f32_16x16x32_bf16 v[128:131], a[200:203], v[52:55], v[128:131]
    buffer_load_dwordx4 v28, s[44:47], s70 offen offset:2048 lds
    v_mfma_f32_16x16x32_bf16 v[132:135], a[204:207], v[52:55], 0
    ds_read_b128 v[68:71], v21 offset:4096
    s_mul_i32 s32, s4, 7
    v_mfma_f32_16x16x32_bf16 v[132:135], a[188:191], v[48:51], v[132:135]
    s_lshr_b32 s32, s32, 2
    ds_read_b128 v[72:75], v20 offset:6144
    s_waitcnt lgkmcnt(8)
    v_mfma_f32_16x16x32_bf16 v[136:139], a[192:195], v[48:51], 0
    buffer_load_dwordx4 v29, s[44:47], s70 offen offset:3072 lds
    v_mfma_f32_16x16x32_bf16 v[136:139], a[208:211], v[52:55], v[136:139]
    s_lshl_b32 s16, s32, 10
    ds_read_b128 v[76:79], v21 offset:6144
    s_add_u32 m0, s76, 53248
    s_waitcnt lgkmcnt(6)
    v_mfma_f32_16x16x32_bf16 v[140:143], a[212:215], v[52:55], 0
    ds_read_b128 v[80:83], v20 offset:8192
Lst_538:
    s_cbranch_execz Lst_2799
    s_nop 0
    s_add_u32 s32, s16, 1024
    v_mfma_f32_16x16x32_bf16 v[140:143], a[196:199], v[48:51], v[140:143]
    ds_read_b128 v[84:87], v21 offset:8192
    s_sub_u32 s33, s32, 13312
    v_smfmac_f32_16x16x64_bf16 v[120:123], v[44:47], a[184:191], v119
    buffer_load_dwordx4 v26, s[44:47], s71 offen offset:0 lds
    v_smfmac_f32_16x16x64_bf16 v[124:127], v[44:47], a[192:199], v119
    s_min_u32 s17, s32, s33
    ds_read_b128 v[88:91], v20 offset:10240
    s_add_u32 s70, s70, 128
    s_waitcnt lgkmcnt(7)
    v_mfma_f32_16x16x32_bf16 v[144:147], a[184:187], v[56:59], 0
    ds_read_b128 v[92:95], v21 offset:10240
    s_add_u32 s32, s16, 2048
    v_mfma_f32_16x16x32_bf16 v[144:147], a[200:203], v[60:63], v[144:147]
    buffer_load_dwordx4 v27, s[44:47], s71 offen offset:1024 lds
    v_mfma_f32_16x16x32_bf16 v[148:151], a[204:207], v[60:63], 0
    ds_read_b128 v[96:99], v20 offset:12288
    s_sub_u32 s33, s32, 13312
    v_mfma_f32_16x16x32_bf16 v[148:151], a[188:191], v[56:59], v[148:151]
    ds_read_b128 v[100:103], v21 offset:12288
    s_min_u32 s18, s32, s33
    v_mfma_f32_16x16x32_bf16 v[152:155], a[192:195], v[56:59], 0
    ds_read_b128 v[104:107], v20 offset:14336
    s_add_u32 s32, s16, 3072
    v_mfma_f32_16x16x32_bf16 v[152:155], a[208:211], v[60:63], v[152:155]
    buffer_load_dwordx4 v28, s[44:47], s71 offen offset:2048 lds
    v_mfma_f32_16x16x32_bf16 v[156:159], a[212:215], v[60:63], 0
    s_sub_u32 s33, s32, 13312
    ds_read_b128 v[108:111], v21 offset:14336
    v_add_u32 v20, 49152, v20
    v_mfma_f32_16x16x32_bf16 v[156:159], a[196:199], v[56:59], v[156:159]
    s_min_u32 s19, s32, s33
    v_add_u32 v21, 49152, v21
    s_waitcnt lgkmcnt(8)
    v_mfma_f32_16x16x32_bf16 v[160:163], a[184:187], v[64:67], 0
    buffer_load_dwordx4 v29, s[44:47], s71 offen offset:3072 lds
    v_mfma_f32_16x16x32_bf16 v[160:163], a[200:203], v[68:71], v[160:163]
    s_add_u32 m0, s77, 98304
    s_add_u32 s32, s16, 4096
    s_sub_u32 s33, s32, 13312
    v_mfma_f32_16x16x32_bf16 v[164:167], a[204:207], v[68:71], 0
    s_min_u32 s20, s32, s33
    s_add_u32 s32, s16, 5120
    s_sub_u32 s33, s32, 13312
    v_mfma_f32_16x16x32_bf16 v[164:167], a[188:191], v[64:67], v[164:167]
    buffer_load_dwordx4 v30, s[48:51], s72 offen lds
    v_mfma_f32_16x16x32_bf16 v[168:171], a[192:195], v[64:67], 0
    s_lshl_b32 s10, s12, 7
    s_add_u32 s10, s10, 8192
    s_min_u32 s21, s32, s33
    v_mfma_f32_16x16x32_bf16 v[168:171], a[208:211], v[68:71], v[168:171]
    s_cmp_eq_u32 s3, 0
    s_cselect_b32 s10, s10, 15040512
    v_mov_b32 v19, s7
    v_mfma_f32_16x16x32_bf16 v[172:175], a[212:215], v[68:71], 0
    s_add_u32 s32, s16, 6144
    s_sub_u32 s33, s32, 13312
    s_min_u32 s22, s32, s33
    v_mfma_f32_16x16x32_bf16 v[172:175], a[196:199], v[64:67], v[172:175]
    buffer_load_dwordx4 v31, s[48:51], s72 offen offset:1024 lds
    v_mfma_f32_16x16x32_bf16 v[176:179], a[184:187], v[72:75], 0
    s_add_u32 s32, s16, 7168
    s_sub_u32 s33, s32, 13312
    s_min_u32 s23, s32, s33
    v_mfma_f32_16x16x32_bf16 v[176:179], a[200:203], v[76:79], v[176:179]
    s_add_u32 s32, s16, 8192
    s_sub_u32 s33, s32, 13312
    s_min_u32 s24, s32, s33
    v_mfma_f32_16x16x32_bf16 v[180:183], a[204:207], v[76:79], 0
    buffer_load_dwordx4 v30, s[52:55], s72 offen offset:2048 lds
    v_mfma_f32_16x16x32_bf16 v[180:183], a[188:191], v[72:75], v[180:183]
    s_add_u32 s32, s16, 9216
    s_sub_u32 s33, s32, 13312
    s_min_u32 s25, s32, s33
    v_mfma_f32_16x16x32_bf16 v[184:187], a[192:195], v[72:75], 0
    s_add_u32 s32, s16, 10240
    s_sub_u32 s33, s32, 13312
    s_min_u32 s26, s32, s33
    v_mfma_f32_16x16x32_bf16 v[184:187], a[208:211], v[76:79], v[184:187]
    s_add_u32 s32, s16, 11264
    s_sub_u32 s33, s32, 13312
    s_min_u32 s27, s32, s33
    v_mfma_f32_16x16x32_bf16 v[188:191], a[212:215], v[76:79], 0
    buffer_load_dwordx4 v31, s[52:55], s72 offen offset:3072 lds
    v_mfma_f32_16x16x32_bf16 v[188:191], a[196:199], v[72:75], v[188:191]
    s_add_u32 m0, s76, 98304
    s_add_u32 s32, s16, 12288
    s_waitcnt lgkmcnt(6)
    v_mfma_f32_16x16x32_bf16 v[192:195], a[184:187], v[80:83], 0
    s_sub_u32 s33, s32, 13312
    s_min_u32 s28, s32, s33
    s_lshr_b32 s32, s3, 1
    v_mfma_f32_16x16x32_bf16 v[192:195], a[200:203], v[84:87], v[192:195]
    buffer_load_dwordx4 v26, s[44:47], s70 offen offset:0 lds
    v_mfma_f32_16x16x32_bf16 v[196:199], a[204:207], v[84:87], 0
    s_add_u32 s72, s72, 221184
    s_mul_i32 s33, s3, 13
    s_sub_u32 s32, s32, s33
    v_mfma_f32_16x16x32_bf16 v[196:199], a[188:191], v[80:83], v[196:199]
    s_add_u32 s32, s32, 52
    s_lshl_b32 s29, s32, 10
    s_mul_i32 s41, s81, 0
    v_mfma_f32_16x16x32_bf16 v[200:203], a[192:195], v[80:83], 0
    buffer_load_dwordx4 v27, s[44:47], s70 offen offset:1024 lds
    v_mfma_f32_16x16x32_bf16 v[200:203], a[208:211], v[84:87], v[200:203]
    s_add_u32 s71, s70, 40960
    s_add_u32 s41, s41, s3
    s_and_b32 s41, s41, 3
    v_mfma_f32_16x16x32_bf16 v[204:207], a[212:215], v[84:87], 0
    s_waitcnt vmcnt(6) lgkmcnt(0)
    s_add_u32 s32, s41, 1
    s_and_b32 s32, s32, 3
    v_mfma_f32_16x16x32_bf16 v[204:207], a[196:199], v[80:83], v[204:207]
    s_lshl2_add_u32 s32, s80, s32
    s_mul_i32 s32, s32, 54
    v_mfma_f32_16x16x32_bf16 v[208:211], a[184:187], v[88:91], 0
    s_barrier
    ds_read_b128 v[48:51], v20 offset:0
    s_add_u32 s32, s32, s82
    v_mfma_f32_16x16x32_bf16 v[208:211], a[200:203], v[92:95], v[208:211]
    buffer_load_dwordx4 v28, s[44:47], s70 offen offset:2048 lds
    s_mov_b64 exec, 1
    buffer_store_dword v19, off, s[56:59], s10 sc1
    s_mov_b64 exec, -1
    v_mfma_f32_16x16x32_bf16 v[212:215], a[204:207], v[92:95], 0
    ds_read_b128 v[52:55], v21 offset:0
    s_lshl_b32 s32, s32, 10
    v_mfma_f32_16x16x32_bf16 v[212:215], a[188:191], v[88:91], v[212:215]
    buffer_load_dwordx4 v29, s[44:47], s70 offen offset:3072 lds
    v_mfma_f32_16x16x32_bf16 v[216:219], a[192:195], v[88:91], 0
    s_add_u32 s30, s32, 7962624
    ds_read_b64_tr_b16 a[216:217], v22 offset:0
    s_add_u32 m0, s76, 102400
    v_mfma_f32_16x16x32_bf16 v[216:219], a[208:211], v[92:95], v[216:219]
    ds_read_b64_tr_b16 a[218:219], v22 offset:512
    s_add_u32 s32, s41, 2
    v_mfma_f32_16x16x32_bf16 v[220:223], a[212:215], v[92:95], 0
    ds_read_b64_tr_b16 a[232:233], v24 offset:0
    s_and_b32 s32, s32, 3
    v_mfma_f32_16x16x32_bf16 v[220:223], a[196:199], v[88:91], v[220:223]
    s_lshl2_add_u32 s32, s80, s32
    ds_read_b64_tr_b16 a[234:235], v24 offset:512
    v_mfma_f32_16x16x32_bf16 v[224:227], a[184:187], v[96:99], 0
    buffer_load_dwordx4 v26, s[44:47], s71 offen offset:0 lds
    v_mfma_f32_16x16x32_bf16 v[224:227], a[200:203], v[100:103], v[224:227]
    s_mul_i32 s32, s32, 54
    ds_read_b64_tr_b16 a[220:221], v23 offset:0
    s_add_u32 s70, s70, 128
    v_mfma_f32_16x16x32_bf16 v[228:231], a[204:207], v[100:103], 0
    buffer_load_dwordx4 v27, s[44:47], s71 offen offset:1024 lds
    v_mfma_f32_16x16x32_bf16 v[228:231], a[188:191], v[96:99], v[228:231]
    ds_read_b64_tr_b16 a[222:223], v23 offset:512
    s_add_u32 s32, s32, s82
    v_mfma_f32_16x16x32_bf16 v[232:235], a[192:195], v[96:99], 0
    ds_read_b64_tr_b16 a[236:237], v25 offset:0
    s_lshl_b32 s32, s32, 10
    v_mfma_f32_16x16x32_bf16 v[232:235], a[208:211], v[100:103], v[232:235]
    buffer_load_dwordx4 v28, s[44:47], s71 offen offset:2048 lds
    v_mfma_f32_16x16x32_bf16 v[236:239], a[212:215], v[100:103], 0
    ds_read_b64_tr_b16 a[238:239], v25 offset:512
    s_add_u32 s31, s32, 7962624
    v_mfma_f32_16x16x32_bf16 v[236:239], a[196:199], v[96:99], v[236:239]
    ds_read_b64_tr_b16 a[224:225], v22 offset:2048
    s_add_u32 s32, s41, 3
    v_mfma_f32_16x16x32_bf16 v[240:243], a[184:187], v[104:107], 0
    ds_read_b64_tr_b16 a[226:227], v22 offset:2560
    s_and_b32 s32, s32, 3
    v_mfma_f32_16x16x32_bf16 v[240:243], a[200:203], v[108:111], v[240:243]
    buffer_load_dwordx4 v29, s[44:47], s71 offen offset:3072 lds
    v_mfma_f32_16x16x32_bf16 v[244:247], a[204:207], v[108:111], 0
    ds_read_b64_tr_b16 a[240:241], v24 offset:2048
    s_lshl2_add_u32 s32, s80, s32
    v_mfma_f32_16x16x32_bf16 v[244:247], a[188:191], v[104:107], v[244:247]
    ds_read_b64_tr_b16 a[242:243], v24 offset:2560
    s_mul_i32 s32, s32, 54
    v_mfma_f32_16x16x32_bf16 v[248:251], a[192:195], v[104:107], 0
    s_add_u32 m0, s86, 147456
    s_nop 0
    buffer_load_dwordx4 v14, s[64:67], s85 offen lds
    v_mfma_f32_16x16x32_bf16 v[248:251], a[208:211], v[108:111], v[248:251]
    ds_read_b64_tr_b16 a[228:229], v23 offset:2048
    s_add_u32 s32, s32, s82
    v_mfma_f32_16x16x32_bf16 v[252:255], a[212:215], v[108:111], 0
    ds_read_b64_tr_b16 a[230:231], v23 offset:2560
    s_lshl_b32 s32, s32, 10
    v_mfma_f32_16x16x32_bf16 v[252:255], a[196:199], v[104:107], v[252:255]
    s_add_u32 s40, s32, 7962624
    ds_read_b64_tr_b16 a[244:245], v25 offset:2048
    s_waitcnt lgkmcnt(8)
    v_mfma_f32_16x16x32_bf16 v[128:131], a[216:219], v[48:51], v[128:131]
    s_add_u32 m0, s86, 151552
    s_nop 0
    buffer_load_dwordx4 v15, s[64:67], s85 offen lds
    v_mfma_f32_16x16x32_bf16 v[128:131], a[232:235], v[52:55], v[128:131]
    s_add_u32 s32, s41, 4
    ds_read_b64_tr_b16 a[246:247], v25 offset:2560
    v_add_u32 v22, 49152, v22
    s_waitcnt lgkmcnt(8)
    v_mfma_f32_16x16x32_bf16 v[132:135], a[236:239], v[52:55], v[132:135]
    s_and_b32 s32, s32, 3
    ds_read_b128 v[56:59], v20 offset:2048
    v_add_u32 v23, 49152, v23
    v_mfma_f32_16x16x32_bf16 v[132:135], a[220:223], v[48:51], v[132:135]
    s_lshl2_add_u32 s32, s80, s32
    ds_read_b128 v[60:63], v21 offset:2048
    s_waitcnt lgkmcnt(6)
    v_mfma_f32_16x16x32_bf16 v[136:139], a[224:227], v[48:51], v[136:139]
    s_add_u32 m0, s86, 155648
    s_nop 0
    buffer_load_dwordx4 v16, s[64:67], s87 offen lds
    v_mfma_f32_16x16x32_bf16 v[136:139], a[240:243], v[52:55], v[136:139]
    s_add_u32 m0, s77, 0
    ds_read_b128 v[64:67], v20 offset:4096
    v_add_u32 v24, 49152, v24
    s_waitcnt lgkmcnt(3)
    v_mfma_f32_16x16x32_bf16 v[140:143], a[244:247], v[52:55], v[140:143]
    buffer_load_dwordx4 v30, s[48:51], s72 offen lds
    v_mfma_f32_16x16x32_bf16 v[140:143], a[228:231], v[48:51], v[140:143]
    s_mul_i32 s32, s32, 54
    ds_read_b128 v[68:71], v21 offset:4096
    v_add_u32 v25, 49152, v25
    v_smfmac_f32_16x16x64_bf16 v[120:123], v[44:47], a[216:223], v119
    ds_read_b128 v[72:75], v20 offset:6144
    s_add_u32 s32, s32, s82
    v_smfmac_f32_16x16x64_bf16 v[124:127], v[44:47], a[224:231], v119
    ds_read_b128 v[76:79], v21 offset:6144
    s_lshl_b32 s32, s32, 10
    s_waitcnt lgkmcnt(4)
    v_mfma_f32_16x16x32_bf16 v[144:147], a[216:219], v[56:59], v[144:147]
    buffer_load_dwordx4 v31, s[48:51], s72 offen offset:1024 lds
    v_mfma_f32_16x16x32_bf16 v[144:147], a[232:235], v[60:63], v[144:147]
    ds_read_b128 v[80:83], v20 offset:8192
    s_add_u32 s84, s32, 7962624
    v_mfma_f32_16x16x32_bf16 v[148:151], a[236:239], v[60:63], v[148:151]
    ds_read_b128 v[84:87], v21 offset:8192
    v_mfma_f32_16x16x32_bf16 v[148:151], a[220:223], v[56:59], v[148:151]
    buffer_load_dwordx4 v30, s[52:55], s72 offen offset:2048 lds
    v_mfma_f32_16x16x32_bf16 v[152:155], a[224:227], v[56:59], v[152:155]
    ds_read_b128 v[88:91], v20 offset:10240
    v_mfma_f32_16x16x32_bf16 v[152:155], a[240:243], v[60:63], v[152:155]
    ds_read_b128 v[92:95], v21 offset:10240
    v_mfma_f32_16x16x32_bf16 v[156:159], a[244:247], v[60:63], v[156:159]
    ds_read_b128 v[96:99], v20 offset:12288
    v_mfma_f32_16x16x32_bf16 v[156:159], a[228:231], v[56:59], v[156:159]
    ds_read_b128 v[100:103], v21 offset:12288
    s_waitcnt lgkmcnt(8)
    v_mfma_f32_16x16x32_bf16 v[160:163], a[216:219], v[64:67], v[160:163]
    buffer_load_dwordx4 v31, s[52:55], s72 offen offset:3072 lds
    v_mfma_f32_16x16x32_bf16 v[160:163], a[232:235], v[68:71], v[160:163]
    ds_read_b128 v[104:107], v20 offset:14336
    s_add_u32 m0, s76, 0
    v_mfma_f32_16x16x32_bf16 v[164:167], a[236:239], v[68:71], v[164:167]
    buffer_load_dwordx4 v26, s[44:47], s70 offen offset:0 lds
    v_mfma_f32_16x16x32_bf16 v[164:167], a[220:223], v[64:67], v[164:167]
    s_add_u32 s72, s72, 221184
    ds_read_b128 v[108:111], v21 offset:14336
    v_add_u32 v20, 49152, v20
    v_mfma_f32_16x16x32_bf16 v[168:171], a[224:227], v[64:67], v[168:171]
    v_add_u32 v21, 49152, v21
    v_mfma_f32_16x16x32_bf16 v[168:171], a[240:243], v[68:71], v[168:171]
    buffer_load_dwordx4 v27, s[44:47], s70 offen offset:1024 lds
    v_mfma_f32_16x16x32_bf16 v[172:175], a[244:247], v[68:71], v[172:175]
    s_add_u32 s71, s70, 40960
    v_mfma_f32_16x16x32_bf16 v[172:175], a[228:231], v[64:67], v[172:175]
    s_waitcnt lgkmcnt(8)
    v_mfma_f32_16x16x32_bf16 v[176:179], a[216:219], v[72:75], v[176:179]
    v_mfma_f32_16x16x32_bf16 v[176:179], a[232:235], v[76:79], v[176:179]
    buffer_load_dwordx4 v28, s[44:47], s70 offen offset:2048 lds
    v_mfma_f32_16x16x32_bf16 v[180:183], a[236:239], v[76:79], v[180:183]
    v_mfma_f32_16x16x32_bf16 v[180:183], a[220:223], v[72:75], v[180:183]
    v_mfma_f32_16x16x32_bf16 v[184:187], a[224:227], v[72:75], v[184:187]
    buffer_load_dwordx4 v29, s[44:47], s70 offen offset:3072 lds
    v_mfma_f32_16x16x32_bf16 v[184:187], a[240:243], v[76:79], v[184:187]
    s_add_u32 m0, s76, 4096
    v_mfma_f32_16x16x32_bf16 v[188:191], a[244:247], v[76:79], v[188:191]
    v_mfma_f32_16x16x32_bf16 v[188:191], a[228:231], v[72:75], v[188:191]
    s_waitcnt lgkmcnt(6)
    v_mfma_f32_16x16x32_bf16 v[192:195], a[216:219], v[80:83], v[192:195]
    buffer_load_dwordx4 v26, s[44:47], s71 offen offset:0 lds
    v_mfma_f32_16x16x32_bf16 v[192:195], a[232:235], v[84:87], v[192:195]
    s_add_u32 s70, s70, 128
    v_mfma_f32_16x16x32_bf16 v[196:199], a[236:239], v[84:87], v[196:199]
    v_mfma_f32_16x16x32_bf16 v[196:199], a[220:223], v[80:83], v[196:199]
    buffer_load_dwordx4 v27, s[44:47], s71 offen offset:1024 lds
    v_mfma_f32_16x16x32_bf16 v[200:203], a[224:227], v[80:83], v[200:203]
    v_mfma_f32_16x16x32_bf16 v[200:203], a[240:243], v[84:87], v[200:203]
    v_mfma_f32_16x16x32_bf16 v[204:207], a[244:247], v[84:87], v[204:207]
    s_waitcnt vmcnt(13) lgkmcnt(0)
    v_mfma_f32_16x16x32_bf16 v[204:207], a[228:231], v[80:83], v[204:207]
    buffer_load_dwordx4 v28, s[44:47], s71 offen offset:2048 lds
    v_mfma_f32_16x16x32_bf16 v[208:211], a[216:219], v[88:91], v[208:211]
    s_barrier
    ds_read_b128 v[48:51], v20 offset:0
    v_mfma_f32_16x16x32_bf16 v[208:211], a[232:235], v[92:95], v[208:211]
    ds_read_b128 v[52:55], v21 offset:0
    v_mfma_f32_16x16x32_bf16 v[212:215], a[236:239], v[92:95], v[212:215]
    buffer_load_dwordx4 v29, s[44:47], s71 offen offset:3072 lds
    v_mfma_f32_16x16x32_bf16 v[212:215], a[220:223], v[88:91], v[212:215]
    ds_read_b64_tr_b16 a[184:185], v22 offset:0
    s_add_u32 m0, s77, 49152
    v_mfma_f32_16x16x32_bf16 v[216:219], a[224:227], v[88:91], v[216:219]
    ds_read_b64_tr_b16 a[186:187], v22 offset:512
    v_mfma_f32_16x16x32_bf16 v[216:219], a[240:243], v[92:95], v[216:219]
    buffer_load_dwordx4 v30, s[48:51], s72 offen lds
    v_mfma_f32_16x16x32_bf16 v[220:223], a[244:247], v[92:95], v[220:223]
    ds_read_b64_tr_b16 a[200:201], v24 offset:0
    v_mfma_f32_16x16x32_bf16 v[220:223], a[228:231], v[88:91], v[220:223]
    ds_read_b64_tr_b16 a[202:203], v24 offset:512
    v_mfma_f32_16x16x32_bf16 v[224:227], a[216:219], v[96:99], v[224:227]
    ds_read_b64_tr_b16 a[188:189], v23 offset:0
    v_mfma_f32_16x16x32_bf16 v[224:227], a[232:235], v[100:103], v[224:227]
    buffer_load_dwordx4 v31, s[48:51], s72 offen offset:1024 lds
    v_mfma_f32_16x16x32_bf16 v[228:231], a[236:239], v[100:103], v[228:231]
    ds_read_b64_tr_b16 a[190:191], v23 offset:512
    v_mfma_f32_16x16x32_bf16 v[228:231], a[220:223], v[96:99], v[228:231]
    ds_read_b64_tr_b16 a[204:205], v25 offset:0
    v_mfma_f32_16x16x32_bf16 v[232:235], a[224:227], v[96:99], v[232:235]
    buffer_load_dwordx4 v30, s[52:55], s72 offen offset:2048 lds
    v_mfma_f32_16x16x32_bf16 v[232:235], a[240:243], v[100:103], v[232:235]
    ds_read_b64_tr_b16 a[206:207], v25 offset:512
    v_mfma_f32_16x16x32_bf16 v[236:239], a[244:247], v[100:103], v[236:239]
    ds_read_b64_tr_b16 a[192:193], v22 offset:2048
    v_mfma_f32_16x16x32_bf16 v[236:239], a[228:231], v[96:99], v[236:239]
    buffer_load_dwordx4 v31, s[52:55], s72 offen offset:3072 lds
    v_mfma_f32_16x16x32_bf16 v[240:243], a[216:219], v[104:107], v[240:243]
    ds_read_b64_tr_b16 a[194:195], v22 offset:2560
    s_add_u32 m0, s76, 49152
    v_mfma_f32_16x16x32_bf16 v[240:243], a[232:235], v[108:111], v[240:243]
    ds_read_b64_tr_b16 a[208:209], v24 offset:2048
    v_mfma_f32_16x16x32_bf16 v[244:247], a[236:239], v[108:111], v[244:247]
    ds_read_b64_tr_b16 a[210:211], v24 offset:2560
    v_mfma_f32_16x16x32_bf16 v[244:247], a[220:223], v[104:107], v[244:247]
    buffer_load_dwordx4 v26, s[44:47], s70 offen offset:0 lds
    v_mfma_f32_16x16x32_bf16 v[248:251], a[224:227], v[104:107], v[248:251]
    ds_read_b64_tr_b16 a[196:197], v23 offset:2048
    s_add_u32 s72, s72, 221184
    v_mfma_f32_16x16x32_bf16 v[248:251], a[240:243], v[108:111], v[248:251]
    ds_read_b64_tr_b16 a[198:199], v23 offset:2560
    v_mfma_f32_16x16x32_bf16 v[252:255], a[244:247], v[108:111], v[252:255]
    buffer_load_dwordx4 v27, s[44:47], s70 offen offset:1024 lds
    v_mfma_f32_16x16x32_bf16 v[252:255], a[228:231], v[104:107], v[252:255]
    s_add_u32 s71, s70, 40960
    ds_read_b64_tr_b16 a[212:213], v25 offset:2048
    s_waitcnt lgkmcnt(8)
    v_mfma_f32_16x16x32_bf16 v[128:131], a[184:187], v[48:51], v[128:131]
    ds_read_b64_tr_b16 a[214:215], v25 offset:2560
    v_subrev_u32 v22, 98304, v22
    v_mfma_f32_16x16x32_bf16 v[128:131], a[200:203], v[52:55], v[128:131]
    ds_read_b128 v[56:59], v20 offset:2048
    v_subrev_u32 v23, 98304, v23
    s_waitcnt lgkmcnt(8)
    v_mfma_f32_16x16x32_bf16 v[132:135], a[204:207], v[52:55], v[132:135]
    buffer_load_dwordx4 v28, s[44:47], s70 offen offset:2048 lds
    v_mfma_f32_16x16x32_bf16 v[132:135], a[188:191], v[48:51], v[132:135]
    ds_read_b128 v[60:63], v21 offset:2048
    s_waitcnt lgkmcnt(6)
    v_mfma_f32_16x16x32_bf16 v[136:139], a[192:195], v[48:51], v[136:139]
    ds_read_b128 v[64:67], v20 offset:4096
    v_subrev_u32 v24, 98304, v24
    v_mfma_f32_16x16x32_bf16 v[136:139], a[208:211], v[52:55], v[136:139]
    buffer_load_dwordx4 v29, s[44:47], s70 offen offset:3072 lds
    s_waitcnt lgkmcnt(3)
    v_mfma_f32_16x16x32_bf16 v[140:143], a[212:215], v[52:55], v[140:143]
    s_add_u32 m0, s76, 53248
    ds_read_b128 v[68:71], v21 offset:4096
    v_subrev_u32 v25, 98304, v25
    v_mfma_f32_16x16x32_bf16 v[140:143], a[196:199], v[48:51], v[140:143]
    ds_read_b128 v[72:75], v20 offset:6144
    v_smfmac_f32_16x16x64_bf16 v[120:123], v[44:47], a[184:191], v119
    buffer_load_dwordx4 v26, s[44:47], s71 offen offset:0 lds
    v_smfmac_f32_16x16x64_bf16 v[124:127], v[44:47], a[192:199], v119
    ds_read_b128 v[76:79], v21 offset:6144
    s_add_u32 s70, s70, 128
    s_waitcnt lgkmcnt(4)
    v_mfma_f32_16x16x32_bf16 v[144:147], a[184:187], v[56:59], v[144:147]
    ds_read_b128 v[80:83], v20 offset:8192
    v_mfma_f32_16x16x32_bf16 v[144:147], a[200:203], v[60:63], v[144:147]
    ds_read_b128 v[84:87], v21 offset:8192
    v_mfma_f32_16x16x32_bf16 v[148:151], a[204:207], v[60:63], v[148:151]
    buffer_load_dwordx4 v27, s[44:47], s71 offen offset:1024 lds
    v_mfma_f32_16x16x32_bf16 v[148:151], a[188:191], v[56:59], v[148:151]
    ds_read_b128 v[88:91], v20 offset:10240
    v_mfma_f32_16x16x32_bf16 v[152:155], a[192:195], v[56:59], v[152:155]
    ds_read_b128 v[92:95], v21 offset:10240
    v_mfma_f32_16x16x32_bf16 v[152:155], a[208:211], v[60:63], v[152:155]
    buffer_load_dwordx4 v28, s[44:47], s71 offen offset:2048 lds
    v_mfma_f32_16x16x32_bf16 v[156:159], a[212:215], v[60:63], v[156:159]
    ds_read_b128 v[96:99], v20 offset:12288
    v_mfma_f32_16x16x32_bf16 v[156:159], a[196:199], v[56:59], v[156:159]
    ds_read_b128 v[100:103], v21 offset:12288
    s_waitcnt lgkmcnt(8)
    v_mfma_f32_16x16x32_bf16 v[160:163], a[184:187], v[64:67], v[160:163]
    ds_read_b128 v[104:107], v20 offset:14336
    v_mfma_f32_16x16x32_bf16 v[160:163], a[200:203], v[68:71], v[160:163]
    buffer_load_dwordx4 v29, s[44:47], s71 offen offset:3072 lds
    v_mfma_f32_16x16x32_bf16 v[164:167], a[204:207], v[68:71], v[164:167]
    ds_read_b128 v[108:111], v21 offset:14336
    v_subrev_u32 v20, 98304, v20
    v_mfma_f32_16x16x32_bf16 v[164:167], a[188:191], v[64:67], v[164:167]
    v_subrev_u32 v21, 98304, v21
    v_mfma_f32_16x16x32_bf16 v[168:171], a[192:195], v[64:67], v[168:171]
    v_mfma_f32_16x16x32_bf16 v[168:171], a[208:211], v[68:71], v[168:171]
    v_mfma_f32_16x16x32_bf16 v[172:175], a[212:215], v[68:71], v[172:175]
    v_mfma_f32_16x16x32_bf16 v[172:175], a[196:199], v[64:67], v[172:175]
    s_waitcnt lgkmcnt(8)
    v_mfma_f32_16x16x32_bf16 v[176:179], a[184:187], v[72:75], v[176:179]
    v_mfma_f32_16x16x32_bf16 v[176:179], a[200:203], v[76:79], v[176:179]
    v_mfma_f32_16x16x32_bf16 v[180:183], a[204:207], v[76:79], v[180:183]
    v_mfma_f32_16x16x32_bf16 v[180:183], a[188:191], v[72:75], v[180:183]
    v_mfma_f32_16x16x32_bf16 v[184:187], a[192:195], v[72:75], v[184:187]
    v_mfma_f32_16x16x32_bf16 v[184:187], a[208:211], v[76:79], v[184:187]
    v_mfma_f32_16x16x32_bf16 v[188:191], a[212:215], v[76:79], v[188:191]
    v_mfma_f32_16x16x32_bf16 v[188:191], a[196:199], v[72:75], v[188:191]
    s_waitcnt lgkmcnt(6)
    v_mfma_f32_16x16x32_bf16 v[192:195], a[184:187], v[80:83], v[192:195]
    v_mfma_f32_16x16x32_bf16 v[192:195], a[200:203], v[84:87], v[192:195]
    v_mfma_f32_16x16x32_bf16 v[196:199], a[204:207], v[84:87], v[196:199]
    v_mfma_f32_16x16x32_bf16 v[196:199], a[188:191], v[80:83], v[196:199]
    v_mfma_f32_16x16x32_bf16 v[200:203], a[192:195], v[80:83], v[200:203]
    v_mfma_f32_16x16x32_bf16 v[200:203], a[208:211], v[84:87], v[200:203]
    v_mfma_f32_16x16x32_bf16 v[204:207], a[212:215], v[84:87], v[204:207]
    s_waitcnt vmcnt(12) lgkmcnt(0)
    v_mfma_f32_16x16x32_bf16 v[204:207], a[196:199], v[80:83], v[204:207]
    v_mfma_f32_16x16x32_bf16 v[208:211], a[184:187], v[88:91], v[208:211]
    s_barrier
    ds_read_b128 v[48:51], v20 offset:0
    s_add_u32 m0, s77, 98304
    v_mfma_f32_16x16x32_bf16 v[208:211], a[200:203], v[92:95], v[208:211]
    buffer_load_dwordx4 v30, s[48:51], s72 offen lds
    v_mfma_f32_16x16x32_bf16 v[212:215], a[204:207], v[92:95], v[212:215]
    ds_read_b128 v[52:55], v21 offset:0
    v_lshrrev_b32 v2, 2, v0
    v_mfma_f32_16x16x32_bf16 v[212:215], a[188:191], v[88:91], v[212:215]
    ds_read_b64_tr_b16 a[216:217], v22 offset:0
    v_mul_u32_u24 v2, 320, v2
    v_mfma_f32_16x16x32_bf16 v[216:219], a[192:195], v[88:91], v[216:219]
    buffer_load_dwordx4 v31, s[48:51], s72 offen offset:1024 lds
    v_mfma_f32_16x16x32_bf16 v[216:219], a[208:211], v[92:95], v[216:219]
    ds_read_b64_tr_b16 a[218:219], v22 offset:512
    v_and_b32_e64 v3, 3, v0
    v_mfma_f32_16x16x32_bf16 v[220:223], a[212:215], v[92:95], v[220:223]
    ds_read_b64_tr_b16 a[232:233], v24 offset:0
    s_lshr_b32 s32, s3, 1
    v_mfma_f32_16x16x32_bf16 v[220:223], a[196:199], v[88:91], v[220:223]
    s_lshl_b32 s32, s32, 6
    ds_read_b64_tr_b16 a[234:235], v24 offset:512
    v_mfma_f32_16x16x32_bf16 v[224:227], a[184:187], v[96:99], v[224:227]
    buffer_load_dwordx4 v30, s[52:55], s72 offen offset:2048 lds
    v_mfma_f32_16x16x32_bf16 v[224:227], a[200:203], v[100:103], v[224:227]
    ds_read_b64_tr_b16 a[220:221], v23 offset:0
    s_and_b32 s33, s3, 1
    v_mfma_f32_16x16x32_bf16 v[228:231], a[204:207], v[100:103], v[228:231]
    ds_read_b64_tr_b16 a[222:223], v23 offset:512
    s_lshl_b32 s34, s33, 3
    v_mfma_f32_16x16x32_bf16 v[228:231], a[188:191], v[96:99], v[228:231]
    ds_read_b64_tr_b16 a[236:237], v25 offset:0
    s_add_u32 s32, s32, s34
    v_mfma_f32_16x16x32_bf16 v[232:235], a[192:195], v[96:99], v[232:235]
    buffer_load_dwordx4 v31, s[52:55], s72 offen offset:3072 lds
    v_mfma_f32_16x16x32_bf16 v[232:235], a[208:211], v[100:103], v[232:235]
    s_add_u32 s32, s32, 147456
    ds_read_b64_tr_b16 a[238:239], v25 offset:512
    s_add_u32 m0, s76, 98304
    v_mfma_f32_16x16x32_bf16 v[236:239], a[212:215], v[100:103], v[236:239]
    ds_read_b64_tr_b16 a[224:225], v22 offset:2048
    s_mul_i32 s33, s33, 160
    v_mfma_f32_16x16x32_bf16 v[236:239], a[196:199], v[96:99], v[236:239]
    ds_read_b64_tr_b16 a[226:227], v22 offset:2560
    s_add_u32 s33, s33, 147584
    v_mfma_f32_16x16x32_bf16 v[240:243], a[184:187], v[104:107], v[240:243]
    ds_read_b64_tr_b16 a[240:241], v24 offset:2048
    v_lshl_add_u32 v6, v3, 4, v2
    v_mfma_f32_16x16x32_bf16 v[240:243], a[200:203], v[108:111], v[240:243]
    buffer_load_dwordx4 v26, s[44:47], s70 offen offset:0 lds
    v_mfma_f32_16x16x32_bf16 v[244:247], a[204:207], v[108:111], v[244:247]
    ds_read_b64_tr_b16 a[242:243], v24 offset:2560
    s_add_u32 s72, s72, 221184
    v_mfma_f32_16x16x32_bf16 v[244:247], a[188:191], v[104:107], v[244:247]
    ds_read_b64_tr_b16 a[228:229], v23 offset:2048
    v_lshl_add_u32 v7, v3, 3, v2
    v_mfma_f32_16x16x32_bf16 v[248:251], a[192:195], v[104:107], v[248:251]
    ds_read_b64_tr_b16 a[230:231], v23 offset:2560
    v_add_u32 v6, s32, v6
    v_mfma_f32_16x16x32_bf16 v[248:251], a[208:211], v[108:111], v[248:251]
    buffer_load_dwordx4 v27, s[44:47], s70 offen offset:1024 lds
    v_mfma_f32_16x16x32_bf16 v[252:255], a[212:215], v[108:111], v[252:255]
    ds_read_b64_tr_b16 a[244:245], v25 offset:2048
    s_add_u32 s71, s70, 40960
    v_mfma_f32_16x16x32_bf16 v[252:255], a[196:199], v[104:107], v[252:255]
    ds_read_b64_tr_b16 a[246:247], v25 offset:2560
    s_waitcnt lgkmcnt(8)
    v_mfma_f32_16x16x32_bf16 v[128:131], a[216:219], v[48:51], v[128:131]
    ds_read_b128 v[56:59], v20 offset:2048
    v_add_u32 v22, 49152, v22
    v_mfma_f32_16x16x32_bf16 v[128:131], a[232:235], v[52:55], v[128:131]
    s_lshl_b32 s86, s15, 5
    ds_read_b128 v[60:63], v21 offset:2048
    v_add_u32 v23, 49152, v23
    v_mfma_f32_16x16x32_bf16 v[132:135], a[236:239], v[52:55], v[132:135]
    buffer_load_dwordx4 v28, s[44:47], s70 offen offset:2048 lds
    v_mfma_f32_16x16x32_bf16 v[132:135], a[220:223], v[48:51], v[132:135]
    s_mul_i32 s87, s3, 663552
    ds_read_b128 v[64:67], v20 offset:4096
    s_waitcnt lgkmcnt(7)
    v_mfma_f32_16x16x32_bf16 v[136:139], a[224:227], v[48:51], v[136:139]
    s_add_u32 s86, s86, s87
    ds_read_b128 v[68:71], v21 offset:4096
    v_add_u32 v24, 49152, v24
    v_mfma_f32_16x16x32_bf16 v[136:139], a[240:243], v[52:55], v[136:139]
    s_add_u32 s86, s86, 393216
    ds_read_b128 v[72:75], v20 offset:6144
    v_add_u32 v25, 49152, v25
    s_waitcnt lgkmcnt(5)
    v_mfma_f32_16x16x32_bf16 v[140:143], a[244:247], v[52:55], v[140:143]
    ds_read_b128 v[76:79], v21 offset:6144
    s_add_u32 s87, s86, 331776
    v_mfma_f32_16x16x32_bf16 v[140:143], a[228:231], v[48:51], v[140:143]
    buffer_load_dwordx4 v29, s[44:47], s70 offen offset:3072 lds
    v_smfmac_f32_16x16x64_bf16 v[120:123], v[44:47], a[216:223], v119
    ds_read_b128 v[80:83], v20 offset:8192
    s_add_u32 m0, s76, 102400
    v_smfmac_f32_16x16x64_bf16 v[124:127], v[44:47], a[224:231], v119
    ds_read_b128 v[84:87], v21 offset:8192
    v_lshrrev_b32_e64 v4, 1, v0
    s_waitcnt lgkmcnt(6)
    v_mfma_f32_16x16x32_bf16 v[144:147], a[216:219], v[56:59], v[144:147]
    ds_read_b128 v[88:91], v20 offset:10240
    v_mul_u32_u24 v4, 10336, v4
    v_mfma_f32_16x16x32_bf16 v[144:147], a[232:235], v[60:63], v[144:147]
    buffer_load_dwordx4 v26, s[44:47], s71 offen offset:0 lds
    v_mfma_f32_16x16x32_bf16 v[148:151], a[236:239], v[60:63], v[148:151]
    ds_read_b128 v[92:95], v21 offset:10240
    s_add_u32 s70, s70, 128
    v_mfma_f32_16x16x32_bf16 v[148:151], a[220:223], v[56:59], v[148:151]
    ds_read_b128 v[96:99], v20 offset:12288
    v_lshl_add_u32 v4, v0, 4, v4
    v_mfma_f32_16x16x32_bf16 v[152:155], a[224:227], v[56:59], v[152:155]
    ds_read_b128 v[100:103], v21 offset:12288
    v_add_u32_e64 v7, s33, v7
    v_mfma_f32_16x16x32_bf16 v[152:155], a[240:243], v[60:63], v[152:155]
    ds_read_b128 v[104:107], v20 offset:14336
    v_mfma_f32_16x16x32_bf16 v[156:159], a[244:247], v[60:63], v[156:159]
    buffer_load_dwordx4 v27, s[44:47], s71 offen offset:1024 lds
    v_mfma_f32_16x16x32_bf16 v[156:159], a[228:231], v[56:59], v[156:159]
    ds_read_b128 v[108:111], v21 offset:14336
    s_waitcnt lgkmcnt(8)
    v_mfma_f32_16x16x32_bf16 v[160:163], a[216:219], v[64:67], v[160:163]
    v_add_u32 v20, 49152, v20
    v_add_u32 v21, 49152, v21
    v_mfma_f32_16x16x32_bf16 v[160:163], a[232:235], v[68:71], v[160:163]
    ds_read_b64_tr_b16 a[0:1], v6
    v_mfma_f32_16x16x32_bf16 v[164:167], a[236:239], v[68:71], v[164:167]
    ds_read_b64_tr_b16 a[2:3], v6 offset:5120
    v_mfma_f32_16x16x32_bf16 v[164:167], a[220:223], v[64:67], v[164:167]
    buffer_load_dwordx4 v28, s[44:47], s71 offen offset:2048 lds
    v_mfma_f32_16x16x32_bf16 v[168:171], a[224:227], v[64:67], v[168:171]
    ds_read_b64_tr_b16 a[4:5], v6 offset:160
Lst_1098:
    s_cbranch_execz Lst_2807
    s_nop 0
    v_mfma_f32_16x16x32_bf16 v[168:171], a[240:243], v[68:71], v[168:171]
    ds_read_b64_tr_b16 a[6:7], v6 offset:5280
    v_mfma_f32_16x16x32_bf16 v[172:175], a[244:247], v[68:71], v[172:175]
    ds_read_b64_tr_b16 a[8:9], v7
    v_mfma_f32_16x16x32_bf16 v[172:175], a[228:231], v[64:67], v[172:175]
    ds_read_b64_tr_b16 a[10:11], v7 offset:5120
    s_and_b32 s32, s14, 3
    v_mfma_f32_16x16x32_bf16 v[176:179], a[216:219], v[72:75], v[176:179]
    buffer_load_dwordx4 v29, s[44:47], s71 offen offset:3072 lds
    v_mfma_f32_16x16x32_bf16 v[176:179], a[232:235], v[76:79], v[176:179]
    s_mul_i32 s32, s32, 108
    s_lshr_b32 s33, s14, 2
    s_add_u32 s32, s32, s33
    v_mfma_f32_16x16x32_bf16 v[180:183], a[236:239], v[76:79], v[180:183]
    s_mul_i32 s32, s32, 5120
    s_add_u32 s32, s32, 3047424
    s_mul_i32 s34, s3, 276480
    v_mfma_f32_16x16x32_bf16 v[180:183], a[220:223], v[72:75], v[180:183]
    s_add_u32 s34, s34, s32
    s_add_u32 s34, s34, 4096
    v_mfma_f32_16x16x32_bf16 v[184:187], a[224:227], v[72:75], v[184:187]
    s_cmp_lt_u32 s3, 2
    s_cselect_b32 s34, s34, 15040512
    s_lshl_b32 s33, s3, 10
    v_mfma_f32_16x16x32_bf16 v[184:187], a[240:243], v[76:79], v[184:187]
    s_add_u32 s32, s32, s33
    s_add_u32 s33, s32, 276480
    s_waitcnt lgkmcnt(0)
    v_mfma_f32_16x16x32_bf16 v[188:191], a[244:247], v[76:79], v[188:191]
    v_mfma_f32_16x16x32_bf16 v[188:191], a[228:231], v[72:75], v[188:191]
    v_mfma_f32_16x16x32_bf16 v[192:195], a[216:219], v[80:83], v[192:195]
    v_mfma_f32_16x16x32_bf16 v[192:195], a[232:235], v[84:87], v[192:195]
    v_mfma_f32_16x16x32_bf16 v[196:199], a[236:239], v[84:87], v[196:199]
    v_mfma_f32_16x16x32_bf16 v[196:199], a[220:223], v[80:83], v[196:199]
    v_mfma_f32_16x16x32_bf16 v[200:203], a[224:227], v[80:83], v[200:203]
    s_waitcnt vmcnt(12) lgkmcnt(0)
    v_mfma_f32_16x16x32_bf16 v[200:203], a[240:243], v[84:87], v[200:203]
    v_mfma_f32_16x16x32_bf16 v[204:207], a[244:247], v[84:87], v[204:207]
    s_barrier
    ds_read_b128 v[48:51], v20 offset:0
    v_mfma_f32_16x16x32_bf16 v[204:207], a[228:231], v[80:83], v[204:207]
    buffer_store_dwordx4 a[0:3], v1, s[56:59], s32 offen sc1
    v_mfma_f32_16x16x32_bf16 v[208:211], a[216:219], v[88:91], v[208:211]
    ds_read_b128 v[52:55], v21 offset:0
    v_mfma_f32_16x16x32_bf16 v[208:211], a[232:235], v[92:95], v[208:211]
    ds_read_b64_tr_b16 a[184:185], v22 offset:0
    v_mfma_f32_16x16x32_bf16 v[212:215], a[236:239], v[92:95], v[212:215]
    v_mfma_f32_16x16x32_bf16 v[212:215], a[220:223], v[88:91], v[212:215]
    ds_read_b64_tr_b16 a[186:187], v22 offset:512
    v_mfma_f32_16x16x32_bf16 v[216:219], a[224:227], v[88:91], v[216:219]
    ds_read_b64_tr_b16 a[200:201], v24 offset:0
    v_mfma_f32_16x16x32_bf16 v[216:219], a[240:243], v[92:95], v[216:219]
    ds_read_b64_tr_b16 a[202:203], v24 offset:512
    v_mfma_f32_16x16x32_bf16 v[220:223], a[244:247], v[92:95], v[220:223]
    ds_read_b64_tr_b16 a[188:189], v23 offset:0
    v_mfma_f32_16x16x32_bf16 v[220:223], a[228:231], v[88:91], v[220:223]
    ds_read_b64_tr_b16 a[190:191], v23 offset:512
    v_mfma_f32_16x16x32_bf16 v[224:227], a[216:219], v[96:99], v[224:227]
    buffer_store_dwordx4 a[4:7], v1, s[56:59], s33 offen sc1
    v_mfma_f32_16x16x32_bf16 v[224:227], a[232:235], v[100:103], v[224:227]
    ds_read_b64_tr_b16 a[204:205], v25 offset:0
    v_mfma_f32_16x16x32_bf16 v[228:231], a[236:239], v[100:103], v[228:231]
    ds_read_b64_tr_b16 a[206:207], v25 offset:512
    v_mfma_f32_16x16x32_bf16 v[228:231], a[220:223], v[96:99], v[228:231]
    ds_read_b64_tr_b16 a[192:193], v22 offset:2048
    v_mfma_f32_16x16x32_bf16 v[232:235], a[224:227], v[96:99], v[232:235]
    v_mfma_f32_16x16x32_bf16 v[232:235], a[240:243], v[100:103], v[232:235]
    ds_read_b64_tr_b16 a[194:195], v22 offset:2560
    v_mfma_f32_16x16x32_bf16 v[236:239], a[244:247], v[100:103], v[236:239]
    ds_read_b64_tr_b16 a[208:209], v24 offset:2048
    v_mfma_f32_16x16x32_bf16 v[236:239], a[228:231], v[96:99], v[236:239]
    ds_read_b64_tr_b16 a[210:211], v24 offset:2560
    v_mfma_f32_16x16x32_bf16 v[240:243], a[216:219], v[104:107], v[240:243]
    buffer_store_dwordx4 a[8:11], v1, s[56:59], s34 offen sc1
    v_mfma_f32_16x16x32_bf16 v[240:243], a[232:235], v[108:111], v[240:243]
    ds_read_b64_tr_b16 a[196:197], v23 offset:2048
    v_mfma_f32_16x16x32_bf16 v[244:247], a[236:239], v[108:111], v[244:247]
    ds_read_b64_tr_b16 a[198:199], v23 offset:2560
    s_lshr_b32 s32, s3, 1
    v_mfma_f32_16x16x32_bf16 v[244:247], a[220:223], v[104:107], v[244:247]
    ds_read_b64_tr_b16 a[212:213], v25 offset:2048
    s_lshl_b32 s32, s32, 4
    v_mfma_f32_16x16x32_bf16 v[248:251], a[224:227], v[104:107], v[248:251]
    s_lshr_b32 s78, s78, s32
    ds_read_b64_tr_b16 a[214:215], v25 offset:2560
    v_add_u32 v22, 49152, v22
    v_mfma_f32_16x16x32_bf16 v[248:251], a[240:243], v[108:111], v[248:251]
    s_lshl_b32 s78, s78, 16
    s_lshr_b32 s79, s79, s32
    s_lshl_b32 s79, s79, 16
    v_mfma_f32_16x16x32_bf16 v[252:255], a[244:247], v[108:111], v[252:255]
    s_add_u32 m0, s77, 0
    ds_read_b128 v[56:59], v20 offset:2048
    v_add_u32 v23, 49152, v23
    v_mfma_f32_16x16x32_bf16 v[252:255], a[228:231], v[104:107], v[252:255]
    s_mov_b32 s33, 0x3fb8aa3b
    ds_read_b128 v[60:63], v21 offset:2048
    s_waitcnt lgkmcnt(8)
    v_mfma_f32_16x16x32_bf16 v[128:131], a[184:187], v[48:51], v[128:131]
    ds_read_b128 v[64:67], v20 offset:4096
    v_add_u32 v24, 49152, v24
    v_mfma_f32_16x16x32_bf16 v[128:131], a[200:203], v[52:55], v[128:131]
    ds_read_b128 v[68:71], v21 offset:4096
    v_add_u32 v25, 49152, v25
    v_mfma_f32_16x16x32_bf16 v[132:135], a[204:207], v[52:55], v[132:135]
    buffer_load_dwordx4 v30, s[48:51], s72 offen lds
    v_mfma_f32_16x16x32_bf16 v[132:135], a[188:191], v[48:51], v[132:135]
    ds_read_b128 v[72:75], v20 offset:6144
    s_waitcnt lgkmcnt(8)
    v_mfma_f32_16x16x32_bf16 v[136:139], a[192:195], v[48:51], v[136:139]
    ds_read_b128 v[76:79], v21 offset:6144
    v_mov_b32_e64 v8, s78
    v_mfma_f32_16x16x32_bf16 v[136:139], a[208:211], v[52:55], v[136:139]
    ds_read_b128 v[80:83], v20 offset:8192
    v_lshlrev_b32 v13, 16, v36
    s_waitcnt lgkmcnt(7)
    v_mfma_f32_16x16x32_bf16 v[140:143], a[212:215], v[52:55], v[140:143]
    buffer_load_dwordx4 v31, s[48:51], s72 offen offset:1024 lds
    v_mfma_f32_16x16x32_bf16 v[140:143], a[196:199], v[48:51], v[140:143]
    ds_read_b128 v[84:87], v21 offset:8192
    v_and_b32_e64 v14, s6, v36
    v_smfmac_f32_16x16x64_bf16 v[120:123], v[44:47], a[184:191], v119
    ds_read_b128 v[88:91], v20 offset:10240
    v_mul_f32_e64 v8, s33, v8
    v_smfmac_f32_16x16x64_bf16 v[124:127], v[44:47], a[192:199], v119
    ds_read_b128 v[92:95], v21 offset:10240
    v_mul_f32 v13, s33, v13
    s_waitcnt lgkmcnt(8)
    v_mfma_f32_16x16x32_bf16 v[144:147], a[184:187], v[56:59], v[144:147]
    ds_read_b128 v[96:99], v20 offset:12288
    v_mul_f32_e64 v14, s33, v14
    v_mfma_f32_16x16x32_bf16 v[144:147], a[200:203], v[60:63], v[144:147]
    buffer_load_dwordx4 v30, s[52:55], s72 offen offset:2048 lds
    v_mfma_f32_16x16x32_bf16 v[148:151], a[204:207], v[60:63], v[148:151]
    ds_read_b128 v[100:103], v21 offset:12288
    v_mfma_f32_16x16x32_bf16 v[148:151], a[188:191], v[56:59], v[148:151]
    ds_read_b128 v[104:107], v20 offset:14336
    v_mfma_f32_16x16x32_bf16 v[152:155], a[192:195], v[56:59], v[152:155]
    ds_read_b128 v[108:111], v21 offset:14336
    v_add_u32 v20, 49152, v20
    v_mfma_f32_16x16x32_bf16 v[152:155], a[208:211], v[60:63], v[152:155]
    v_add_u32 v21, 49152, v21
    v_mfma_f32_16x16x32_bf16 v[156:159], a[212:215], v[60:63], v[156:159]
    buffer_load_dwordx4 v31, s[52:55], s72 offen offset:3072 lds
    v_mfma_f32_16x16x32_bf16 v[156:159], a[196:199], v[56:59], v[156:159]
    s_add_u32 m0, s76, 0
    s_waitcnt lgkmcnt(8)
    v_mfma_f32_16x16x32_bf16 v[160:163], a[184:187], v[64:67], v[160:163]
    s_and_b32 s10, s14, 3
    s_lshl_b32 s10, s10, 8
    s_and_b32 s9, s14, 0xfc
    v_mfma_f32_16x16x32_bf16 v[160:163], a[200:203], v[68:71], v[160:163]
    s_add_u32 s10, s10, s9
    s_lshl_b32 s10, s10, 5
    s_add_u32 s10, s10, 40960
    v_mfma_f32_16x16x32_bf16 v[164:167], a[204:207], v[68:71], v[164:167]
    s_cmp_eq_u32 s3, 0
    s_cselect_b32 s10, s10, 15040512
    v_mov_b32 v19, s7
    v_mfma_f32_16x16x32_bf16 v[164:167], a[188:191], v[64:67], v[164:167]
    buffer_load_dwordx4 v26, s[44:47], s70 offen offset:0 lds
    v_mfma_f32_16x16x32_bf16 v[168:171], a[192:195], v[64:67], v[168:171]
    s_add_u32 s72, s72, 221184
    v_exp_f32_e64 v8, v8
    v_mfma_f32_16x16x32_bf16 v[168:171], a[208:211], v[68:71], v[168:171]
    v_exp_f32_e64 v13, v13
    v_mfma_f32_16x16x32_bf16 v[172:175], a[212:215], v[68:71], v[172:175]
    v_exp_f32_e64 v14, v14
    v_mfma_f32_16x16x32_bf16 v[172:175], a[196:199], v[64:67], v[172:175]
    buffer_load_dwordx4 v27, s[44:47], s70 offen offset:1024 lds
    v_mfma_f32_16x16x32_bf16 v[176:179], a[184:187], v[72:75], v[176:179]
    s_add_u32 s71, s70, 40960
    v_lshlrev_b32 v15, 16, v37
    v_and_b32 v16, s6, v37
    v_mfma_f32_16x16x32_bf16 v[176:179], a[200:203], v[76:79], v[176:179]
    v_cvt_pk_bf16_f32 v8, v8, v8
    v_cvt_pk_bf16_f32 v14, v13, v14
    v_mfma_f32_16x16x32_bf16 v[180:183], a[204:207], v[76:79], v[180:183]
    v_lshlrev_b32 v8, 16, v8
    v_lshlrev_b32 v13, 16, v14
    v_mfma_f32_16x16x32_bf16 v[180:183], a[188:191], v[72:75], v[180:183]
    v_and_b32 v14, s6, v14
    v_mul_f32 v15, v15, v8
    v_mfma_f32_16x16x32_bf16 v[184:187], a[192:195], v[72:75], v[184:187]
    buffer_load_dwordx4 v28, s[44:47], s70 offen offset:2048 lds
    v_mfma_f32_16x16x32_bf16 v[184:187], a[208:211], v[76:79], v[184:187]
    v_mul_f32 v16, v16, v8
    v_mul_f32 v13, v13, v8
    v_mfma_f32_16x16x32_bf16 v[188:191], a[212:215], v[76:79], v[188:191]
    v_mul_f32 v14, v14, v8
    v_mul_f32 v15, 0.15915494, v15
    v_mfma_f32_16x16x32_bf16 v[188:191], a[196:199], v[72:75], v[188:191]
    v_mul_f32 v16, 0.15915494, v16
    s_waitcnt lgkmcnt(6)
    v_mfma_f32_16x16x32_bf16 v[192:195], a[184:187], v[80:83], v[192:195]
    v_mul_f32 v13, s33, v13
    v_mul_f32 v14, s33, v14
    v_mfma_f32_16x16x32_bf16 v[192:195], a[200:203], v[84:87], v[192:195]
    buffer_load_dwordx4 v29, s[44:47], s70 offen offset:3072 lds
    v_mfma_f32_16x16x32_bf16 v[196:199], a[204:207], v[84:87], v[196:199]
    s_waitcnt vmcnt(11) lgkmcnt(0)
    s_add_u32 m0, s76, 4096
    v_add_f32 v8, v8, v8
    v_mfma_f32_16x16x32_bf16 v[196:199], a[188:191], v[80:83], v[196:199]
    s_waitcnt vmcnt(8)
    v_lshlrev_b32 v40, 16, v38
    v_and_b32_e64 v41, s6, v38
    v_mfma_f32_16x16x32_bf16 v[200:203], a[192:195], v[80:83], v[200:203]
    s_barrier
    ds_read_b128 v[48:51], v20 offset:0
    v_lshlrev_b32 v42, 16, v39
    v_mfma_f32_16x16x32_bf16 v[200:203], a[208:211], v[84:87], v[200:203]
    buffer_load_dwordx4 v26, s[44:47], s71 offen offset:0 lds
    s_mov_b64 exec, 1
    buffer_store_dword v19, off, s[56:59], s10 sc1
    s_mov_b64 exec, -1
    v_mfma_f32_16x16x32_bf16 v[204:207], a[212:215], v[84:87], v[204:207]
    ds_read_b128 v[52:55], v21 offset:0
    s_add_u32 s70, s70, 128
    v_mfma_f32_16x16x32_bf16 v[204:207], a[196:199], v[80:83], v[204:207]
    ds_read_b64_tr_b16 a[216:217], v22 offset:0
    v_and_b32_e64 v43, s6, v39
    v_mfma_f32_16x16x32_bf16 v[208:211], a[184:187], v[88:91], v[208:211]
    s_bitcmp1_b32 s3, 0
    s_cselect_b32 s32, 1.0, 0x41000000
    ds_read_b64_tr_b16 a[218:219], v22 offset:512
    v_mfma_f32_16x16x32_bf16 v[208:211], a[200:203], v[92:95], v[208:211]
    ds_read_b64_tr_b16 a[232:233], v24 offset:0
    s_mov_b32 s33, 0x43800000
    v_mfma_f32_16x16x32_bf16 v[212:215], a[204:207], v[92:95], v[212:215]
    buffer_load_dwordx4 v27, s[44:47], s71 offen offset:1024 lds
    v_mfma_f32_16x16x32_bf16 v[212:215], a[188:191], v[88:91], v[212:215]
    ds_read_b64_tr_b16 a[234:235], v24 offset:512
    v_mul_f32 v40, v40, v8
    v_mfma_f32_16x16x32_bf16 v[216:219], a[192:195], v[88:91], v[216:219]
    ds_read_b64_tr_b16 a[220:221], v23 offset:0
    v_mul_f32_e64 v41, v41, v8
    v_mfma_f32_16x16x32_bf16 v[216:219], a[208:211], v[92:95], v[216:219]
    ds_read_b64_tr_b16 a[222:223], v23 offset:512
    v_mul_f32_e64 v42, v42, v8
    v_mfma_f32_16x16x32_bf16 v[220:223], a[212:215], v[92:95], v[220:223]
    ds_read_b64_tr_b16 a[236:237], v25 offset:0
    v_mul_f32_e64 v43, v43, v8
    v_mfma_f32_16x16x32_bf16 v[220:223], a[196:199], v[88:91], v[220:223]
    ds_read_b64_tr_b16 a[238:239], v25 offset:512
    v_mfma_f32_16x16x32_bf16 v[224:227], a[184:187], v[96:99], v[224:227]
    buffer_load_dwordx4 v28, s[44:47], s71 offen offset:2048 lds
    v_mfma_f32_16x16x32_bf16 v[224:227], a[200:203], v[100:103], v[224:227]
    ds_read_b64_tr_b16 a[224:225], v22 offset:2048
    v_mul_f32_e64 v6, s32, v13
    v_mfma_f32_16x16x32_bf16 v[228:231], a[204:207], v[100:103], v[228:231]
    ds_read_b64_tr_b16 a[226:227], v22 offset:2560
    v_mul_f32_e64 v7, s32, v14
    v_mfma_f32_16x16x32_bf16 v[228:231], a[188:191], v[96:99], v[228:231]
    buffer_load_dwordx4 v29, s[44:47], s71 offen offset:3072 lds
    v_mfma_f32_16x16x32_bf16 v[232:235], a[192:195], v[96:99], v[232:235]
    ds_read_b64_tr_b16 a[240:241], v24 offset:2048
    s_add_u32 m0, s77, 49152
    v_mfma_f32_16x16x32_bf16 v[232:235], a[208:211], v[100:103], v[232:235]
    ds_read_b64_tr_b16 a[242:243], v24 offset:2560
    v_mul_f32_e64 v34, s32, v15
    v_mfma_f32_16x16x32_bf16 v[236:239], a[212:215], v[100:103], v[236:239]
    ds_read_b64_tr_b16 a[228:229], v23 offset:2048
    v_mul_f32_e64 v35, s32, v16
    v_mfma_f32_16x16x32_bf16 v[236:239], a[196:199], v[96:99], v[236:239]
    ds_read_b64_tr_b16 a[230:231], v23 offset:2560
    v_mfma_f32_16x16x32_bf16 v[240:243], a[184:187], v[104:107], v[240:243]
    buffer_load_dwordx4 v30, s[48:51], s72 offen lds
    v_mfma_f32_16x16x32_bf16 v[240:243], a[200:203], v[108:111], v[240:243]
    ds_read_b64_tr_b16 a[244:245], v25 offset:2048
    v_mfma_f32_16x16x32_bf16 v[244:247], a[204:207], v[108:111], v[244:247]
    ds_read_b64_tr_b16 a[246:247], v25 offset:2560
    v_subrev_u32 v22, 98304, v22
    v_mfma_f32_16x16x32_bf16 v[244:247], a[188:191], v[104:107], v[244:247]
    ds_read_b128 v[56:59], v20 offset:2048
    v_subrev_u32 v23, 98304, v23
    v_mfma_f32_16x16x32_bf16 v[248:251], a[192:195], v[104:107], v[248:251]
    ds_read_b128 v[60:63], v21 offset:2048
    v_subrev_u32 v24, 98304, v24
    v_mfma_f32_16x16x32_bf16 v[248:251], a[208:211], v[108:111], v[248:251]
    buffer_load_dwordx4 v31, s[48:51], s72 offen offset:1024 lds
    v_mfma_f32_16x16x32_bf16 v[252:255], a[212:215], v[108:111], v[252:255]
    ds_read_b128 v[64:67], v20 offset:4096
    v_subrev_u32 v25, 98304, v25
    v_mfma_f32_16x16x32_bf16 v[252:255], a[196:199], v[104:107], v[252:255]
    ds_read_b128 v[68:71], v21 offset:4096
    s_waitcnt lgkmcnt(8)
    v_mfma_f32_16x16x32_bf16 v[128:131], a[216:219], v[48:51], v[128:131]
    ds_read_b128 v[72:75], v20 offset:6144
    v_mfma_f32_16x16x32_bf16 v[128:131], a[232:235], v[52:55], v[128:131]
    ds_read_b128 v[76:79], v21 offset:6144
    v_mfma_f32_16x16x32_bf16 v[132:135], a[236:239], v[52:55], v[132:135]
    buffer_load_dwordx4 v30, s[52:55], s72 offen offset:2048 lds
    v_mfma_f32_16x16x32_bf16 v[132:135], a[220:223], v[48:51], v[132:135]
    ds_read_b128 v[80:83], v20 offset:8192
    v_mfma_f32_16x16x32_bf16 v[136:139], a[224:227], v[48:51], v[136:139]
    ds_read_b128 v[84:87], v21 offset:8192
    v_mfma_f32_16x16x32_bf16 v[136:139], a[240:243], v[52:55], v[136:139]
    ds_read_b128 v[88:91], v20 offset:10240
    s_waitcnt lgkmcnt(8)
    v_mfma_f32_16x16x32_bf16 v[140:143], a[244:247], v[52:55], v[140:143]
    buffer_load_dwordx4 v31, s[52:55], s72 offen offset:3072 lds
    v_mfma_f32_16x16x32_bf16 v[140:143], a[228:231], v[48:51], v[140:143]
    ds_read_b128 v[92:95], v21 offset:10240
    s_add_u32 m0, s76, 49152
    v_smfmac_f32_16x16x64_bf16 v[120:123], v[44:47], a[216:223], v119
    ds_read_b128 v[96:99], v20 offset:12288
    v_smfmac_f32_16x16x64_bf16 v[124:127], v[44:47], a[224:231], v119
    ds_read_b128 v[100:103], v21 offset:12288
    s_waitcnt lgkmcnt(8)
    v_mfma_f32_16x16x32_bf16 v[144:147], a[216:219], v[56:59], v[144:147]
    ds_read_b128 v[104:107], v20 offset:14336
    v_mfma_f32_16x16x32_bf16 v[144:147], a[232:235], v[60:63], v[144:147]
    buffer_load_dwordx4 v26, s[44:47], s70 offen offset:0 lds
    v_mfma_f32_16x16x32_bf16 v[148:151], a[236:239], v[60:63], v[148:151]
    s_add_u32 s72, s72, 221184
    ds_read_b128 v[108:111], v21 offset:14336
    v_subrev_u32 v20, 98304, v20
    v_mfma_f32_16x16x32_bf16 v[148:151], a[220:223], v[56:59], v[148:151]
    v_subrev_u32 v21, 98304, v21
    v_mfma_f32_16x16x32_bf16 v[152:155], a[224:227], v[56:59], v[152:155]
    v_exp_f32_e64 v6, -v6
    v_mfma_f32_16x16x32_bf16 v[152:155], a[240:243], v[60:63], v[152:155]
    v_exp_f32_e64 v7, -v7
    v_mfma_f32_16x16x32_bf16 v[156:159], a[244:247], v[60:63], v[156:159]
    buffer_load_dwordx4 v27, s[44:47], s70 offen offset:1024 lds
    v_mfma_f32_16x16x32_bf16 v[156:159], a[228:231], v[56:59], v[156:159]
    s_add_u32 s71, s70, 40960
    v_fract_f32 v34, v34
    v_mfma_f32_16x16x32_bf16 v[160:163], a[216:219], v[64:67], v[160:163]
    v_fract_f32_e64 v35, v35
    v_mfma_f32_16x16x32_bf16 v[160:163], a[232:235], v[68:71], v[160:163]
    v_cos_f32_e64 v32, v34
    v_mfma_f32_16x16x32_bf16 v[164:167], a[236:239], v[68:71], v[164:167]
    buffer_load_dwordx4 v28, s[44:47], s70 offen offset:2048 lds
    v_mfma_f32_16x16x32_bf16 v[164:167], a[220:223], v[64:67], v[164:167]
    v_cos_f32_e64 v33, v35
    v_mfma_f32_16x16x32_bf16 v[168:171], a[224:227], v[64:67], v[168:171]
    v_sin_f32_e64 v34, v34
    v_mfma_f32_16x16x32_bf16 v[168:171], a[240:243], v[68:71], v[168:171]
    v_sin_f32_e64 v35, v35
    v_mfma_f32_16x16x32_bf16 v[172:175], a[244:247], v[68:71], v[172:175]
    v_mul_f32 v32, v32, v6
    v_mul_f32 v33, v33, v7
    v_mfma_f32_16x16x32_bf16 v[172:175], a[228:231], v[64:67], v[172:175]
    buffer_load_dwordx4 v29, s[44:47], s70 offen offset:3072 lds
    s_waitcnt lgkmcnt(8)
    v_mfma_f32_16x16x32_bf16 v[176:179], a[216:219], v[72:75], v[176:179]
    s_add_u32 m0, s76, 53248
    v_mul_f32 v34, v34, v6
    v_mul_f32_e64 v35, v35, v7
    v_mfma_f32_16x16x32_bf16 v[176:179], a[232:235], v[76:79], v[176:179]
    v_mul_f32 v6, s33, v13
    v_mul_f32 v7, s33, v14
    v_mfma_f32_16x16x32_bf16 v[180:183], a[236:239], v[76:79], v[180:183]
    v_mul_f32 v38, s33, v15
    v_mul_f32 v39, s33, v16
    v_mfma_f32_16x16x32_bf16 v[180:183], a[220:223], v[72:75], v[180:183]
    v_exp_f32_e64 v6, -v6
    v_mfma_f32_16x16x32_bf16 v[184:187], a[224:227], v[72:75], v[184:187]
    buffer_load_dwordx4 v26, s[44:47], s71 offen offset:0 lds
    v_mfma_f32_16x16x32_bf16 v[184:187], a[240:243], v[76:79], v[184:187]
    s_add_u32 s70, s70, 128
    v_exp_f32_e64 v7, -v7
    v_mfma_f32_16x16x32_bf16 v[188:191], a[244:247], v[76:79], v[188:191]
    v_fract_f32 v38, v38
    v_fract_f32 v39, v39
    v_mfma_f32_16x16x32_bf16 v[188:191], a[228:231], v[72:75], v[188:191]
    s_waitcnt lgkmcnt(6)
    v_mfma_f32_16x16x32_bf16 v[192:195], a[216:219], v[80:83], v[192:195]
    s_waitcnt vmcnt(9) lgkmcnt(0)
    v_cos_f32_e64 v36, v38
    v_mfma_f32_16x16x32_bf16 v[192:195], a[232:235], v[84:87], v[192:195]
    buffer_load_dwordx4 v27, s[44:47], s71 offen offset:1024 lds
    v_mfma_f32_16x16x32_bf16 v[196:199], a[236:239], v[84:87], v[196:199]
    s_barrier
    ds_read_b128 v[48:51], v20 offset:0
    v_mfma_f32_16x16x32_bf16 v[196:199], a[220:223], v[80:83], v[196:199]
    ds_read_b128 v[52:55], v21 offset:0
    v_mfma_f32_16x16x32_bf16 v[200:203], a[224:227], v[80:83], v[200:203]
    ds_read_b64_tr_b16 a[184:185], v22 offset:0
    v_mfma_f32_16x16x32_bf16 v[200:203], a[240:243], v[84:87], v[200:203]
    buffer_load_dwordx4 v28, s[44:47], s71 offen offset:2048 lds
    v_mfma_f32_16x16x32_bf16 v[204:207], a[244:247], v[84:87], v[204:207]
    ds_read_b64_tr_b16 a[186:187], v22 offset:512
    v_mfma_f32_16x16x32_bf16 v[204:207], a[228:231], v[80:83], v[204:207]
    ds_read_b64_tr_b16 a[200:201], v24 offset:0
    v_mfma_f32_16x16x32_bf16 v[208:211], a[216:219], v[88:91], v[208:211]
    ds_read_b64_tr_b16 a[202:203], v24 offset:512
    v_mfma_f32_16x16x32_bf16 v[208:211], a[232:235], v[92:95], v[208:211]
    ds_read_b64_tr_b16 a[188:189], v23 offset:0
    v_mfma_f32_16x16x32_bf16 v[212:215], a[236:239], v[92:95], v[212:215]
    buffer_load_dwordx4 v29, s[44:47], s71 offen offset:3072 lds
    v_mfma_f32_16x16x32_bf16 v[212:215], a[220:223], v[88:91], v[212:215]
    ds_read_b64_tr_b16 a[190:191], v23 offset:512
    s_add_u32 m0, s77, 98304
    v_mfma_f32_16x16x32_bf16 v[216:219], a[224:227], v[88:91], v[216:219]
    ds_read_b64_tr_b16 a[204:205], v25 offset:0
    v_mfma_f32_16x16x32_bf16 v[216:219], a[240:243], v[92:95], v[216:219]
    ds_read_b64_tr_b16 a[206:207], v25 offset:512
    v_mfma_f32_16x16x32_bf16 v[220:223], a[244:247], v[92:95], v[220:223]
    ds_read_b64_tr_b16 a[192:193], v22 offset:2048
    v_mfma_f32_16x16x32_bf16 v[220:223], a[228:231], v[88:91], v[220:223]
    ds_read_b64_tr_b16 a[194:195], v22 offset:2560
    v_mfma_f32_16x16x32_bf16 v[224:227], a[216:219], v[96:99], v[224:227]
    buffer_load_dwordx4 v30, s[48:51], s72 offen lds
    v_mfma_f32_16x16x32_bf16 v[224:227], a[232:235], v[100:103], v[224:227]
    ds_read_b64_tr_b16 a[208:209], v24 offset:2048
    v_mfma_f32_16x16x32_bf16 v[228:231], a[236:239], v[100:103], v[228:231]
    ds_read_b64_tr_b16 a[210:211], v24 offset:2560
    v_mfma_f32_16x16x32_bf16 v[228:231], a[220:223], v[96:99], v[228:231]
    buffer_load_dwordx4 v31, s[48:51], s72 offen offset:1024 lds
    v_mfma_f32_16x16x32_bf16 v[232:235], a[224:227], v[96:99], v[232:235]
    ds_read_b64_tr_b16 a[196:197], v23 offset:2048
    v_mfma_f32_16x16x32_bf16 v[232:235], a[240:243], v[100:103], v[232:235]
    ds_read_b64_tr_b16 a[198:199], v23 offset:2560
    v_mfma_f32_16x16x32_bf16 v[236:239], a[244:247], v[100:103], v[236:239]
    ds_read_b64_tr_b16 a[212:213], v25 offset:2048
    v_mfma_f32_16x16x32_bf16 v[236:239], a[228:231], v[96:99], v[236:239]
    ds_read_b64_tr_b16 a[214:215], v25 offset:2560
    v_add_u32 v22, 49152, v22
    v_mfma_f32_16x16x32_bf16 v[240:243], a[216:219], v[104:107], v[240:243]
    buffer_load_dwordx4 v30, s[52:55], s72 offen offset:2048 lds
    v_mfma_f32_16x16x32_bf16 v[240:243], a[232:235], v[108:111], v[240:243]
    ds_read_b128 v[56:59], v20 offset:2048
    v_add_u32 v23, 49152, v23
    v_mfma_f32_16x16x32_bf16 v[244:247], a[236:239], v[108:111], v[244:247]
    ds_read_b128 v[60:63], v21 offset:2048
    v_add_u32 v24, 49152, v24
    v_mfma_f32_16x16x32_bf16 v[244:247], a[220:223], v[104:107], v[244:247]
    ds_read_b128 v[64:67], v20 offset:4096
    v_add_u32 v25, 49152, v25
    v_mfma_f32_16x16x32_bf16 v[248:251], a[224:227], v[104:107], v[248:251]
    ds_read_b128 v[68:71], v21 offset:4096
    v_mfma_f32_16x16x32_bf16 v[248:251], a[240:243], v[108:111], v[248:251]
    buffer_load_dwordx4 v31, s[52:55], s72 offen offset:3072 lds
    v_mfma_f32_16x16x32_bf16 v[252:255], a[244:247], v[108:111], v[252:255]
    ds_read_b128 v[72:75], v20 offset:6144
    s_add_u32 m0, s76, 98304
    v_mfma_f32_16x16x32_bf16 v[252:255], a[228:231], v[104:107], v[252:255]
    ds_read_b128 v[76:79], v21 offset:6144
    s_waitcnt lgkmcnt(8)
    v_mfma_f32_16x16x32_bf16 v[128:131], a[184:187], v[48:51], v[128:131]
    ds_read_b128 v[80:83], v20 offset:8192
    v_mfma_f32_16x16x32_bf16 v[128:131], a[200:203], v[52:55], v[128:131]
    buffer_load_dwordx4 v26, s[44:47], s70 offen offset:0 lds
    v_mfma_f32_16x16x32_bf16 v[132:135], a[204:207], v[52:55], v[132:135]
    ds_read_b128 v[84:87], v21 offset:8192
    s_add_u32 s72, s72, 221184
    v_mfma_f32_16x16x32_bf16 v[132:135], a[188:191], v[48:51], v[132:135]
    ds_read_b128 v[88:91], v20 offset:10240
    v_mfma_f32_16x16x32_bf16 v[136:139], a[192:195], v[48:51], v[136:139]
    ds_read_b128 v[92:95], v21 offset:10240
    v_mfma_f32_16x16x32_bf16 v[136:139], a[208:211], v[52:55], v[136:139]
    ds_read_b128 v[96:99], v20 offset:12288
    s_waitcnt lgkmcnt(8)
    v_mfma_f32_16x16x32_bf16 v[140:143], a[212:215], v[52:55], v[140:143]
    buffer_load_dwordx4 v27, s[44:47], s70 offen offset:1024 lds
    v_mfma_f32_16x16x32_bf16 v[140:143], a[196:199], v[48:51], v[140:143]
    ds_read_b128 v[100:103], v21 offset:12288
    s_add_u32 s71, s70, 40960
    v_smfmac_f32_16x16x64_bf16 v[120:123], v[44:47], a[184:191], v119
    ds_read_b128 v[104:107], v20 offset:14336
    v_smfmac_f32_16x16x64_bf16 v[124:127], v[44:47], a[192:199], v119
    ds_read_b128 v[108:111], v21 offset:14336
    v_add_u32 v20, 49152, v20
    v_mfma_f32_16x16x32_bf16 v[144:147], a[184:187], v[56:59], v[144:147]
    v_add_u32 v21, 49152, v21
    s_lshr_b32 s10, s29, 10
    v_mfma_f32_16x16x32_bf16 v[144:147], a[200:203], v[60:63], v[144:147]
    buffer_load_dwordx4 v28, s[44:47], s70 offen offset:2048 lds
    v_mfma_f32_16x16x32_bf16 v[148:151], a[204:207], v[60:63], v[148:151]
    v_min_u32_e64 v19, 12, v0
    v_writelane_b32 v19, s10, 62
    v_mfma_f32_16x16x32_bf16 v[148:151], a[188:191], v[56:59], v[148:151]
    s_lshr_b32 s10, s81, 1
    s_lshl_b32 s10, s10, 6
    s_add_u32 s10, s10, s82
    v_mfma_f32_16x16x32_bf16 v[152:155], a[192:195], v[56:59], v[152:155]
    s_lshl_b32 s10, s10, 7
    s_add_u32 s10, s10, 40960
    v_lshl_add_u32 v19, v19, 7, s10
    v_mfma_f32_16x16x32_bf16 v[152:155], a[208:211], v[60:63], v[152:155]
    buffer_load_dwordx4 v29, s[44:47], s70 offen offset:3072 lds
    v_mfma_f32_16x16x32_bf16 v[156:159], a[212:215], v[60:63], v[156:159]
    s_add_u32 m0, s76, 102400
    s_lshl_b32 s10, s4, 7
    s_add_u32 s10, s10, 4096
    v_mfma_f32_16x16x32_bf16 v[156:159], a[196:199], v[56:59], v[156:159]
    v_writelane_b32 v19, s10, 63
    s_waitcnt lgkmcnt(8)
    v_mfma_f32_16x16x32_bf16 v[160:163], a[184:187], v[64:67], v[160:163]
    buffer_load_dword v18, v19, s[56:59], 0 offen sc1
    v_mfma_f32_16x16x32_bf16 v[160:163], a[200:203], v[68:71], v[160:163]
    v_cos_f32_e64 v37, v39
    v_mfma_f32_16x16x32_bf16 v[164:167], a[204:207], v[68:71], v[164:167]
    buffer_load_dwordx4 v26, s[44:47], s71 offen offset:0 lds
    v_mfma_f32_16x16x32_bf16 v[164:167], a[188:191], v[64:67], v[164:167]
    s_add_u32 s70, s70, 128
    v_sin_f32_e64 v38, v38
    v_mfma_f32_16x16x32_bf16 v[168:171], a[192:195], v[64:67], v[168:171]
    v_sin_f32_e64 v39, v39
    v_mfma_f32_16x16x32_bf16 v[168:171], a[208:211], v[68:71], v[168:171]
    v_mul_f32 v36, v36, v6
    v_mul_f32 v37, v37, v7
    v_mfma_f32_16x16x32_bf16 v[172:175], a[212:215], v[68:71], v[172:175]
    v_mul_f32 v38, v38, v6
    v_mul_f32 v39, v39, v7
    v_mfma_f32_16x16x32_bf16 v[172:175], a[196:199], v[64:67], v[172:175]
    buffer_load_dwordx4 v27, s[44:47], s71 offen offset:1024 lds
    v_mfma_f32_16x16x32_bf16 v[176:179], a[184:187], v[72:75], v[176:179]
    s_lshr_b32 s32, s3, 1
    s_and_b32 s33, s3, 1
    s_mul_i32 s34, s32, 9216
    v_mfma_f32_16x16x32_bf16 v[176:179], a[200:203], v[76:79], v[176:179]
    s_add_u32 s34, s34, 49152
    v_lshrrev_b32_e64 v6, 4, v0
    s_mul_i32 s35, s32, 4160
    v_mfma_f32_16x16x32_bf16 v[180:183], a[204:207], v[76:79], v[180:183]
    s_add_u32 s35, s35, 67584
    v_lshl_add_u32 v7, v6, 4, s35
    s_mul_i32 s35, s32, 8224
    v_mfma_f32_16x16x32_bf16 v[180:183], a[188:191], v[72:75], v[180:183]
    s_add_u32 s35, s35, 75904
    v_mov_b32_e64 v8, s35
    v_cmp_lt_u32 s[36:37], 31, v0
    v_mfma_f32_16x16x32_bf16 v[184:187], a[192:195], v[72:75], v[184:187]
    buffer_load_dwordx4 v28, s[44:47], s71 offen offset:2048 lds
    v_mfma_f32_16x16x32_bf16 v[184:187], a[208:211], v[76:79], v[184:187]
    v_mul_u32_u24 v6, 2048, v6
    v_lshl_add_u32 v6, v0, 4, v6
    v_mfma_f32_16x16x32_bf16 v[188:191], a[212:215], v[76:79], v[188:191]
    s_waitcnt vmcnt(12) lgkmcnt(0)
    v_cndmask_b32 v7, v7, v8, s[36:37]
    v_and_b32 v8, 15, v0
    v_mfma_f32_16x16x32_bf16 v[188:191], a[196:199], v[72:75], v[188:191]
    v_cmp_eq_u32 s[36:37], 15, v8
    v_mfma_f32_16x16x32_bf16 v[192:195], a[184:187], v[80:83], v[192:195]
    s_barrier
    ds_read_b128 v[48:51], v20 offset:0
    v_add_u32 v6, s34, v6
    v_mfma_f32_16x16x32_bf16 v[192:195], a[200:203], v[84:87], v[192:195]
    buffer_load_dwordx4 v29, s[44:47], s71 offen offset:3072 lds
    v_mfma_f32_16x16x32_bf16 v[196:199], a[204:207], v[84:87], v[196:199]
    ds_read_b128 v[52:55], v21 offset:0
    s_add_u32 m0, s77, 0
    v_mfma_f32_16x16x32_bf16 v[196:199], a[188:191], v[80:83], v[196:199]
    ds_read_b64_tr_b16 a[216:217], v22 offset:0
    v_mov_b32 v10, 0
    v_mfma_f32_16x16x32_bf16 v[200:203], a[192:195], v[80:83], v[200:203]
    ds_read_b64_tr_b16 a[218:219], v22 offset:512
    v_mov_b32_e64 v11, 0
    v_mfma_f32_16x16x32_bf16 v[200:203], a[208:211], v[84:87], v[200:203]
    buffer_load_dwordx4 v30, s[48:51], s72 offen lds
    v_mfma_f32_16x16x32_bf16 v[204:207], a[212:215], v[84:87], v[204:207]
    ds_read_b64_tr_b16 a[232:233], v24 offset:0
    v_cndmask_b32 v6, v6, v7, s[36:37]
Lst_1657:
    s_cbranch_execz Lst_3032
    s_nop 0
    v_mfma_f32_16x16x32_bf16 v[204:207], a[196:199], v[80:83], v[204:207]
    ds_read_b64_tr_b16 a[234:235], v24 offset:512
    s_lshl_b32 s35, s33, 3
    v_mfma_f32_16x16x32_bf16 v[208:211], a[184:187], v[88:91], v[208:211]
    ds_read_b64_tr_b16 a[220:221], v23 offset:0
    s_sub_u32 s34, s34, s35
    v_mfma_f32_16x16x32_bf16 v[208:211], a[200:203], v[92:95], v[208:211]
    ds_read_b64_tr_b16 a[222:223], v23 offset:512
    v_add_u32_e64 v6, s35, v6
    v_mfma_f32_16x16x32_bf16 v[212:215], a[204:207], v[92:95], v[212:215]
    buffer_load_dwordx4 v31, s[48:51], s72 offen offset:1024 lds
    v_mfma_f32_16x16x32_bf16 v[212:215], a[188:191], v[88:91], v[212:215]
    ds_read_b64_tr_b16 a[236:237], v25 offset:0
    s_add_u32 s34, s34, 240
    v_mfma_f32_16x16x32_bf16 v[216:219], a[192:195], v[88:91], v[216:219]
    ds_read_b64_tr_b16 a[238:239], v25 offset:512
    v_bfe_u32 v7, v0, 1, 4
    v_mfma_f32_16x16x32_bf16 v[216:219], a[208:211], v[92:95], v[216:219]
    ds_read_b64_tr_b16 a[224:225], v22 offset:2048
    v_lshl_add_u32 v7, v7, 4, s34
    v_mfma_f32_16x16x32_bf16 v[220:223], a[212:215], v[92:95], v[220:223]
    buffer_load_dwordx4 v30, s[52:55], s72 offen offset:2048 lds
    v_mfma_f32_16x16x32_bf16 v[220:223], a[196:199], v[88:91], v[220:223]
    ds_read_b64_tr_b16 a[226:227], v22 offset:2560
    v_mfma_f32_16x16x32_bf16 v[224:227], a[184:187], v[96:99], v[224:227]
    ds_read_b64_tr_b16 a[240:241], v24 offset:2048
    v_and_b32_e64 v12, 1, v0
    v_mfma_f32_16x16x32_bf16 v[224:227], a[200:203], v[100:103], v[224:227]
    ds_read_b64_tr_b16 a[242:243], v24 offset:2560
    v_lshl_add_u32 v7, v12, 2, v7
    v_mfma_f32_16x16x32_bf16 v[228:231], a[204:207], v[100:103], v[228:231]
    ds_read_b64_tr_b16 a[228:229], v23 offset:2048
    v_lshrrev_b32_e64 v9, 5, v0
    v_mfma_f32_16x16x32_bf16 v[228:231], a[188:191], v[96:99], v[228:231]
    buffer_load_dwordx4 v31, s[52:55], s72 offen offset:3072 lds
    v_mfma_f32_16x16x32_bf16 v[232:235], a[192:195], v[96:99], v[232:235]
    ds_read_b64_tr_b16 a[230:231], v23 offset:2560
    s_add_u32 m0, s76, 0
    v_mfma_f32_16x16x32_bf16 v[232:235], a[208:211], v[100:103], v[232:235]
    ds_read_b64_tr_b16 a[244:245], v25 offset:2048
    v_lshl_add_u32 v8, v9, 9, v7
    v_mfma_f32_16x16x32_bf16 v[236:239], a[212:215], v[100:103], v[236:239]
    ds_read_b64_tr_b16 a[246:247], v25 offset:2560
    v_add_u32 v22, 49152, v22
    v_mfma_f32_16x16x32_bf16 v[236:239], a[196:199], v[96:99], v[236:239]
    ds_read_b128 v[56:59], v20 offset:2048
    v_add_u32 v23, 49152, v23
    v_mfma_f32_16x16x32_bf16 v[240:243], a[184:187], v[104:107], v[240:243]
    buffer_load_dwordx4 v26, s[44:47], s70 offen offset:0 lds
    v_mfma_f32_16x16x32_bf16 v[240:243], a[200:203], v[108:111], v[240:243]
    s_add_u32 s72, s72, 221184
    ds_read_b128 v[60:63], v21 offset:2048
    v_add_u32 v24, 49152, v24
    v_mfma_f32_16x16x32_bf16 v[244:247], a[204:207], v[108:111], v[244:247]
    ds_read_b128 v[64:67], v20 offset:4096
    v_add_u32 v25, 49152, v25
    v_mfma_f32_16x16x32_bf16 v[244:247], a[188:191], v[104:107], v[244:247]
    ds_read_b128 v[68:71], v21 offset:4096
    v_lshl_add_u32 v7, v9, 8, v7
    v_mfma_f32_16x16x32_bf16 v[248:251], a[192:195], v[104:107], v[248:251]
    buffer_load_dwordx4 v27, s[44:47], s70 offen offset:1024 lds
    v_mfma_f32_16x16x32_bf16 v[248:251], a[208:211], v[108:111], v[248:251]
    s_lshl_b32 s32, s3, 10
    ds_read_b128 v[72:75], v20 offset:6144
    s_add_u32 s71, s70, 40960
    v_mfma_f32_16x16x32_bf16 v[252:255], a[212:215], v[108:111], v[252:255]
    ds_read_b128 v[76:79], v21 offset:6144
    s_add_u32 s32, s32, 67616
    v_mfma_f32_16x16x32_bf16 v[252:255], a[196:199], v[104:107], v[252:255]
    ds_read_b128 v[80:83], v20 offset:8192
    s_waitcnt lgkmcnt(8)
    v_mfma_f32_16x16x32_bf16 v[128:131], a[216:219], v[48:51], v[128:131]
    ds_read_b128 v[84:87], v21 offset:8192
    v_mul_u32_u24 v12, 4152, v12
    v_mfma_f32_16x16x32_bf16 v[128:131], a[232:235], v[52:55], v[128:131]
    buffer_load_dwordx4 v28, s[44:47], s70 offen offset:2048 lds
    v_mfma_f32_16x16x32_bf16 v[132:135], a[236:239], v[52:55], v[132:135]
    ds_read_b128 v[88:91], v20 offset:10240
    v_lshl_add_u32 v12, v0, 3, v12
    v_mfma_f32_16x16x32_bf16 v[132:135], a[220:223], v[48:51], v[132:135]
    ds_read_b128 v[92:95], v21 offset:10240
    v_mfma_f32_16x16x32_bf16 v[136:139], a[224:227], v[48:51], v[136:139]
    ds_read_b128 v[96:99], v20 offset:12288
    v_add_u32 v12, s32, v12
    v_mfma_f32_16x16x32_bf16 v[136:139], a[240:243], v[52:55], v[136:139]
    ds_read_b128 v[100:103], v21 offset:12288
    s_lshr_b32 s32, s3, 1
    s_waitcnt lgkmcnt(8)
    v_mfma_f32_16x16x32_bf16 v[140:143], a[244:247], v[52:55], v[140:143]
    buffer_load_dwordx4 v29, s[44:47], s70 offen offset:3072 lds
    v_mfma_f32_16x16x32_bf16 v[140:143], a[228:231], v[48:51], v[140:143]
    s_mul_i32 s33, s32, 4160
    ds_read_b128 v[104:107], v20 offset:14336
    s_add_u32 m0, s76, 4096
    v_smfmac_f32_16x16x64_bf16 v[120:123], v[44:47], a[216:223], v119
    s_add_u32 s33, s33, 67808
    ds_read_b128 v[108:111], v21 offset:14336
    v_add_u32 v20, 49152, v20
    v_smfmac_f32_16x16x64_bf16 v[124:127], v[44:47], a[224:231], v119
    v_add_u32 v21, 49152, v21
    v_and_b32_e64 v13, 3, v0
    v_mfma_f32_16x16x32_bf16 v[144:147], a[216:219], v[56:59], v[144:147]
    v_bfe_u32 v16, v0, 2, 2
    v_sub_u32_e64 v13, v13, v16
    v_mfma_f32_16x16x32_bf16 v[144:147], a[232:235], v[60:63], v[144:147]
    buffer_load_dwordx4 v26, s[44:47], s71 offen offset:0 lds
    v_mfma_f32_16x16x32_bf16 v[148:151], a[236:239], v[60:63], v[148:151]
    s_add_u32 s70, s70, 128
    v_lshrrev_b32 v16, 4, v0
    v_lshlrev_b32 v17, 3, v16
    v_mfma_f32_16x16x32_bf16 v[148:151], a[220:223], v[56:59], v[148:151]
    v_sub_u32_e64 v13, v13, v17
    v_lshl_add_u32 v14, v13, 3, s33
    v_mfma_f32_16x16x32_bf16 v[152:155], a[224:227], v[56:59], v[152:155]
    s_mul_i32 s33, s32, 9216
    s_add_u32 s33, s33, 49152
    v_and_b32_e64 v13, 15, v0
    v_mfma_f32_16x16x32_bf16 v[152:155], a[240:243], v[60:63], v[152:155]
    buffer_load_dwordx4 v27, s[44:47], s71 offen offset:1024 lds
    v_mfma_f32_16x16x32_bf16 v[156:159], a[244:247], v[60:63], v[156:159]
    v_lshl_add_u32 v13, v16, 1, v13
    v_lshl_add_u32 v15, v13, 4, s33
    v_mfma_f32_16x16x32_bf16 v[156:159], a[228:231], v[56:59], v[156:159]
    s_lshl_b32 s38, s68, 1
    s_lshr_b32 s35, s3, 1
    v_mfma_f32_16x16x32_bf16 v[160:163], a[216:219], v[64:67], v[160:163]
    s_add_u32 s38, s38, s35
    s_lshl_b32 s38, s38, 11
    s_add_u32 s38, s38, 360448
    v_mfma_f32_16x16x32_bf16 v[160:163], a[232:235], v[68:71], v[160:163]
    v_lshrrev_b32_e64 v5, 2, v0
    v_mul_u32_u24 v5, 96, v5
    v_mfma_f32_16x16x32_bf16 v[164:167], a[236:239], v[68:71], v[164:167]
    buffer_load_dwordx4 v28, s[44:47], s71 offen offset:2048 lds
    v_mfma_f32_16x16x32_bf16 v[164:167], a[220:223], v[64:67], v[164:167]
    v_lshl_add_u32 v5, v0, 3, v5
    v_mfma_f32_16x16x32_bf16 v[168:171], a[224:227], v[64:67], v[168:171]
    v_mfma_f32_16x16x32_bf16 v[168:171], a[240:243], v[68:71], v[168:171]
    v_mfma_f32_16x16x32_bf16 v[172:175], a[244:247], v[68:71], v[172:175]
    v_mfma_f32_16x16x32_bf16 v[172:175], a[228:231], v[64:67], v[172:175]
    buffer_load_dwordx4 v29, s[44:47], s71 offen offset:3072 lds
    s_waitcnt lgkmcnt(8)
    v_mfma_f32_16x16x32_bf16 v[176:179], a[216:219], v[72:75], v[176:179]
    s_waitcnt vmcnt(16)
    v_cmp_ne_u32 vcc, s7, v18
    s_cbranch_vccnz Lslow_1
Lback_2:
    v_mfma_f32_16x16x32_bf16 v[176:179], a[232:235], v[76:79], v[176:179]
    v_mfma_f32_16x16x32_bf16 v[180:183], a[236:239], v[76:79], v[180:183]
    v_mfma_f32_16x16x32_bf16 v[180:183], a[220:223], v[72:75], v[180:183]
    v_mfma_f32_16x16x32_bf16 v[184:187], a[224:227], v[72:75], v[184:187]
    s_waitcnt vmcnt(12) lgkmcnt(0)
    v_mfma_f32_16x16x32_bf16 v[184:187], a[240:243], v[76:79], v[184:187]
    v_mfma_f32_16x16x32_bf16 v[188:191], a[244:247], v[76:79], v[188:191]
    s_barrier
    ds_read_b128 v[48:51], v20 offset:0
    v_mfma_f32_16x16x32_bf16 v[188:191], a[228:231], v[72:75], v[188:191]
    ds_read_b128 v[52:55], v21 offset:0
    v_mfma_f32_16x16x32_bf16 v[192:195], a[216:219], v[80:83], v[192:195]
    buffer_load_dwordx4 a[248:251], v4, s[56:59], s86 offen sc1
    v_mfma_f32_16x16x32_bf16 v[192:195], a[232:235], v[84:87], v[192:195]
    ds_read_b64_tr_b16 a[184:185], v22 offset:0
    v_mov_b32_e64 v26, v12
    v_mfma_f32_16x16x32_bf16 v[196:199], a[236:239], v[84:87], v[196:199]
    ds_read_b64_tr_b16 a[186:187], v22 offset:512
    v_mov_b32_e64 v27, v7
    v_mfma_f32_16x16x32_bf16 v[196:199], a[220:223], v[80:83], v[196:199]
    ds_read_b64_tr_b16 a[200:201], v24 offset:0
    v_mov_b32_e64 v28, v8
    v_mfma_f32_16x16x32_bf16 v[200:203], a[224:227], v[80:83], v[200:203]
    ds_read_b64_tr_b16 a[202:203], v24 offset:512
    v_mov_b32_e64 v29, v14
    v_mfma_f32_16x16x32_bf16 v[200:203], a[240:243], v[84:87], v[200:203]
    v_mov_b32_e64 v30, v15
    s_mul_i32 s33, s3, 16896
    v_mfma_f32_16x16x32_bf16 v[204:207], a[244:247], v[84:87], v[204:207]
    ds_read_b64_tr_b16 a[188:189], v23 offset:0
    s_add_u32 s33, s33, 96256
    v_mfma_f32_16x16x32_bf16 v[204:207], a[228:231], v[80:83], v[204:207]
    ds_read_b64_tr_b16 a[190:191], v23 offset:512
    v_lshl_add_u32 v15, v0, 3, s33
    v_mfma_f32_16x16x32_bf16 v[208:211], a[216:219], v[88:91], v[208:211]
    ds_read_b64_tr_b16 a[204:205], v25 offset:0
    s_lshr_b32 s33, s3, 1
    v_mfma_f32_16x16x32_bf16 v[208:211], a[232:235], v[92:95], v[208:211]
    buffer_load_dwordx4 a[252:255], v4, s[56:59], s87 offen sc1
    v_mfma_f32_16x16x32_bf16 v[212:215], a[236:239], v[92:95], v[212:215]
    ds_read_b64_tr_b16 a[206:207], v25 offset:512
    s_mul_i32 s33, s33, 33792
    v_mfma_f32_16x16x32_bf16 v[212:215], a[220:223], v[88:91], v[212:215]
    ds_read_b64_tr_b16 a[192:193], v22 offset:2048
    s_add_u32 s33, s33, 96256
    v_mfma_f32_16x16x32_bf16 v[216:219], a[224:227], v[88:91], v[216:219]
    ds_read_b64_tr_b16 a[194:195], v22 offset:2560
    v_lshrrev_b32 v14, 5, v0
    v_mfma_f32_16x16x32_bf16 v[216:219], a[240:243], v[92:95], v[216:219]
    ds_read_b64_tr_b16 a[208:209], v24 offset:2048
    v_lshl_add_u32 v14, v14, 4, s33
    v_mfma_f32_16x16x32_bf16 v[220:223], a[244:247], v[92:95], v[220:223]
    buffer_load_dwordx2 v[2:3], v5, s[56:59], s38 offen sc1
    v_mfma_f32_16x16x32_bf16 v[220:223], a[228:231], v[88:91], v[220:223]
    ds_read_b64_tr_b16 a[210:211], v24 offset:2560
    v_mfma_f32_16x16x32_bf16 v[224:227], a[216:219], v[96:99], v[224:227]
    ds_read_b64_tr_b16 a[196:197], v23 offset:2048
    v_and_b32_e64 v17, 31, v0
    v_mfma_f32_16x16x32_bf16 v[224:227], a[232:235], v[100:103], v[224:227]
    ds_read_b64_tr_b16 a[198:199], v23 offset:2560
    v_and_b32_e64 v16, 24, v0
    v_mfma_f32_16x16x32_bf16 v[228:231], a[236:239], v[100:103], v[228:231]
    ds_read_b64_tr_b16 a[212:213], v25 offset:2048
    s_mul_i32 s85, s16, 5
    v_mfma_f32_16x16x32_bf16 v[228:231], a[220:223], v[96:99], v[228:231]
    v_and_b32 v31, 3, v0
    v_lshl_add_u32 v16, v31, 1, v16
    v_mfma_f32_16x16x32_bf16 v[232:235], a[224:227], v[96:99], v[232:235]
    s_add_u32 s85, s85, s83
    ds_read_b64_tr_b16 a[214:215], v25 offset:2560
    v_subrev_u32 v22, 98304, v22
    v_mfma_f32_16x16x32_bf16 v[232:235], a[240:243], v[100:103], v[232:235]
    ds_read_b128 v[56:59], v20 offset:2048
    v_subrev_u32 v23, 98304, v23
    v_mfma_f32_16x16x32_bf16 v[236:239], a[244:247], v[100:103], v[236:239]
    ds_read_b128 v[60:63], v21 offset:2048
    v_subrev_u32 v24, 98304, v24
    v_mfma_f32_16x16x32_bf16 v[236:239], a[228:231], v[96:99], v[236:239]
    ds_read_b128 v[64:67], v20 offset:4096
    v_subrev_u32 v25, 98304, v25
    v_mfma_f32_16x16x32_bf16 v[240:243], a[216:219], v[104:107], v[240:243]
    buffer_load_dwordx4 a[0:3], v1, s[56:59], s85 offen offset:0 sc1
    v_mfma_f32_16x16x32_bf16 v[240:243], a[232:235], v[108:111], v[240:243]
    ds_read_b128 v[68:71], v21 offset:4096
    s_lshr_b32 s32, s3, 1
    v_mfma_f32_16x16x32_bf16 v[244:247], a[236:239], v[108:111], v[244:247]
    ds_read_b128 v[72:75], v20 offset:6144
    s_mul_i32 s32, s32, 32
    v_mfma_f32_16x16x32_bf16 v[244:247], a[220:223], v[104:107], v[244:247]
    ds_read_b128 v[76:79], v21 offset:6144
    s_lshl_b32 s34, s3, 12
    v_mfma_f32_16x16x32_bf16 v[248:251], a[224:227], v[104:107], v[248:251]
    buffer_load_dwordx4 a[4:7], v1, s[56:59], s85 offen offset:1024 sc1
    v_mfma_f32_16x16x32_bf16 v[248:251], a[240:243], v[108:111], v[248:251]
    ds_read_b128 v[80:83], v20 offset:8192
    s_add_u32 s32, s32, s34
    v_mfma_f32_16x16x32_bf16 v[252:255], a[244:247], v[108:111], v[252:255]
    ds_read_b128 v[84:87], v21 offset:8192
    s_add_u32 s32, s32, 75920
    v_mfma_f32_16x16x32_bf16 v[252:255], a[228:231], v[104:107], v[252:255]
    ds_read_b128 v[88:91], v20 offset:10240
    s_waitcnt lgkmcnt(8)
    v_mfma_f32_16x16x32_bf16 v[128:131], a[184:187], v[48:51], v[128:131]
    ds_read_b128 v[92:95], v21 offset:10240
    v_add_u32_e64 v19, s32, v1
    v_mfma_f32_16x16x32_bf16 v[128:131], a[200:203], v[52:55], v[128:131]
    buffer_load_dwordx4 a[8:11], v1, s[56:59], s85 offen offset:2048 sc1
    v_mfma_f32_16x16x32_bf16 v[132:135], a[204:207], v[52:55], v[132:135]
    ds_read_b128 v[96:99], v20 offset:12288
    v_bfe_u32 v31, v0, 2, 1
    v_mfma_f32_16x16x32_bf16 v[132:135], a[188:191], v[48:51], v[132:135]
    ds_read_b128 v[100:103], v21 offset:12288
    v_mfma_f32_16x16x32_bf16 v[136:139], a[192:195], v[48:51], v[136:139]
    ds_read_b128 v[104:107], v20 offset:14336
    v_add_u32_e64 v16, v16, v31
    v_mfma_f32_16x16x32_bf16 v[136:139], a[208:211], v[52:55], v[136:139]
    s_movk_i32 s33, 528
    ds_read_b128 v[108:111], v21 offset:14336
    v_subrev_u32 v20, 98304, v20
    v_mfma_f32_16x16x32_bf16 v[140:143], a[212:215], v[52:55], v[140:143]
    buffer_load_dwordx4 a[12:15], v1, s[56:59], s85 offen offset:3072 sc1
    v_mfma_f32_16x16x32_bf16 v[140:143], a[196:199], v[48:51], v[140:143]
    v_subrev_u32 v21, 98304, v21
    s_add_u32 s85, s85, 4096
    v_smfmac_f32_16x16x64_bf16 v[120:123], v[44:47], a[184:191], v119
    ds_write_b64 v6, v[10:11]
    v_smfmac_f32_16x16x64_bf16 v[124:127], v[44:47], a[192:199], v119
    v_mad_u32_u24 v17, v17, s33, v14
    v_mad_u32_u24 v16, v16, s33, v14
    s_waitcnt lgkmcnt(8)
    v_mfma_f32_16x16x32_bf16 v[144:147], a[184:187], v[56:59], v[144:147]
    buffer_load_dwordx4 a[16:19], v1, s[56:59], s85 offen offset:0 sc1
    v_mfma_f32_16x16x32_bf16 v[144:147], a[200:203], v[60:63], v[144:147]
    s_mul_i32 s85, s17, 5
    s_add_u32 s85, s85, s83
    s_lshr_b32 s70, s3, 1
    v_mfma_f32_16x16x32_bf16 v[148:151], a[204:207], v[60:63], v[148:151]
    s_lshl_b32 s70, s70, 3
    v_add_f32 v112, v120, v121
    v_add_f32 v113, v122, v123
    v_mfma_f32_16x16x32_bf16 v[148:151], a[188:191], v[56:59], v[148:151]
    s_lshl_b32 s71, s68, 4
    v_add_f32 v114, v124, v125
    v_add_f32_e64 v115, v126, v127
    v_mfma_f32_16x16x32_bf16 v[152:155], a[192:195], v[56:59], v[152:155]
    ds_write_b128 v19, v[112:115]
    v_mfma_f32_16x16x32_bf16 v[152:155], a[208:211], v[60:63], v[152:155]
    buffer_load_dwordx4 a[20:23], v1, s[56:59], s85 offen offset:0 sc1
    v_mfma_f32_16x16x32_bf16 v[156:159], a[212:215], v[60:63], v[156:159]
    v_add_u32 v117, 2048, v19
    s_add_u32 s70, s70, s71
    v_mfma_f32_16x16x32_bf16 v[156:159], a[196:199], v[56:59], v[156:159]
    s_bitcmp1_b32 s3, 1
    s_cselect_b32 s32, -1, 1
    v_mfma_f32_16x16x32_bf16 v[160:163], a[184:187], v[64:67], v[160:163]
    s_mul_i32 s32, s32, 8224
    v_add_u32_e64 v19, s32, v19
    s_mul_i32 s70, s70, 54
    v_mfma_f32_16x16x32_bf16 v[160:163], a[200:203], v[68:71], v[160:163]
    s_lshl_b32 s71, s69, 1
    s_add_u32 s70, s70, s71
    s_and_b32 s71, s3, 1
    v_mfma_f32_16x16x32_bf16 v[164:167], a[204:207], v[68:71], v[164:167]
    buffer_load_dwordx4 a[24:27], v1, s[56:59], s85 offen offset:1024 sc1
    v_mfma_f32_16x16x32_bf16 v[164:167], a[188:191], v[64:67], v[164:167]
    s_add_u32 s70, s70, s71
    s_lshl_b32 s70, s70, 10
    s_add_u32 s70, s70, 7962624
    v_mfma_f32_16x16x32_bf16 v[168:171], a[192:195], v[64:67], v[168:171]
    s_lshl_b32 s35, s3, 9
    s_add_u32 s35, s35, 92416
    v_and_b32_e64 v12, 7, v0
    v_mfma_f32_16x16x32_bf16 v[168:171], a[208:211], v[68:71], v[168:171]
    v_lshrrev_b32 v13, 3, v0
    v_lshlrev_b32 v12, 6, v12
    v_mfma_f32_16x16x32_bf16 v[172:175], a[212:215], v[68:71], v[172:175]
    buffer_load_dwordx4 a[28:31], v1, s[56:59], s85 offen offset:2048 sc1
    v_mfma_f32_16x16x32_bf16 v[172:175], a[196:199], v[64:67], v[172:175]
    v_lshl_add_u32 v12, v13, 2, v12
    v_add_u32_e64 v12, s35, v12
    v_mfma_f32_16x16x32_bf16 v[176:179], a[184:187], v[72:75], v[176:179]
    v_and_b32_e64 v13, 15, v0
    v_lshl_add_u32 v13, v13, 5, s35
    v_mfma_f32_16x16x32_bf16 v[176:179], a[200:203], v[76:79], v[176:179]
    v_mfma_f32_16x16x32_bf16 v[180:183], a[204:207], v[76:79], v[180:183]
    s_waitcnt vmcnt(11) lgkmcnt(0)
    v_mfma_f32_16x16x32_bf16 v[180:183], a[188:191], v[72:75], v[180:183]
    buffer_load_dwordx4 a[32:35], v1, s[56:59], s85 offen offset:3072 sc1
    v_mfma_f32_16x16x32_bf16 v[184:187], a[192:195], v[72:75], v[184:187]
    s_barrier
    ds_read_b128 v[48:51], v20 offset:0
    s_add_u32 s85, s85, 4096
    v_mfma_f32_16x16x32_bf16 v[184:187], a[208:211], v[76:79], v[184:187]
    ds_read_b128 v[52:55], v21 offset:0
    s_waitcnt vmcnt(9)
    v_mfma_f32_16x16x32_bf16 v[188:191], a[212:215], v[76:79], v[188:191]
    ds_read_b64_tr_b16 a[216:217], v22 offset:0
    v_mfma_f32_16x16x32_bf16 v[188:191], a[196:199], v[72:75], v[188:191]
    ds_read_b64_tr_b16 a[218:219], v22 offset:512
    v_mfma_f32_16x16x32_bf16 v[192:195], a[184:187], v[80:83], v[192:195]
    buffer_load_dwordx4 a[36:39], v1, s[56:59], s85 offen offset:0 sc1
    v_mfma_f32_16x16x32_bf16 v[192:195], a[200:203], v[84:87], v[192:195]
    ds_read_b64_tr_b16 a[232:233], v24 offset:0
    s_mul_i32 s85, s18, 5
    v_mfma_f32_16x16x32_bf16 v[196:199], a[204:207], v[84:87], v[196:199]
    ds_read_b64_tr_b16 a[234:235], v24 offset:512
    s_add_u32 s85, s85, s83
    v_mfma_f32_16x16x32_bf16 v[196:199], a[188:191], v[80:83], v[196:199]
    ds_read_b64_tr_b16 a[220:221], v23 offset:0
    v_mfma_f32_16x16x32_bf16 v[200:203], a[192:195], v[80:83], v[200:203]
    ds_read_b64_tr_b16 a[222:223], v23 offset:512
    v_mfma_f32_16x16x32_bf16 v[200:203], a[208:211], v[84:87], v[200:203]
    buffer_load_dwordx4 a[40:43], v1, s[56:59], s85 offen offset:0 sc1
    v_mfma_f32_16x16x32_bf16 v[204:207], a[212:215], v[84:87], v[204:207]
    ds_read_b64_tr_b16 a[236:237], v25 offset:0
    v_mfma_f32_16x16x32_bf16 v[204:207], a[196:199], v[80:83], v[204:207]
    ds_read_b64_tr_b16 a[238:239], v25 offset:512
    v_mfma_f32_16x16x32_bf16 v[208:211], a[184:187], v[88:91], v[208:211]
    ds_read_b64_tr_b16 a[224:225], v22 offset:2048
    v_mfma_f32_16x16x32_bf16 v[208:211], a[200:203], v[92:95], v[208:211]
    buffer_load_dwordx4 a[44:47], v1, s[56:59], s85 offen offset:1024 sc1
    v_mfma_f32_16x16x32_bf16 v[212:215], a[204:207], v[92:95], v[212:215]
    ds_read_b64_tr_b16 a[226:227], v22 offset:2560
    v_mfma_f32_16x16x32_bf16 v[212:215], a[188:191], v[88:91], v[212:215]
    ds_read_b64_tr_b16 a[240:241], v24 offset:2048
    v_mfma_f32_16x16x32_bf16 v[216:219], a[192:195], v[88:91], v[216:219]
    ds_read_b64_tr_b16 a[242:243], v24 offset:2560
    v_mfma_f32_16x16x32_bf16 v[216:219], a[208:211], v[92:95], v[216:219]
    ds_read_b64_tr_b16 a[228:229], v23 offset:2048
    v_mfma_f32_16x16x32_bf16 v[220:223], a[212:215], v[92:95], v[220:223]
    buffer_load_dwordx4 a[48:51], v1, s[56:59], s85 offen offset:2048 sc1
    v_mfma_f32_16x16x32_bf16 v[220:223], a[196:199], v[88:91], v[220:223]
    ds_read_b64_tr_b16 a[230:231], v23 offset:2560
    v_mfma_f32_16x16x32_bf16 v[224:227], a[184:187], v[96:99], v[224:227]
    ds_read_b64_tr_b16 a[244:245], v25 offset:2048
    v_mfma_f32_16x16x32_bf16 v[224:227], a[200:203], v[100:103], v[224:227]
    ds_read_b64_tr_b16 a[246:247], v25 offset:2560
    v_mfma_f32_16x16x32_bf16 v[228:231], a[204:207], v[100:103], v[228:231]
    ds_read_b128 v[56:59], v20 offset:2048
    v_mfma_f32_16x16x32_bf16 v[228:231], a[188:191], v[96:99], v[228:231]
    buffer_load_dwordx4 a[52:55], v1, s[56:59], s85 offen offset:3072 sc1
    v_mfma_f32_16x16x32_bf16 v[232:235], a[192:195], v[96:99], v[232:235]
    ds_read_b128 v[60:63], v21 offset:2048
    s_add_u32 s85, s85, 4096
    v_mfma_f32_16x16x32_bf16 v[232:235], a[208:211], v[100:103], v[232:235]
    ds_read_b128 v[64:67], v20 offset:4096
    v_mfma_f32_16x16x32_bf16 v[236:239], a[212:215], v[100:103], v[236:239]
    ds_read_b128 v[68:71], v21 offset:4096
    v_mfma_f32_16x16x32_bf16 v[236:239], a[196:199], v[96:99], v[236:239]
    buffer_load_dwordx4 a[56:59], v1, s[56:59], s85 offen offset:0 sc1
    v_mfma_f32_16x16x32_bf16 v[240:243], a[184:187], v[104:107], v[240:243]
    ds_read_b128 v[72:75], v20 offset:6144
    s_mul_i32 s85, s19, 5
    v_mfma_f32_16x16x32_bf16 v[240:243], a[200:203], v[108:111], v[240:243]
    ds_read_b128 v[76:79], v21 offset:6144
    s_add_u32 s85, s85, s83
    v_mfma_f32_16x16x32_bf16 v[244:247], a[204:207], v[108:111], v[244:247]
    ds_read_b128 v[80:83], v20 offset:8192
    v_mfma_f32_16x16x32_bf16 v[244:247], a[188:191], v[104:107], v[244:247]
    ds_read_b128 v[84:87], v21 offset:8192
    v_mfma_f32_16x16x32_bf16 v[248:251], a[192:195], v[104:107], v[248:251]
    buffer_load_dwordx4 a[60:63], v1, s[56:59], s85 offen offset:0 sc1
    v_mfma_f32_16x16x32_bf16 v[248:251], a[208:211], v[108:111], v[248:251]
    ds_read_b128 v[88:91], v20 offset:10240
    v_mfma_f32_16x16x32_bf16 v[252:255], a[212:215], v[108:111], v[252:255]
    ds_read_b128 v[92:95], v21 offset:10240
    v_mfma_f32_16x16x32_bf16 v[252:255], a[196:199], v[104:107], v[252:255]
    ds_read_b128 v[96:99], v20 offset:12288
    s_waitcnt lgkmcnt(8)
    v_mfma_f32_16x16x32_bf16 v[128:131], a[216:219], v[48:51], v[128:131]
    ds_read_b128 v[100:103], v21 offset:12288
    v_mfma_f32_16x16x32_bf16 v[128:131], a[232:235], v[52:55], v[128:131]
    buffer_load_dwordx4 a[64:67], v1, s[56:59], s85 offen offset:1024 sc1
    v_mfma_f32_16x16x32_bf16 v[132:135], a[236:239], v[52:55], v[132:135]
    ds_read_b128 v[104:107], v20 offset:14336
    v_mfma_f32_16x16x32_bf16 v[132:135], a[220:223], v[48:51], v[132:135]
    ds_read_b128 v[108:111], v21 offset:14336
    v_mfma_f32_16x16x32_bf16 v[136:139], a[224:227], v[48:51], v[136:139]
    ds_read_b128 v[112:115], v19
    v_and_b32_e64 v19, 15, v0
    v_mfma_f32_16x16x32_bf16 v[136:139], a[240:243], v[52:55], v[136:139]
    v_sub_u32_e64 v117, v117, v1
    v_lshl_add_u32 v19, v19, 2, v117
    v_mfma_f32_16x16x32_bf16 v[140:143], a[244:247], v[52:55], v[140:143]
    buffer_load_dwordx4 a[68:71], v1, s[56:59], s85 offen offset:2048 sc1
    v_mfma_f32_16x16x32_bf16 v[140:143], a[228:231], v[48:51], v[140:143]
    v_and_b32 v118, 48, v0
    v_add_u32 v117, v117, v118
    v_smfmac_f32_16x16x64_bf16 v[120:123], v[44:47], a[216:223], v119
    ds_write2_b32 v12, v2, v3 offset1:8
    v_smfmac_f32_16x16x64_bf16 v[120:123], v[44:47], a[232:239], v119
    ds_read_b128 v[2:5], v13
    v_smfmac_f32_16x16x64_bf16 v[124:127], v[44:47], a[224:231], v119
    buffer_load_dwordx4 a[72:75], v1, s[56:59], s85 offen offset:3072 sc1
    v_smfmac_f32_16x16x64_bf16 v[124:127], v[44:47], a[240:247], v119
    s_add_u32 s85, s85, 4096
    ds_read_b128 v[6:9], v13 offset:16
    v_mfma_f32_16x16x32_bf16 v[144:147], a[216:219], v[56:59], v[144:147]
    ds_write_b128 v26, a[248:251]
    v_mfma_f32_16x16x32_bf16 v[144:147], a[232:235], v[60:63], v[144:147]
    ds_write_b128 v26, a[252:255] offset:512
    v_mfma_f32_16x16x32_bf16 v[148:151], a[236:239], v[60:63], v[148:151]
    v_mfma_f32_16x16x32_bf16 v[148:151], a[220:223], v[56:59], v[148:151]
    buffer_load_dwordx4 a[76:79], v1, s[56:59], s85 offen offset:0 sc1
    v_mfma_f32_16x16x32_bf16 v[152:155], a[224:227], v[56:59], v[152:155]
    s_waitcnt lgkmcnt(5)
    v_add_f32 v112, v112, v120
    v_add_f32_e64 v112, v112, v121
    v_mfma_f32_16x16x32_bf16 v[152:155], a[240:243], v[60:63], v[152:155]
    s_mul_i32 s85, s20, 5
    v_add_f32 v113, v113, v122
    v_add_f32_e64 v113, v113, v123
    v_mfma_f32_16x16x32_bf16 v[156:159], a[244:247], v[60:63], v[156:159]
    s_add_u32 s85, s85, s83
    v_add_f32 v114, v114, v124
    v_add_f32_e64 v114, v114, v125
    v_mfma_f32_16x16x32_bf16 v[156:159], a[228:231], v[56:59], v[156:159]
    v_add_f32_e64 v115, v115, v126
    v_mfma_f32_16x16x32_bf16 v[160:163], a[216:219], v[64:67], v[160:163]
    buffer_load_dwordx4 a[80:83], v1, s[56:59], s85 offen offset:0 sc1
    v_mfma_f32_16x16x32_bf16 v[160:163], a[232:235], v[68:71], v[160:163]
    v_add_f32_e64 v115, v115, v127
    v_mfma_f32_16x16x32_bf16 v[164:167], a[236:239], v[68:71], v[164:167]
    ds_write2_b32 v19, v112, v113 offset0:0 offset1:16
    v_mfma_f32_16x16x32_bf16 v[164:167], a[220:223], v[64:67], v[164:167]
    ds_write2_b32 v19, v114, v115 offset0:32 offset1:48
    v_mfma_f32_16x16x32_bf16 v[168:171], a[224:227], v[64:67], v[168:171]
    buffer_load_dwordx4 a[84:87], v1, s[56:59], s85 offen offset:1024 sc1
    v_mfma_f32_16x16x32_bf16 v[168:171], a[240:243], v[68:71], v[168:171]
    v_mov_b32_e64 v19, v117
    v_mfma_f32_16x16x32_bf16 v[172:175], a[244:247], v[68:71], v[172:175]
    ds_read_b128 v[112:115], v19 offset:0
    v_mfma_f32_16x16x32_bf16 v[172:175], a[228:231], v[64:67], v[172:175]
    ds_read_b128 v[116:119], v19 offset:64
    v_mfma_f32_16x16x32_bf16 v[176:179], a[216:219], v[72:75], v[176:179]
    ds_read_b128 v[120:123], v19 offset:128
    v_mfma_f32_16x16x32_bf16 v[176:179], a[232:235], v[76:79], v[176:179]
    buffer_load_dwordx4 a[88:91], v1, s[56:59], s85 offen offset:2048 sc1
    v_mfma_f32_16x16x32_bf16 v[180:183], a[236:239], v[76:79], v[180:183]
    ds_read_b128 v[124:127], v19 offset:192
    v_mfma_f32_16x16x32_bf16 v[180:183], a[220:223], v[72:75], v[180:183]
    v_mfma_f32_16x16x32_bf16 v[184:187], a[224:227], v[72:75], v[184:187]
    v_mfma_f32_16x16x32_bf16 v[184:187], a[240:243], v[76:79], v[184:187]
    v_mfma_f32_16x16x32_bf16 v[188:191], a[244:247], v[76:79], v[188:191]
    buffer_load_dwordx4 a[92:95], v1, s[56:59], s85 offen offset:3072 sc1
    v_mfma_f32_16x16x32_bf16 v[188:191], a[228:231], v[72:75], v[188:191]
    s_waitcnt lgkmcnt(0)
    s_add_u32 s85, s85, 4096
    v_mfma_f32_16x16x32_bf16 v[192:195], a[216:219], v[80:83], v[192:195]
    v_lshlrev_b32 v48, 16, v2
    v_and_b32_e64 v49, s6, v2
    v_mfma_f32_16x16x32_bf16 v[192:195], a[232:235], v[84:87], v[192:195]
    v_rcp_f32_e64 v2, v49
    v_mfma_f32_16x16x32_bf16 v[196:199], a[236:239], v[84:87], v[196:199]
    buffer_load_dwordx4 a[96:99], v1, s[56:59], s85 offen offset:0 sc1
    v_mfma_f32_16x16x32_bf16 v[196:199], a[220:223], v[80:83], v[196:199]
    s_mul_i32 s85, s21, 5
    s_add_u32 s85, s85, s83
    v_lshlrev_b32_e64 v50, 16, v3
    v_mfma_f32_16x16x32_bf16 v[200:203], a[224:227], v[80:83], v[200:203]
    v_and_b32_e64 v51, s6, v3
    v_mfma_f32_16x16x32_bf16 v[200:203], a[240:243], v[84:87], v[200:203]
    v_rcp_f32_e64 v3, v51
    v_mfma_f32_16x16x32_bf16 v[204:207], a[244:247], v[84:87], v[204:207]
    v_lshlrev_b32 v52, 16, v4
    v_and_b32 v53, s6, v4
    v_mfma_f32_16x16x32_bf16 v[204:207], a[228:231], v[80:83], v[204:207]
    buffer_load_dwordx4 a[100:103], v1, s[56:59], s85 offen offset:0 sc1
    v_mfma_f32_16x16x32_bf16 v[208:211], a[216:219], v[88:91], v[208:211]
    v_rcp_f32_e64 v4, v53
    v_mfma_f32_16x16x32_bf16 v[208:211], a[232:235], v[92:95], v[208:211]
    v_lshlrev_b32 v54, 16, v5
    v_and_b32 v55, s6, v5
    v_mfma_f32_16x16x32_bf16 v[212:215], a[236:239], v[92:95], v[212:215]
    v_rcp_f32_e64 v5, v55
    v_mfma_f32_16x16x32_bf16 v[212:215], a[220:223], v[88:91], v[212:215]
    v_lshlrev_b32 v56, 16, v6
    v_and_b32 v57, s6, v6
    v_mfma_f32_16x16x32_bf16 v[216:219], a[224:227], v[88:91], v[216:219]
    buffer_load_dwordx4 a[104:107], v1, s[56:59], s85 offen offset:1024 sc1
    v_mfma_f32_16x16x32_bf16 v[216:219], a[240:243], v[92:95], v[216:219]
    v_rcp_f32_e64 v6, v57
    v_mfma_f32_16x16x32_bf16 v[220:223], a[244:247], v[92:95], v[220:223]
    v_lshlrev_b32 v58, 16, v7
    v_and_b32 v59, s6, v7
    v_mfma_f32_16x16x32_bf16 v[220:223], a[228:231], v[88:91], v[220:223]
    v_mfma_f32_16x16x32_bf16 v[224:227], a[216:219], v[96:99], v[224:227]
    v_rcp_f32_e64 v7, v59
    v_mfma_f32_16x16x32_bf16 v[224:227], a[232:235], v[100:103], v[224:227]
    buffer_load_dwordx4 a[108:111], v1, s[56:59], s85 offen offset:2048 sc1
    v_mfma_f32_16x16x32_bf16 v[228:231], a[236:239], v[100:103], v[228:231]
    v_lshlrev_b32 v60, 16, v8
    v_and_b32 v61, s6, v8
    v_mfma_f32_16x16x32_bf16 v[228:231], a[220:223], v[96:99], v[228:231]
    v_rcp_f32_e64 v8, v61
    v_mfma_f32_16x16x32_bf16 v[232:235], a[224:227], v[96:99], v[232:235]
    v_lshlrev_b32 v62, 16, v9
    v_and_b32 v63, s6, v9
    v_mfma_f32_16x16x32_bf16 v[232:235], a[240:243], v[100:103], v[232:235]
    buffer_load_dwordx4 a[112:115], v1, s[56:59], s85 offen offset:3072 sc1
    v_mfma_f32_16x16x32_bf16 v[236:239], a[244:247], v[100:103], v[236:239]
    s_add_u32 s85, s85, 4096
    v_rcp_f32_e64 v9, v63
    v_mfma_f32_16x16x32_bf16 v[236:239], a[228:231], v[96:99], v[236:239]
    v_mul_f32 v2, 0xbfb8aa3b, v2
    v_mul_f32 v3, 0xbfb8aa3b, v3
    v_mfma_f32_16x16x32_bf16 v[240:243], a[216:219], v[104:107], v[240:243]
Lst_2213:
    s_cbranch_execz Lst_3369
    s_nop 0
    v_mul_f32 v4, 0xbfb8aa3b, v4
    v_mul_f32 v5, 0xbfb8aa3b, v5
    v_mfma_f32_16x16x32_bf16 v[240:243], a[232:235], v[108:111], v[240:243]
    v_mul_f32 v6, 0xbfb8aa3b, v6
    v_mul_f32 v7, 0xbfb8aa3b, v7
    v_mfma_f32_16x16x32_bf16 v[244:247], a[236:239], v[108:111], v[244:247]
    buffer_load_dwordx4 a[116:119], v1, s[56:59], s85 offen offset:0 sc1
    v_mfma_f32_16x16x32_bf16 v[244:247], a[220:223], v[104:107], v[244:247]
    v_mul_f32 v8, 0xbfb8aa3b, v8
    v_mul_f32 v9, 0xbfb8aa3b, v9
    v_mfma_f32_16x16x32_bf16 v[248:251], a[224:227], v[104:107], v[248:251]
    v_mfma_f32_16x16x32_bf16 v[248:251], a[240:243], v[108:111], v[248:251]
    v_mfma_f32_16x16x32_bf16 v[252:255], a[244:247], v[108:111], v[252:255]
    v_mfma_f32_16x16x32_bf16 v[252:255], a[228:231], v[104:107], v[252:255]
    v_pk_fma_f32 v[128:129], v[112:113], v[48:49], v[128:129] op_sel_hi:[1,0,1] neg_lo:[0,1,0] neg_hi:[0,1,0]
    v_pk_fma_f32 v[130:131], v[114:115], v[48:49], v[130:131] op_sel_hi:[1,0,1] neg_lo:[0,1,0] neg_hi:[0,1,0]
    v_pk_fma_f32 v[132:133], v[116:117], v[48:49], v[132:133] op_sel_hi:[1,0,1] neg_lo:[0,1,0] neg_hi:[0,1,0]
    v_pk_fma_f32 v[134:135], v[118:119], v[48:49], v[134:135] op_sel_hi:[1,0,1] neg_lo:[0,1,0] neg_hi:[0,1,0]
    v_pk_fma_f32 v[136:137], v[120:121], v[48:49], v[136:137] op_sel_hi:[1,0,1] neg_lo:[0,1,0] neg_hi:[0,1,0]
    v_pk_fma_f32 v[138:139], v[122:123], v[48:49], v[138:139] op_sel_hi:[1,0,1] neg_lo:[0,1,0] neg_hi:[0,1,0]
    v_pk_fma_f32 v[140:141], v[124:125], v[48:49], v[140:141] op_sel_hi:[1,0,1] neg_lo:[0,1,0] neg_hi:[0,1,0]
    v_pk_fma_f32 v[142:143], v[126:127], v[48:49], v[142:143] op_sel_hi:[1,0,1] neg_lo:[0,1,0] neg_hi:[0,1,0]
    v_pk_mul_f32 v[128:129], v[128:129], v[2:3] op_sel_hi:[1,0]
    v_pk_mul_f32 v[130:131], v[130:131], v[2:3] op_sel_hi:[1,0]
    v_pk_mul_f32 v[132:133], v[132:133], v[2:3] op_sel_hi:[1,0]
    v_pk_mul_f32 v[134:135], v[134:135], v[2:3] op_sel_hi:[1,0]
    v_exp_f32 v128, v128
    v_exp_f32 v129, v129
    v_exp_f32 v130, v130
    v_exp_f32 v131, v131
    v_exp_f32 v132, v132
    v_exp_f32 v133, v133
    v_exp_f32 v134, v134
    v_exp_f32 v135, v135
    v_pk_fma_f32 v[128:129], v[128:129], v[48:49], v[48:49] op_sel:[0,1,1] op_sel_hi:[1,1,1]
    v_pk_fma_f32 v[130:131], v[130:131], v[48:49], v[48:49] op_sel:[0,1,1] op_sel_hi:[1,1,1]
    v_pk_fma_f32 v[132:133], v[132:133], v[48:49], v[48:49] op_sel:[0,1,1] op_sel_hi:[1,1,1]
    v_pk_fma_f32 v[134:135], v[134:135], v[48:49], v[48:49] op_sel:[0,1,1] op_sel_hi:[1,1,1]
    v_rcp_f32 v128, v128
    v_rcp_f32 v129, v129
    v_rcp_f32 v130, v130
    v_rcp_f32 v131, v131
    v_rcp_f32 v132, v132
    v_rcp_f32 v133, v133
    v_rcp_f32 v134, v134
    v_rcp_f32 v135, v135
    v_pk_mul_f32 v[128:129], v[128:129], v[136:137]
    v_pk_mul_f32 v[130:131], v[130:131], v[138:139]
    v_pk_mul_f32 v[132:133], v[132:133], v[140:141]
    v_pk_mul_f32 v[134:135], v[134:135], v[142:143]
    v_cvt_pk_bf16_f32 v136, v128, v129
    v_cvt_pk_bf16_f32 v137, v130, v131
    v_cvt_pk_bf16_f32 v138, v132, v133
    v_cvt_pk_bf16_f32 v139, v134, v135
    buffer_store_dwordx4 v[136:139], v1, s[56:59], s70 offen sc1
    s_add_u32 s70, s70, 55296
    v_pk_fma_f32 v[144:145], v[112:113], v[50:51], v[144:145] op_sel_hi:[1,0,1] neg_lo:[0,1,0] neg_hi:[0,1,0]
    v_pk_fma_f32 v[146:147], v[114:115], v[50:51], v[146:147] op_sel_hi:[1,0,1] neg_lo:[0,1,0] neg_hi:[0,1,0]
    v_pk_fma_f32 v[148:149], v[116:117], v[50:51], v[148:149] op_sel_hi:[1,0,1] neg_lo:[0,1,0] neg_hi:[0,1,0]
    v_pk_fma_f32 v[150:151], v[118:119], v[50:51], v[150:151] op_sel_hi:[1,0,1] neg_lo:[0,1,0] neg_hi:[0,1,0]
    v_pk_fma_f32 v[152:153], v[120:121], v[50:51], v[152:153] op_sel_hi:[1,0,1] neg_lo:[0,1,0] neg_hi:[0,1,0]
    v_pk_fma_f32 v[154:155], v[122:123], v[50:51], v[154:155] op_sel_hi:[1,0,1] neg_lo:[0,1,0] neg_hi:[0,1,0]
    v_pk_fma_f32 v[156:157], v[124:125], v[50:51], v[156:157] op_sel_hi:[1,0,1] neg_lo:[0,1,0] neg_hi:[0,1,0]
    v_pk_fma_f32 v[158:159], v[126:127], v[50:51], v[158:159] op_sel_hi:[1,0,1] neg_lo:[0,1,0] neg_hi:[0,1,0]
    v_pk_mul_f32 v[144:145], v[144:145], v[2:3] op_sel:[0,1] op_sel_hi:[1,1]
    v_pk_mul_f32 v[146:147], v[146:147], v[2:3] op_sel:[0,1] op_sel_hi:[1,1]
    v_pk_mul_f32 v[148:149], v[148:149], v[2:3] op_sel:[0,1] op_sel_hi:[1,1]
    v_pk_mul_f32 v[150:151], v[150:151], v[2:3] op_sel:[0,1] op_sel_hi:[1,1]
    v_exp_f32 v144, v144
    v_exp_f32 v145, v145
    v_exp_f32 v146, v146
    v_exp_f32 v147, v147
    v_exp_f32 v148, v148
    v_exp_f32 v149, v149
    v_exp_f32 v150, v150
    v_exp_f32 v151, v151
    v_pk_fma_f32 v[144:145], v[144:145], v[50:51], v[50:51] op_sel:[0,1,1] op_sel_hi:[1,1,1]
    v_pk_fma_f32 v[146:147], v[146:147], v[50:51], v[50:51] op_sel:[0,1,1] op_sel_hi:[1,1,1]
    v_pk_fma_f32 v[148:149], v[148:149], v[50:51], v[50:51] op_sel:[0,1,1] op_sel_hi:[1,1,1]
    v_pk_fma_f32 v[150:151], v[150:151], v[50:51], v[50:51] op_sel:[0,1,1] op_sel_hi:[1,1,1]
    v_rcp_f32 v144, v144
    v_rcp_f32 v145, v145
    v_rcp_f32 v146, v146
    v_rcp_f32 v147, v147
    v_rcp_f32 v148, v148
    v_rcp_f32 v149, v149
    v_rcp_f32 v150, v150
    v_rcp_f32 v151, v151
    v_pk_mul_f32 v[144:145], v[144:145], v[152:153]
    v_pk_mul_f32 v[146:147], v[146:147], v[154:155]
    v_pk_mul_f32 v[148:149], v[148:149], v[156:157]
    v_pk_mul_f32 v[150:151], v[150:151], v[158:159]
    v_cvt_pk_bf16_f32 v152, v144, v145
    v_cvt_pk_bf16_f32 v153, v146, v147
    v_cvt_pk_bf16_f32 v154, v148, v149
    v_cvt_pk_bf16_f32 v155, v150, v151
    buffer_store_dwordx4 v[152:155], v1, s[56:59], s70 offen sc1
    s_add_u32 s70, s70, 55296
    v_pk_fma_f32 v[160:161], v[112:113], v[52:53], v[160:161] op_sel_hi:[1,0,1] neg_lo:[0,1,0] neg_hi:[0,1,0]
    v_pk_fma_f32 v[162:163], v[114:115], v[52:53], v[162:163] op_sel_hi:[1,0,1] neg_lo:[0,1,0] neg_hi:[0,1,0]
    v_pk_fma_f32 v[164:165], v[116:117], v[52:53], v[164:165] op_sel_hi:[1,0,1] neg_lo:[0,1,0] neg_hi:[0,1,0]
    v_pk_fma_f32 v[166:167], v[118:119], v[52:53], v[166:167] op_sel_hi:[1,0,1] neg_lo:[0,1,0] neg_hi:[0,1,0]
    v_pk_fma_f32 v[168:169], v[120:121], v[52:53], v[168:169] op_sel_hi:[1,0,1] neg_lo:[0,1,0] neg_hi:[0,1,0]
    v_pk_fma_f32 v[170:171], v[122:123], v[52:53], v[170:171] op_sel_hi:[1,0,1] neg_lo:[0,1,0] neg_hi:[0,1,0]
    v_pk_fma_f32 v[172:173], v[124:125], v[52:53], v[172:173] op_sel_hi:[1,0,1] neg_lo:[0,1,0] neg_hi:[0,1,0]
    v_pk_fma_f32 v[174:175], v[126:127], v[52:53], v[174:175] op_sel_hi:[1,0,1] neg_lo:[0,1,0] neg_hi:[0,1,0]
    v_pk_mul_f32 v[160:161], v[160:161], v[4:5] op_sel_hi:[1,0]
    v_pk_mul_f32 v[162:163], v[162:163], v[4:5] op_sel_hi:[1,0]
    v_pk_mul_f32 v[164:165], v[164:165], v[4:5] op_sel_hi:[1,0]
    v_pk_mul_f32 v[166:167], v[166:167], v[4:5] op_sel_hi:[1,0]
    v_exp_f32 v160, v160
    v_exp_f32 v161, v161
    v_exp_f32 v162, v162
    v_exp_f32 v163, v163
    v_exp_f32 v164, v164
    v_exp_f32 v165, v165
    v_exp_f32 v166, v166
    v_exp_f32 v167, v167
    v_pk_fma_f32 v[160:161], v[160:161], v[52:53], v[52:53] op_sel:[0,1,1] op_sel_hi:[1,1,1]
    v_pk_fma_f32 v[162:163], v[162:163], v[52:53], v[52:53] op_sel:[0,1,1] op_sel_hi:[1,1,1]
    v_pk_fma_f32 v[164:165], v[164:165], v[52:53], v[52:53] op_sel:[0,1,1] op_sel_hi:[1,1,1]
    v_pk_fma_f32 v[166:167], v[166:167], v[52:53], v[52:53] op_sel:[0,1,1] op_sel_hi:[1,1,1]
    v_rcp_f32 v160, v160
    v_rcp_f32 v161, v161
    v_rcp_f32 v162, v162
    v_rcp_f32 v163, v163
    v_rcp_f32 v164, v164
    v_rcp_f32 v165, v165
    v_rcp_f32 v166, v166
    v_rcp_f32 v167, v167
    v_pk_mul_f32 v[160:161], v[160:161], v[168:169]
    v_pk_mul_f32 v[162:163], v[162:163], v[170:171]
    v_pk_mul_f32 v[164:165], v[164:165], v[172:173]
    v_pk_mul_f32 v[166:167], v[166:167], v[174:175]
    v_cvt_pk_bf16_f32 v168, v160, v161
    v_cvt_pk_bf16_f32 v169, v162, v163
    v_cvt_pk_bf16_f32 v170, v164, v165
    v_cvt_pk_bf16_f32 v171, v166, v167
    buffer_store_dwordx4 v[168:171], v1, s[56:59], s70 offen sc1
    s_add_u32 s70, s70, 55296
    v_pk_fma_f32 v[176:177], v[112:113], v[54:55], v[176:177] op_sel_hi:[1,0,1] neg_lo:[0,1,0] neg_hi:[0,1,0]
    v_pk_fma_f32 v[178:179], v[114:115], v[54:55], v[178:179] op_sel_hi:[1,0,1] neg_lo:[0,1,0] neg_hi:[0,1,0]
    v_pk_fma_f32 v[180:181], v[116:117], v[54:55], v[180:181] op_sel_hi:[1,0,1] neg_lo:[0,1,0] neg_hi:[0,1,0]
    v_pk_fma_f32 v[182:183], v[118:119], v[54:55], v[182:183] op_sel_hi:[1,0,1] neg_lo:[0,1,0] neg_hi:[0,1,0]
    v_pk_fma_f32 v[184:185], v[120:121], v[54:55], v[184:185] op_sel_hi:[1,0,1] neg_lo:[0,1,0] neg_hi:[0,1,0]
    v_pk_fma_f32 v[186:187], v[122:123], v[54:55], v[186:187] op_sel_hi:[1,0,1] neg_lo:[0,1,0] neg_hi:[0,1,0]
    v_pk_fma_f32 v[188:189], v[124:125], v[54:55], v[188:189] op_sel_hi:[1,0,1] neg_lo:[0,1,0] neg_hi:[0,1,0]
    v_pk_fma_f32 v[190:191], v[126:127], v[54:55], v[190:191] op_sel_hi:[1,0,1] neg_lo:[0,1,0] neg_hi:[0,1,0]
    v_pk_mul_f32 v[176:177], v[176:177], v[4:5] op_sel:[0,1] op_sel_hi:[1,1]
    v_pk_mul_f32 v[178:179], v[178:179], v[4:5] op_sel:[0,1] op_sel_hi:[1,1]
    v_pk_mul_f32 v[180:181], v[180:181], v[4:5] op_sel:[0,1] op_sel_hi:[1,1]
    v_pk_mul_f32 v[182:183], v[182:183], v[4:5] op_sel:[0,1] op_sel_hi:[1,1]
    v_exp_f32 v176, v176
    v_exp_f32 v177, v177
    v_exp_f32 v178, v178
    v_exp_f32 v179, v179
    v_exp_f32 v180, v180
    v_exp_f32 v181, v181
    v_exp_f32 v182, v182
    v_exp_f32 v183, v183
    v_pk_fma_f32 v[176:177], v[176:177], v[54:55], v[54:55] op_sel:[0,1,1] op_sel_hi:[1,1,1]
    v_pk_fma_f32 v[178:179], v[178:179], v[54:55], v[54:55] op_sel:[0,1,1] op_sel_hi:[1,1,1]
    v_pk_fma_f32 v[180:181], v[180:181], v[54:55], v[54:55] op_sel:[0,1,1] op_sel_hi:[1,1,1]
    v_pk_fma_f32 v[182:183], v[182:183], v[54:55], v[54:55] op_sel:[0,1,1] op_sel_hi:[1,1,1]
    v_rcp_f32 v176, v176
    v_rcp_f32 v177, v177
    v_rcp_f32 v178, v178
    v_rcp_f32 v179, v179
    v_rcp_f32 v180, v180
    v_rcp_f32 v181, v181
    v_rcp_f32 v182, v182
    v_rcp_f32 v183, v183
    v_pk_mul_f32 v[176:177], v[176:177], v[184:185]
    v_pk_mul_f32 v[178:179], v[178:179], v[186:187]
    v_pk_mul_f32 v[180:181], v[180:181], v[188:189]
    v_pk_mul_f32 v[182:183], v[182:183], v[190:191]
    v_cvt_pk_bf16_f32 v184, v176, v177
    v_cvt_pk_bf16_f32 v185, v178, v179
    v_cvt_pk_bf16_f32 v186, v180, v181
    v_cvt_pk_bf16_f32 v187, v182, v183
    buffer_store_dwordx4 v[184:187], v1, s[56:59], s70 offen sc1
    s_add_u32 s70, s70, 55296
    v_pk_fma_f32 v[192:193], v[112:113], v[56:57], v[192:193] op_sel_hi:[1,0,1] neg_lo:[0,1,0] neg_hi:[0,1,0]
    v_pk_fma_f32 v[194:195], v[114:115], v[56:57], v[194:195] op_sel_hi:[1,0,1] neg_lo:[0,1,0] neg_hi:[0,1,0]
    v_pk_fma_f32 v[196:197], v[116:117], v[56:57], v[196:197] op_sel_hi:[1,0,1] neg_lo:[0,1,0] neg_hi:[0,1,0]
    v_pk_fma_f32 v[198:199], v[118:119], v[56:57], v[198:199] op_sel_hi:[1,0,1] neg_lo:[0,1,0] neg_hi:[0,1,0]
    v_pk_fma_f32 v[200:201], v[120:121], v[56:57], v[200:201] op_sel_hi:[1,0,1] neg_lo:[0,1,0] neg_hi:[0,1,0]
    v_pk_fma_f32 v[202:203], v[122:123], v[56:57], v[202:203] op_sel_hi:[1,0,1] neg_lo:[0,1,0] neg_hi:[0,1,0]
    v_pk_fma_f32 v[204:205], v[124:125], v[56:57], v[204:205] op_sel_hi:[1,0,1] neg_lo:[0,1,0] neg_hi:[0,1,0]
    v_pk_fma_f32 v[206:207], v[126:127], v[56:57], v[206:207] op_sel_hi:[1,0,1] neg_lo:[0,1,0] neg_hi:[0,1,0]
    v_pk_mul_f32 v[192:193], v[192:193], v[6:7] op_sel_hi:[1,0]
    v_pk_mul_f32 v[194:195], v[194:195], v[6:7] op_sel_hi:[1,0]
    v_pk_mul_f32 v[196:197], v[196:197], v[6:7] op_sel_hi:[1,0]
    v_pk_mul_f32 v[198:199], v[198:199], v[6:7] op_sel_hi:[1,0]
    v_exp_f32 v192, v192
    v_exp_f32 v193, v193
    v_exp_f32 v194, v194
    v_exp_f32 v195, v195
    v_exp_f32 v196, v196
    v_exp_f32 v197, v197
    v_exp_f32 v198, v198
    v_exp_f32 v199, v199
    v_pk_fma_f32 v[192:193], v[192:193], v[56:57], v[56:57] op_sel:[0,1,1] op_sel_hi:[1,1,1]
    v_pk_fma_f32 v[194:195], v[194:195], v[56:57], v[56:57] op_sel:[0,1,1] op_sel_hi:[1,1,1]
    v_pk_fma_f32 v[196:197], v[196:197], v[56:57], v[56:57] op_sel:[0,1,1] op_sel_hi:[1,1,1]
    v_pk_fma_f32 v[198:199], v[198:199], v[56:57], v[56:57] op_sel:[0,1,1] op_sel_hi:[1,1,1]
    v_rcp_f32 v192, v192
    v_rcp_f32 v193, v193
    v_rcp_f32 v194, v194
    v_rcp_f32 v195, v195
    v_rcp_f32 v196, v196
    v_rcp_f32 v197, v197
    v_rcp_f32 v198, v198
    v_rcp_f32 v199, v199
    v_pk_mul_f32 v[192:193], v[192:193], v[200:201]
    v_pk_mul_f32 v[194:195], v[194:195], v[202:203]
    v_pk_mul_f32 v[196:197], v[196:197], v[204:205]
    v_pk_mul_f32 v[198:199], v[198:199], v[206:207]
    v_cvt_pk_bf16_f32 v200, v192, v193
    v_cvt_pk_bf16_f32 v201, v194, v195
    v_cvt_pk_bf16_f32 v202, v196, v197
    v_cvt_pk_bf16_f32 v203, v198, v199
    buffer_store_dwordx4 v[200:203], v1, s[56:59], s70 offen sc1
    s_add_u32 s70, s70, 55296
    v_pk_fma_f32 v[208:209], v[112:113], v[58:59], v[208:209] op_sel_hi:[1,0,1] neg_lo:[0,1,0] neg_hi:[0,1,0]
    v_pk_fma_f32 v[210:211], v[114:115], v[58:59], v[210:211] op_sel_hi:[1,0,1] neg_lo:[0,1,0] neg_hi:[0,1,0]
    v_pk_fma_f32 v[212:213], v[116:117], v[58:59], v[212:213] op_sel_hi:[1,0,1] neg_lo:[0,1,0] neg_hi:[0,1,0]
    v_pk_fma_f32 v[214:215], v[118:119], v[58:59], v[214:215] op_sel_hi:[1,0,1] neg_lo:[0,1,0] neg_hi:[0,1,0]
    v_pk_fma_f32 v[216:217], v[120:121], v[58:59], v[216:217] op_sel_hi:[1,0,1] neg_lo:[0,1,0] neg_hi:[0,1,0]
    v_pk_fma_f32 v[218:219], v[122:123], v[58:59], v[218:219] op_sel_hi:[1,0,1] neg_lo:[0,1,0] neg_hi:[0,1,0]
    v_pk_fma_f32 v[220:221], v[124:125], v[58:59], v[220:221] op_sel_hi:[1,0,1] neg_lo:[0,1,0] neg_hi:[0,1,0]
    v_pk_fma_f32 v[222:223], v[126:127], v[58:59], v[222:223] op_sel_hi:[1,0,1] neg_lo:[0,1,0] neg_hi:[0,1,0]
    v_pk_mul_f32 v[208:209], v[208:209], v[6:7] op_sel:[0,1] op_sel_hi:[1,1]
    v_pk_mul_f32 v[210:211], v[210:211], v[6:7] op_sel:[0,1] op_sel_hi:[1,1]
    v_pk_mul_f32 v[212:213], v[212:213], v[6:7] op_sel:[0,1] op_sel_hi:[1,1]
    v_pk_mul_f32 v[214:215], v[214:215], v[6:7] op_sel:[0,1] op_sel_hi:[1,1]
    v_exp_f32 v208, v208
    v_exp_f32 v209, v209
    v_exp_f32 v210, v210
    v_exp_f32 v211, v211
    v_exp_f32 v212, v212
    v_exp_f32 v213, v213
    v_exp_f32 v214, v214
    v_exp_f32 v215, v215
    v_pk_fma_f32 v[208:209], v[208:209], v[58:59], v[58:59] op_sel:[0,1,1] op_sel_hi:[1,1,1]
    v_pk_fma_f32 v[210:211], v[210:211], v[58:59], v[58:59] op_sel:[0,1,1] op_sel_hi:[1,1,1]
    v_pk_fma_f32 v[212:213], v[212:213], v[58:59], v[58:59] op_sel:[0,1,1] op_sel_hi:[1,1,1]
    v_pk_fma_f32 v[214:215], v[214:215], v[58:59], v[58:59] op_sel:[0,1,1] op_sel_hi:[1,1,1]
    v_rcp_f32 v208, v208
    v_rcp_f32 v209, v209
    v_rcp_f32 v210, v210
    v_rcp_f32 v211, v211
    v_rcp_f32 v212, v212
    v_rcp_f32 v213, v213
    v_rcp_f32 v214, v214
    v_rcp_f32 v215, v215
    v_pk_mul_f32 v[208:209], v[208:209], v[216:217]
    v_pk_mul_f32 v[210:211], v[210:211], v[218:219]
    v_pk_mul_f32 v[212:213], v[212:213], v[220:221]
    v_pk_mul_f32 v[214:215], v[214:215], v[222:223]
    v_cvt_pk_bf16_f32 v216, v208, v209
    v_cvt_pk_bf16_f32 v217, v210, v211
    v_cvt_pk_bf16_f32 v218, v212, v213
    v_cvt_pk_bf16_f32 v219, v214, v215
    buffer_store_dwordx4 v[216:219], v1, s[56:59], s70 offen sc1
    s_add_u32 s70, s70, 55296
    v_pk_fma_f32 v[224:225], v[112:113], v[60:61], v[224:225] op_sel_hi:[1,0,1] neg_lo:[0,1,0] neg_hi:[0,1,0]
    v_pk_fma_f32 v[226:227], v[114:115], v[60:61], v[226:227] op_sel_hi:[1,0,1] neg_lo:[0,1,0] neg_hi:[0,1,0]
    v_pk_fma_f32 v[228:229], v[116:117], v[60:61], v[228:229] op_sel_hi:[1,0,1] neg_lo:[0,1,0] neg_hi:[0,1,0]
    v_pk_fma_f32 v[230:231], v[118:119], v[60:61], v[230:231] op_sel_hi:[1,0,1] neg_lo:[0,1,0] neg_hi:[0,1,0]
    v_pk_fma_f32 v[232:233], v[120:121], v[60:61], v[232:233] op_sel_hi:[1,0,1] neg_lo:[0,1,0] neg_hi:[0,1,0]
    v_pk_fma_f32 v[234:235], v[122:123], v[60:61], v[234:235] op_sel_hi:[1,0,1] neg_lo:[0,1,0] neg_hi:[0,1,0]
    v_pk_fma_f32 v[236:237], v[124:125], v[60:61], v[236:237] op_sel_hi:[1,0,1] neg_lo:[0,1,0] neg_hi:[0,1,0]
    v_pk_fma_f32 v[238:239], v[126:127], v[60:61], v[238:239] op_sel_hi:[1,0,1] neg_lo:[0,1,0] neg_hi:[0,1,0]
    v_pk_mul_f32 v[224:225], v[224:225], v[8:9] op_sel_hi:[1,0]
    v_pk_mul_f32 v[226:227], v[226:227], v[8:9] op_sel_hi:[1,0]
    v_pk_mul_f32 v[228:229], v[228:229], v[8:9] op_sel_hi:[1,0]
    v_pk_mul_f32 v[230:231], v[230:231], v[8:9] op_sel_hi:[1,0]
    v_exp_f32 v224, v224
    v_exp_f32 v225, v225
    v_exp_f32 v226, v226
    v_exp_f32 v227, v227
    v_exp_f32 v228, v228
    v_exp_f32 v229, v229
    v_exp_f32 v230, v230
    v_exp_f32 v231, v231
    v_pk_fma_f32 v[224:225], v[224:225], v[60:61], v[60:61] op_sel:[0,1,1] op_sel_hi:[1,1,1]
    v_pk_fma_f32 v[226:227], v[226:227], v[60:61], v[60:61] op_sel:[0,1,1] op_sel_hi:[1,1,1]
    v_pk_fma_f32 v[228:229], v[228:229], v[60:61], v[60:61] op_sel:[0,1,1] op_sel_hi:[1,1,1]
    v_pk_fma_f32 v[230:231], v[230:231], v[60:61], v[60:61] op_sel:[0,1,1] op_sel_hi:[1,1,1]
    v_rcp_f32 v224, v224
    v_rcp_f32 v225, v225
    v_rcp_f32 v226, v226
    v_rcp_f32 v227, v227
    v_rcp_f32 v228, v228
    v_rcp_f32 v229, v229
    v_rcp_f32 v230, v230
    v_rcp_f32 v231, v231
    v_pk_mul_f32 v[224:225], v[224:225], v[232:233]
    v_pk_mul_f32 v[226:227], v[226:227], v[234:235]
    v_pk_mul_f32 v[228:229], v[228:229], v[236:237]
    v_pk_mul_f32 v[230:231], v[230:231], v[238:239]
    v_cvt_pk_bf16_f32 v232, v224, v225
    v_cvt_pk_bf16_f32 v233, v226, v227
    v_cvt_pk_bf16_f32 v234, v228, v229
    v_cvt_pk_bf16_f32 v235, v230, v231
    buffer_store_dwordx4 v[232:235], v1, s[56:59], s70 offen sc1
    s_add_u32 s70, s70, 55296
    v_pk_fma_f32 v[240:241], v[112:113], v[62:63], v[240:241] op_sel_hi:[1,0,1] neg_lo:[0,1,0] neg_hi:[0,1,0]
    v_pk_fma_f32 v[242:243], v[114:115], v[62:63], v[242:243] op_sel_hi:[1,0,1] neg_lo:[0,1,0] neg_hi:[0,1,0]
    v_pk_fma_f32 v[244:245], v[116:117], v[62:63], v[244:245] op_sel_hi:[1,0,1] neg_lo:[0,1,0] neg_hi:[0,1,0]
    v_pk_fma_f32 v[246:247], v[118:119], v[62:63], v[246:247] op_sel_hi:[1,0,1] neg_lo:[0,1,0] neg_hi:[0,1,0]
    v_pk_fma_f32 v[248:249], v[120:121], v[62:63], v[248:249] op_sel_hi:[1,0,1] neg_lo:[0,1,0] neg_hi:[0,1,0]
    v_pk_fma_f32 v[250:251], v[122:123], v[62:63], v[250:251] op_sel_hi:[1,0,1] neg_lo:[0,1,0] neg_hi:[0,1,0]
    v_pk_fma_f32 v[252:253], v[124:125], v[62:63], v[252:253] op_sel_hi:[1,0,1] neg_lo:[0,1,0] neg_hi:[0,1,0]
    v_pk_fma_f32 v[254:255], v[126:127], v[62:63], v[254:255] op_sel_hi:[1,0,1] neg_lo:[0,1,0] neg_hi:[0,1,0]
    v_pk_mul_f32 v[240:241], v[240:241], v[8:9] op_sel:[0,1] op_sel_hi:[1,1]
    v_pk_mul_f32 v[242:243], v[242:243], v[8:9] op_sel:[0,1] op_sel_hi:[1,1]
    v_pk_mul_f32 v[244:245], v[244:245], v[8:9] op_sel:[0,1] op_sel_hi:[1,1]
    v_pk_mul_f32 v[246:247], v[246:247], v[8:9] op_sel:[0,1] op_sel_hi:[1,1]
    v_exp_f32 v240, v240
    v_exp_f32 v241, v241
    v_exp_f32 v242, v242
    v_exp_f32 v243, v243
    v_exp_f32 v244, v244
    v_exp_f32 v245, v245
    v_exp_f32 v246, v246
    v_exp_f32 v247, v247
    v_pk_fma_f32 v[240:241], v[240:241], v[62:63], v[62:63] op_sel:[0,1,1] op_sel_hi:[1,1,1]
    v_pk_fma_f32 v[242:243], v[242:243], v[62:63], v[62:63] op_sel:[0,1,1] op_sel_hi:[1,1,1]
    v_pk_fma_f32 v[244:245], v[244:245], v[62:63], v[62:63] op_sel:[0,1,1] op_sel_hi:[1,1,1]
    v_pk_fma_f32 v[246:247], v[246:247], v[62:63], v[62:63] op_sel:[0,1,1] op_sel_hi:[1,1,1]
    v_rcp_f32 v240, v240
    v_rcp_f32 v241, v241
    v_rcp_f32 v242, v242
    v_rcp_f32 v243, v243
    v_rcp_f32 v244, v244
    v_rcp_f32 v245, v245
    v_rcp_f32 v246, v246
    v_rcp_f32 v247, v247
    v_pk_mul_f32 v[240:241], v[240:241], v[248:249]
    v_pk_mul_f32 v[242:243], v[242:243], v[250:251]
    v_pk_mul_f32 v[244:245], v[244:245], v[252:253]
    v_pk_mul_f32 v[246:247], v[246:247], v[254:255]
    v_cvt_pk_bf16_f32 v248, v240, v241
    v_cvt_pk_bf16_f32 v249, v242, v243
    v_cvt_pk_bf16_f32 v250, v244, v245
    v_cvt_pk_bf16_f32 v251, v246, v247
    buffer_store_dwordx4 v[248:251], v1, s[56:59], s70 offen sc1
L_last:
Lst_2565:
    s_cbranch_execz Lst_3369
    s_nop 0
    s_bitcmp1_b32 s3, 0
    s_cbranch_scc1 LG_H
    v_mov_b32 v200, 0x3f803f80
    v_mov_b32_e64 v201, 0
    v_cvt_pk_bf16_f32 v202, v32, v33
    v_cvt_pk_bf16_f32 v203, v34, v35
    v_pk_mul_f32 v[196:197], v[32:33], v[32:33]
    v_pk_mul_f32 v[198:199], v[32:33], v[34:35]
    v_pk_fma_f32 v[192:193], v[34:35], v[34:35], v[196:197] neg_lo:[1,0,0] neg_hi:[1,0,0]
    v_pk_fma_f32 v[194:195], v[34:35], v[32:33], v[198:199]
    ds_write2_b64 v15, v[200:201], v[202:203] offset0:0 offset1:66
    s_mul_i32 s85, s22, 5
    s_add_u32 s85, s85, s83
    v_cvt_pk_bf16_f32 v204, v192, v193
    v_cvt_pk_bf16_f32 v205, v194, v195
    v_pk_mul_f32 v[196:197], v[192:193], v[32:33]
    v_pk_mul_f32 v[198:199], v[192:193], v[34:35]
    v_pk_fma_f32 v[192:193], v[194:195], v[34:35], v[196:197] neg_lo:[1,0,0] neg_hi:[1,0,0]
    v_pk_fma_f32 v[194:195], v[194:195], v[32:33], v[198:199]
    v_cvt_pk_bf16_f32 v206, v192, v193
    v_cvt_pk_bf16_f32 v207, v194, v195
    v_pk_mul_f32 v[196:197], v[192:193], v[32:33]
    v_pk_mul_f32 v[198:199], v[192:193], v[34:35]
    v_pk_fma_f32 v[192:193], v[194:195], v[34:35], v[196:197] neg_lo:[1,0,0] neg_hi:[1,0,0]
    v_pk_fma_f32 v[194:195], v[194:195], v[32:33], v[198:199]
    ds_write2_b64 v15, v[204:205], v[206:207] offset0:132 offset1:198
    buffer_load_dwordx4 a[120:123], v1, s[56:59], s85 offen offset:0 sc1
    buffer_load_dwordx4 a[124:127], v1, s[56:59], s85 offen offset:1024 sc1
    v_add_u32 v15, 2112, v15
    v_cvt_pk_bf16_f32 v200, v192, v193
    v_cvt_pk_bf16_f32 v201, v194, v195
    v_pk_mul_f32 v[196:197], v[192:193], v[32:33]
    v_pk_mul_f32 v[198:199], v[192:193], v[34:35]
    v_pk_fma_f32 v[192:193], v[194:195], v[34:35], v[196:197] neg_lo:[1,0,0] neg_hi:[1,0,0]
    v_pk_fma_f32 v[194:195], v[194:195], v[32:33], v[198:199]
    v_cvt_pk_bf16_f32 v202, v192, v193
    v_cvt_pk_bf16_f32 v203, v194, v195
    v_pk_mul_f32 v[196:197], v[192:193], v[32:33]
    v_pk_mul_f32 v[198:199], v[192:193], v[34:35]
    v_pk_fma_f32 v[192:193], v[194:195], v[34:35], v[196:197] neg_lo:[1,0,0] neg_hi:[1,0,0]
    v_pk_fma_f32 v[194:195], v[194:195], v[32:33], v[198:199]
    ds_write2_b64 v15, v[200:201], v[202:203] offset0:0 offset1:66
    buffer_load_dwordx4 a[128:131], v1, s[56:59], s85 offen offset:2048 sc1
    v_cvt_pk_bf16_f32 v204, v192, v193
    v_cvt_pk_bf16_f32 v205, v194, v195
    v_pk_mul_f32 v[196:197], v[192:193], v[32:33]
    v_pk_mul_f32 v[198:199], v[192:193], v[34:35]
    v_pk_fma_f32 v[192:193], v[194:195], v[34:35], v[196:197] neg_lo:[1,0,0] neg_hi:[1,0,0]
    v_pk_fma_f32 v[194:195], v[194:195], v[32:33], v[198:199]
    v_cvt_pk_bf16_f32 v206, v192, v193
    v_cvt_pk_bf16_f32 v207, v194, v195
    v_pk_mul_f32 v[196:197], v[192:193], v[32:33]
    v_pk_mul_f32 v[198:199], v[192:193], v[34:35]
    v_pk_fma_f32 v[192:193], v[194:195], v[34:35], v[196:197] neg_lo:[1,0,0] neg_hi:[1,0,0]
    v_pk_fma_f32 v[194:195], v[194:195], v[32:33], v[198:199]
    ds_write2_b64 v15, v[204:205], v[206:207] offset0:132 offset1:198
    buffer_load_dwordx4 a[132:135], v1, s[56:59], s85 offen offset:3072 sc1
    s_add_u32 s85, s85, 4096
    v_add_u32 v15, 2112, v15
    v_cvt_pk_bf16_f32 v200, v192, v193
    v_cvt_pk_bf16_f32 v201, v194, v195
    v_pk_mul_f32 v[196:197], v[192:193], v[32:33]
    v_pk_mul_f32 v[198:199], v[192:193], v[34:35]
    v_pk_fma_f32 v[192:193], v[194:195], v[34:35], v[196:197] neg_lo:[1,0,0] neg_hi:[1,0,0]
    v_pk_fma_f32 v[194:195], v[194:195], v[32:33], v[198:199]
    v_cvt_pk_bf16_f32 v202, v192, v193
    v_cvt_pk_bf16_f32 v203, v194, v195
    v_pk_mul_f32 v[196:197], v[192:193], v[32:33]
    v_pk_mul_f32 v[198:199], v[192:193], v[34:35]
    v_pk_fma_f32 v[192:193], v[194:195], v[34:35], v[196:197] neg_lo:[1,0,0] neg_hi:[1,0,0]
    v_pk_fma_f32 v[194:195], v[194:195], v[32:33], v[198:199]
    ds_write2_b64 v15, v[200:201], v[202:203] offset0:0 offset1:66
    buffer_load_dwordx4 a[136:139], v1, s[56:59], s85 offen offset:0 sc1
    v_cvt_pk_bf16_f32 v204, v192, v193
    v_cvt_pk_bf16_f32 v205, v194, v195
    v_pk_mul_f32 v[196:197], v[192:193], v[32:33]
    v_pk_mul_f32 v[198:199], v[192:193], v[34:35]
    v_pk_fma_f32 v[192:193], v[194:195], v[34:35], v[196:197] neg_lo:[1,0,0] neg_hi:[1,0,0]
    v_pk_fma_f32 v[194:195], v[194:195], v[32:33], v[198:199]
    v_cvt_pk_bf16_f32 v206, v192, v193
    v_cvt_pk_bf16_f32 v207, v194, v195
    v_pk_mul_f32 v[196:197], v[192:193], v[32:33]
    v_pk_mul_f32 v[198:199], v[192:193], v[34:35]
    v_pk_fma_f32 v[192:193], v[194:195], v[34:35], v[196:197] neg_lo:[1,0,0] neg_hi:[1,0,0]
    v_pk_fma_f32 v[194:195], v[194:195], v[32:33], v[198:199]
    ds_write2_b64 v15, v[204:205], v[206:207] offset0:132 offset1:198
    s_mul_i32 s85, s23, 5
    s_add_u32 s85, s85, s83
    v_add_u32 v15, 2112, v15
    v_cvt_pk_bf16_f32 v200, v192, v193
    v_cvt_pk_bf16_f32 v201, v194, v195
    v_pk_mul_f32 v[196:197], v[192:193], v[32:33]
    v_pk_mul_f32 v[198:199], v[192:193], v[34:35]
    v_pk_fma_f32 v[192:193], v[194:195], v[34:35], v[196:197] neg_lo:[1,0,0] neg_hi:[1,0,0]
    v_pk_fma_f32 v[194:195], v[194:195], v[32:33], v[198:199]
    v_cvt_pk_bf16_f32 v202, v192, v193
    v_cvt_pk_bf16_f32 v203, v194, v195
    v_pk_mul_f32 v[196:197], v[192:193], v[32:33]
    v_pk_mul_f32 v[198:199], v[192:193], v[34:35]
    v_pk_fma_f32 v[192:193], v[194:195], v[34:35], v[196:197] neg_lo:[1,0,0] neg_hi:[1,0,0]
    v_pk_fma_f32 v[194:195], v[194:195], v[32:33], v[198:199]
    ds_write2_b64 v15, v[200:201], v[202:203] offset0:0 offset1:66
    buffer_load_dwordx4 a[140:143], v1, s[56:59], s85 offen offset:0 sc1
    v_cvt_pk_bf16_f32 v204, v192, v193
    v_cvt_pk_bf16_f32 v205, v194, v195
    v_pk_mul_f32 v[196:197], v[192:193], v[32:33]
    v_pk_mul_f32 v[198:199], v[192:193], v[34:35]
    v_pk_fma_f32 v[192:193], v[194:195], v[34:35], v[196:197] neg_lo:[1,0,0] neg_hi:[1,0,0]
    v_pk_fma_f32 v[194:195], v[194:195], v[32:33], v[198:199]
    v_cvt_pk_bf16_f32 v206, v192, v193
    v_cvt_pk_bf16_f32 v207, v194, v195
    v_pk_mul_f32 v[196:197], v[192:193], v[32:33]
    v_pk_mul_f32 v[198:199], v[192:193], v[34:35]
    v_pk_fma_f32 v[192:193], v[194:195], v[34:35], v[196:197] neg_lo:[1,0,0] neg_hi:[1,0,0]
    v_pk_fma_f32 v[194:195], v[194:195], v[32:33], v[198:199]
    ds_write2_b64 v15, v[204:205], v[206:207] offset0:132 offset1:198
    buffer_load_dwordx4 a[144:147], v1, s[56:59], s85 offen offset:1024 sc1
    buffer_load_dwordx4 a[148:151], v1, s[56:59], s85 offen offset:2048 sc1
    v_add_u32 v15, 2112, v15
    v_cvt_pk_bf16_f32 v200, v192, v193
    v_cvt_pk_bf16_f32 v201, v194, v195
    v_pk_mul_f32 v[196:197], v[192:193], v[32:33]
    v_pk_mul_f32 v[198:199], v[192:193], v[34:35]
    v_pk_fma_f32 v[192:193], v[194:195], v[34:35], v[196:197] neg_lo:[1,0,0] neg_hi:[1,0,0]
    v_pk_fma_f32 v[194:195], v[194:195], v[32:33], v[198:199]
    v_cvt_pk_bf16_f32 v202, v192, v193
    v_cvt_pk_bf16_f32 v203, v194, v195
    v_pk_mul_f32 v[196:197], v[192:193], v[32:33]
    v_pk_mul_f32 v[198:199], v[192:193], v[34:35]
    v_pk_fma_f32 v[192:193], v[194:195], v[34:35], v[196:197] neg_lo:[1,0,0] neg_hi:[1,0,0]
    v_pk_fma_f32 v[194:195], v[194:195], v[32:33], v[198:199]
    ds_write2_b64 v15, v[200:201], v[202:203] offset0:0 offset1:66
    buffer_load_dwordx4 a[152:155], v1, s[56:59], s85 offen offset:3072 sc1
    v_cvt_pk_bf16_f32 v204, v192, v193
    v_cvt_pk_bf16_f32 v205, v194, v195
    v_pk_mul_f32 v[196:197], v[192:193], v[32:33]
    v_pk_mul_f32 v[198:199], v[192:193], v[34:35]
    v_pk_fma_f32 v[192:193], v[194:195], v[34:35], v[196:197] neg_lo:[1,0,0] neg_hi:[1,0,0]
    v_pk_fma_f32 v[194:195], v[194:195], v[32:33], v[198:199]
    v_cvt_pk_bf16_f32 v206, v192, v193
    v_cvt_pk_bf16_f32 v207, v194, v195
    v_pk_mul_f32 v[196:197], v[192:193], v[32:33]
    v_pk_mul_f32 v[198:199], v[192:193], v[34:35]
    v_pk_fma_f32 v[192:193], v[194:195], v[34:35], v[196:197] neg_lo:[1,0,0] neg_hi:[1,0,0]
    v_pk_fma_f32 v[194:195], v[194:195], v[32:33], v[198:199]
    ds_write2_b64 v15, v[204:205], v[206:207] offset0:132 offset1:198
    s_add_u32 s85, s85, 4096
    buffer_load_dwordx4 a[156:159], v1, s[56:59], s85 offen offset:0 sc1
    v_add_u32 v15, 2112, v15
    v_cvt_pk_bf16_f32 v200, v192, v193
    v_cvt_pk_bf16_f32 v201, v194, v195
    v_pk_mul_f32 v[196:197], v[192:193], v[32:33]
    v_pk_mul_f32 v[198:199], v[192:193], v[34:35]
    v_pk_fma_f32 v[192:193], v[194:195], v[34:35], v[196:197] neg_lo:[1,0,0] neg_hi:[1,0,0]
    v_pk_fma_f32 v[194:195], v[194:195], v[32:33], v[198:199]
    v_cvt_pk_bf16_f32 v202, v192, v193
    v_cvt_pk_bf16_f32 v203, v194, v195
    v_pk_mul_f32 v[196:197], v[192:193], v[32:33]
    v_pk_mul_f32 v[198:199], v[192:193], v[34:35]
    v_pk_fma_f32 v[192:193], v[194:195], v[34:35], v[196:197] neg_lo:[1,0,0] neg_hi:[1,0,0]
    v_pk_fma_f32 v[194:195], v[194:195], v[32:33], v[198:199]
    ds_write2_b64 v15, v[200:201], v[202:203] offset0:0 offset1:66
    s_mul_i32 s85, s24, 5
    s_nop 0
    v_cvt_pk_bf16_f32 v204, v192, v193
    v_cvt_pk_bf16_f32 v205, v194, v195
    v_pk_mul_f32 v[196:197], v[192:193], v[32:33]
    v_pk_mul_f32 v[198:199], v[192:193], v[34:35]
    v_pk_fma_f32 v[192:193], v[194:195], v[34:35], v[196:197] neg_lo:[1,0,0] neg_hi:[1,0,0]
    v_pk_fma_f32 v[194:195], v[194:195], v[32:33], v[198:199]
    v_cvt_pk_bf16_f32 v206, v192, v193
    v_cvt_pk_bf16_f32 v207, v194, v195
    v_pk_mul_f32 v[196:197], v[192:193], v[32:33]
    v_pk_mul_f32 v[198:199], v[192:193], v[34:35]
    v_pk_fma_f32 v[192:193], v[194:195], v[34:35], v[196:197] neg_lo:[1,0,0] neg_hi:[1,0,0]
    v_pk_fma_f32 v[194:195], v[194:195], v[32:33], v[198:199]
    ds_write2_b64 v15, v[204:205], v[206:207] offset0:132 offset1:198
    s_add_u32 s85, s85, s83
    s_waitcnt vmcnt(10)
    v_add_u32 v15, 2112, v15
    v_cvt_pk_bf16_f32 v200, v192, v193
    v_cvt_pk_bf16_f32 v201, v194, v195
    v_pk_mul_f32 v[196:197], v[192:193], v[32:33]
    v_pk_mul_f32 v[198:199], v[192:193], v[34:35]
    v_pk_fma_f32 v[192:193], v[194:195], v[34:35], v[196:197] neg_lo:[1,0,0] neg_hi:[1,0,0]
    v_pk_fma_f32 v[194:195], v[194:195], v[32:33], v[198:199]
    v_cvt_pk_bf16_f32 v202, v192, v193
    v_cvt_pk_bf16_f32 v203, v194, v195
    v_pk_mul_f32 v[196:197], v[192:193], v[32:33]
    v_pk_mul_f32 v[198:199], v[192:193], v[34:35]
    v_pk_fma_f32 v[192:193], v[194:195], v[34:35], v[196:197] neg_lo:[1,0,0] neg_hi:[1,0,0]
    v_pk_fma_f32 v[194:195], v[194:195], v[32:33], v[198:199]
    ds_write2_b64 v15, v[200:201], v[202:203] offset0:0 offset1:66
    v_mov_b32_e64 v13, s7
    v_cvt_pk_bf16_f32 v204, v192, v193
    v_cvt_pk_bf16_f32 v205, v194, v195
    v_pk_mul_f32 v[196:197], v[192:193], v[32:33]
    v_pk_mul_f32 v[198:199], v[192:193], v[34:35]
    v_pk_fma_f32 v[192:193], v[194:195], v[34:35], v[196:197] neg_lo:[1,0,0] neg_hi:[1,0,0]
    v_pk_fma_f32 v[194:195], v[194:195], v[32:33], v[198:199]
    v_cvt_pk_bf16_f32 v206, v192, v193
    v_cvt_pk_bf16_f32 v207, v194, v195
    v_pk_mul_f32 v[196:197], v[192:193], v[32:33]
    v_pk_mul_f32 v[198:199], v[192:193], v[34:35]
    v_pk_fma_f32 v[192:193], v[194:195], v[34:35], v[196:197] neg_lo:[1,0,0] neg_hi:[1,0,0]
    v_pk_fma_f32 v[194:195], v[194:195], v[32:33], v[198:199]
    ds_write2_b64 v15, v[204:205], v[206:207] offset0:132 offset1:198
    s_mov_b64 exec, 1
    buffer_store_dword v13, off, s[56:59], s39 sc1
    s_mov_b64 exec, -1
    buffer_load_dwordx4 a[160:163], v1, s[56:59], s85 offen offset:0 sc1
    v_add_u32 v15, 2112, v15
    v_cvt_pk_bf16_f32 v200, v192, v193
    v_cvt_pk_bf16_f32 v201, v194, v195
    v_pk_mul_f32 v[196:197], v[192:193], v[32:33]
    v_pk_mul_f32 v[198:199], v[192:193], v[34:35]
    v_pk_fma_f32 v[192:193], v[194:195], v[34:35], v[196:197] neg_lo:[1,0,0] neg_hi:[1,0,0]
    v_pk_fma_f32 v[194:195], v[194:195], v[32:33], v[198:199]
    v_cvt_pk_bf16_f32 v202, v192, v193
    v_cvt_pk_bf16_f32 v203, v194, v195
    v_pk_mul_f32 v[196:197], v[192:193], v[32:33]
    v_pk_mul_f32 v[198:199], v[192:193], v[34:35]
    v_pk_fma_f32 v[192:193], v[194:195], v[34:35], v[196:197] neg_lo:[1,0,0] neg_hi:[1,0,0]
    v_pk_fma_f32 v[194:195], v[194:195], v[32:33], v[198:199]
    ds_write2_b64 v15, v[200:201], v[202:203] offset0:0 offset1:66
    buffer_load_dwordx4 a[164:167], v1, s[56:59], s85 offen offset:1024 sc1
    v_cvt_pk_bf16_f32 v204, v192, v193
    v_cvt_pk_bf16_f32 v205, v194, v195
    v_pk_mul_f32 v[196:197], v[192:193], v[32:33]
    v_pk_mul_f32 v[198:199], v[192:193], v[34:35]
    v_pk_fma_f32 v[192:193], v[194:195], v[34:35], v[196:197] neg_lo:[1,0,0] neg_hi:[1,0,0]
Lst_2799:
    s_cbranch_execz Lst_3520
    s_nop 0
    v_pk_fma_f32 v[194:195], v[194:195], v[32:33], v[198:199]
    v_cvt_pk_bf16_f32 v206, v192, v193
    v_cvt_pk_bf16_f32 v207, v194, v195
    ds_write2_b64 v15, v[204:205], v[206:207] offset0:132 offset1:198
    s_branch LG_J
LG_H:
Lst_2807:
    s_cbranch_execz Lst_3837
    s_nop 0
    s_nop 0
    v_pk_mul_f32 v[192:193], v[32:33], v[32:33]
    v_pk_mul_f32 v[194:195], v[32:33], v[34:35]
    v_pk_fma_f32 v[196:197], v[34:35], v[34:35], v[192:193] neg_lo:[1,0,0] neg_hi:[1,0,0]
    v_pk_fma_f32 v[198:199], v[34:35], v[32:33], v[194:195]
    v_pk_mul_f32 v[192:193], v[40:41], v[36:37]
    v_pk_mul_f32 v[194:195], v[40:41], v[38:39]
    v_pk_fma_f32 v[220:221], v[42:43], v[38:39], v[192:193] neg_lo:[1,0,0] neg_hi:[1,0,0]
    v_pk_fma_f32 v[222:223], v[42:43], v[36:37], v[194:195]
    v_cvt_pk_bf16_f32 v234, v40, v41
    v_cvt_pk_bf16_f32 v235, -v42, -v43
    v_cvt_pk_bf16_f32 v238, v220, v221
    v_cvt_pk_bf16_f32 v239, -v222, -v223
    v_pk_mul_f32 v[192:193], v[40:41], v[32:33]
    v_pk_mul_f32 v[194:195], v[40:41], v[34:35]
    v_pk_fma_f32 v[208:209], v[42:43], v[34:35], v[192:193] neg_lo:[1,0,0] neg_hi:[1,0,0]
    v_pk_fma_f32 v[210:211], v[42:43], v[32:33], v[194:195]
    ds_write2_b64 v15, v[234:235], v[238:239] offset0:0 offset1:66
    s_mul_i32 s85, s22, 5
    s_add_u32 s85, s85, s83
    v_pk_mul_f32 v[192:193], v[196:197], v[196:197]
    v_pk_mul_f32 v[194:195], v[196:197], v[198:199]
    v_pk_fma_f32 v[200:201], v[198:199], v[198:199], v[192:193] neg_lo:[1,0,0] neg_hi:[1,0,0]
    v_pk_fma_f32 v[202:203], v[198:199], v[196:197], v[194:195]
    v_cvt_pk_bf16_f32 v232, v208, v209
    v_cvt_pk_bf16_f32 v233, -v210, -v211
    v_pk_mul_f32 v[192:193], v[208:209], v[32:33]
    v_pk_mul_f32 v[194:195], v[208:209], v[34:35]
    v_pk_fma_f32 v[208:209], v[210:211], v[34:35], v[192:193] neg_lo:[1,0,0] neg_hi:[1,0,0]
    v_pk_fma_f32 v[210:211], v[210:211], v[32:33], v[194:195]
    ds_write2_b64 v15, v[232:233], v[238:239] offset0:132 offset1:198
    buffer_load_dwordx4 a[120:123], v1, s[56:59], s85 offen offset:0 sc1
    buffer_load_dwordx4 a[124:127], v1, s[56:59], s85 offen offset:1024 sc1
    v_add_u32 v15, 2112, v15
    v_pk_mul_f32 v[192:193], v[220:221], v[196:197]
    v_pk_mul_f32 v[194:195], v[220:221], v[198:199]
    v_pk_fma_f32 v[212:213], v[222:223], v[198:199], v[192:193] neg_lo:[1,0,0] neg_hi:[1,0,0]
    v_pk_fma_f32 v[214:215], v[222:223], v[196:197], v[194:195]
    v_cvt_pk_bf16_f32 v234, v208, v209
    v_cvt_pk_bf16_f32 v235, -v210, -v211
    v_cvt_pk_bf16_f32 v236, v212, v213
    v_cvt_pk_bf16_f32 v237, -v214, -v215
    v_pk_mul_f32 v[192:193], v[208:209], v[32:33]
    v_pk_mul_f32 v[194:195], v[208:209], v[34:35]
    v_pk_fma_f32 v[208:209], v[210:211], v[34:35], v[192:193] neg_lo:[1,0,0] neg_hi:[1,0,0]
    v_pk_fma_f32 v[210:211], v[210:211], v[32:33], v[194:195]
    ds_write2_b64 v15, v[234:235], v[236:237] offset0:0 offset1:66
    buffer_load_dwordx4 a[128:131], v1, s[56:59], s85 offen offset:2048 sc1
    v_pk_mul_f32 v[192:193], v[212:213], v[196:197]
    v_pk_mul_f32 v[194:195], v[212:213], v[198:199]
    v_pk_fma_f32 v[212:213], v[214:215], v[198:199], v[192:193] neg_lo:[1,0,0] neg_hi:[1,0,0]
    v_pk_fma_f32 v[214:215], v[214:215], v[196:197], v[194:195]
    v_cvt_pk_bf16_f32 v232, v208, v209
    v_cvt_pk_bf16_f32 v233, -v210, -v211
    v_cvt_pk_bf16_f32 v238, v212, v213
    v_cvt_pk_bf16_f32 v239, -v214, -v215
    v_pk_mul_f32 v[192:193], v[208:209], v[32:33]
    v_pk_mul_f32 v[194:195], v[208:209], v[34:35]
    v_pk_fma_f32 v[208:209], v[210:211], v[34:35], v[192:193] neg_lo:[1,0,0] neg_hi:[1,0,0]
    v_pk_fma_f32 v[210:211], v[210:211], v[32:33], v[194:195]
    ds_write2_b64 v15, v[232:233], v[238:239] offset0:132 offset1:198
    buffer_load_dwordx4 a[132:135], v1, s[56:59], s85 offen offset:3072 sc1
    s_add_u32 s85, s85, 4096
    v_add_u32 v15, 2112, v15
    v_pk_mul_f32 v[192:193], v[200:201], v[200:201]
    v_pk_mul_f32 v[194:195], v[200:201], v[202:203]
    v_pk_fma_f32 v[204:205], v[202:203], v[202:203], v[192:193] neg_lo:[1,0,0] neg_hi:[1,0,0]
    v_pk_fma_f32 v[206:207], v[202:203], v[200:201], v[194:195]
    v_cvt_pk_bf16_f32 v234, v208, v209
    v_cvt_pk_bf16_f32 v235, -v210, -v211
    v_pk_mul_f32 v[192:193], v[208:209], v[32:33]
    v_pk_mul_f32 v[194:195], v[208:209], v[34:35]
    v_pk_fma_f32 v[208:209], v[210:211], v[34:35], v[192:193] neg_lo:[1,0,0] neg_hi:[1,0,0]
    v_pk_fma_f32 v[210:211], v[210:211], v[32:33], v[194:195]
    ds_write2_b64 v15, v[234:235], v[238:239] offset0:0 offset1:66
    buffer_load_dwordx4 a[136:139], v1, s[56:59], s85 offen offset:0 sc1
    s_mul_i32 s85, s23, 5
    s_nop 0
    v_pk_mul_f32 v[192:193], v[220:221], v[36:37]
    v_pk_mul_f32 v[194:195], v[220:221], v[38:39]
    v_pk_fma_f32 v[216:217], v[222:223], v[38:39], v[192:193] neg_lo:[1,0,0] neg_hi:[1,0,0]
    v_pk_fma_f32 v[218:219], v[222:223], v[36:37], v[194:195]
    v_cvt_pk_bf16_f32 v232, v208, v209
    v_cvt_pk_bf16_f32 v233, -v210, -v211
    v_pk_mul_f32 v[192:193], v[208:209], v[32:33]
    v_pk_mul_f32 v[194:195], v[208:209], v[34:35]
    v_pk_fma_f32 v[208:209], v[210:211], v[34:35], v[192:193] neg_lo:[1,0,0] neg_hi:[1,0,0]
    v_pk_fma_f32 v[210:211], v[210:211], v[32:33], v[194:195]
    ds_write2_b64 v15, v[232:233], v[238:239] offset0:132 offset1:198
    s_add_u32 s85, s85, s83
    s_nop 0
    v_add_u32 v15, 2112, v15
    v_pk_mul_f32 v[192:193], v[212:213], v[196:197]
    v_pk_mul_f32 v[194:195], v[212:213], v[198:199]
    v_pk_fma_f32 v[212:213], v[214:215], v[198:199], v[192:193] neg_lo:[1,0,0] neg_hi:[1,0,0]
    v_pk_fma_f32 v[214:215], v[214:215], v[196:197], v[194:195]
    v_cvt_pk_bf16_f32 v234, v208, v209
    v_cvt_pk_bf16_f32 v235, -v210, -v211
    v_cvt_pk_bf16_f32 v236, v212, v213
    v_cvt_pk_bf16_f32 v237, -v214, -v215
    v_pk_mul_f32 v[192:193], v[208:209], v[32:33]
    v_pk_mul_f32 v[194:195], v[208:209], v[34:35]
    v_pk_fma_f32 v[208:209], v[210:211], v[34:35], v[192:193] neg_lo:[1,0,0] neg_hi:[1,0,0]
    v_pk_fma_f32 v[210:211], v[210:211], v[32:33], v[194:195]
    ds_write2_b64 v15, v[234:235], v[236:237] offset0:0 offset1:66
    buffer_load_dwordx4 a[140:143], v1, s[56:59], s85 offen offset:0 sc1
    buffer_load_dwordx4 a[144:147], v1, s[56:59], s85 offen offset:1024 sc1
    v_pk_mul_f32 v[192:193], v[212:213], v[196:197]
    v_pk_mul_f32 v[194:195], v[212:213], v[198:199]
    v_pk_fma_f32 v[212:213], v[214:215], v[198:199], v[192:193] neg_lo:[1,0,0] neg_hi:[1,0,0]
    v_pk_fma_f32 v[214:215], v[214:215], v[196:197], v[194:195]
    v_cvt_pk_bf16_f32 v232, v208, v209
    v_cvt_pk_bf16_f32 v233, -v210, -v211
    v_cvt_pk_bf16_f32 v238, v212, v213
    v_cvt_pk_bf16_f32 v239, -v214, -v215
    ds_write2_b64 v15, v[232:233], v[238:239] offset0:132 offset1:198
    buffer_load_dwordx4 a[148:151], v1, s[56:59], s85 offen offset:2048 sc1
    buffer_load_dwordx4 a[152:155], v1, s[56:59], s85 offen offset:3072 sc1
    v_add_u32 v15, 2112, v15
    v_pk_mul_f32 v[192:193], v[216:217], v[36:37]
    v_pk_mul_f32 v[194:195], v[216:217], v[38:39]
    v_pk_fma_f32 v[220:221], v[218:219], v[38:39], v[192:193] neg_lo:[1,0,0] neg_hi:[1,0,0]
    v_pk_fma_f32 v[222:223], v[218:219], v[36:37], v[194:195]
    v_cvt_pk_bf16_f32 v234, v216, v217
    v_cvt_pk_bf16_f32 v235, -v218, -v219
    v_cvt_pk_bf16_f32 v236, v220, v221
    v_cvt_pk_bf16_f32 v237, -v222, -v223
    v_pk_mul_f32 v[192:193], v[216:217], v[200:201]
    v_pk_mul_f32 v[194:195], v[216:217], v[202:203]
    v_pk_fma_f32 v[208:209], v[218:219], v[202:203], v[192:193] neg_lo:[1,0,0] neg_hi:[1,0,0]
    v_pk_fma_f32 v[210:211], v[218:219], v[200:201], v[194:195]
    ds_write2_b64 v15, v[234:235], v[236:237] offset0:0 offset1:66
    s_add_u32 s85, s85, 4096
    v_pk_mul_f32 v[192:193], v[220:221], v[200:201]
    v_pk_mul_f32 v[194:195], v[220:221], v[202:203]
    v_pk_fma_f32 v[212:213], v[222:223], v[202:203], v[192:193] neg_lo:[1,0,0] neg_hi:[1,0,0]
    v_pk_fma_f32 v[214:215], v[222:223], v[200:201], v[194:195]
    v_cvt_pk_bf16_f32 v232, v208, v209
    v_cvt_pk_bf16_f32 v233, -v210, -v211
    v_cvt_pk_bf16_f32 v238, v212, v213
    v_cvt_pk_bf16_f32 v239, -v214, -v215
    v_pk_mul_f32 v[192:193], v[208:209], v[200:201]
    v_pk_mul_f32 v[194:195], v[208:209], v[202:203]
    v_pk_fma_f32 v[208:209], v[210:211], v[202:203], v[192:193] neg_lo:[1,0,0] neg_hi:[1,0,0]
    v_pk_fma_f32 v[210:211], v[210:211], v[200:201], v[194:195]
    ds_write2_b64 v15, v[232:233], v[238:239] offset0:132 offset1:198
    buffer_load_dwordx4 a[156:159], v1, s[56:59], s85 offen offset:0 sc1
    s_mul_i32 s85, s24, 5
    s_nop 0
    v_add_u32 v15, 2112, v15
    v_pk_mul_f32 v[192:193], v[212:213], v[200:201]
    v_pk_mul_f32 v[194:195], v[212:213], v[202:203]
    v_pk_fma_f32 v[212:213], v[214:215], v[202:203], v[192:193] neg_lo:[1,0,0] neg_hi:[1,0,0]
    v_pk_fma_f32 v[214:215], v[214:215], v[200:201], v[194:195]
    v_cvt_pk_bf16_f32 v234, v208, v209
    v_cvt_pk_bf16_f32 v235, -v210, -v211
    v_cvt_pk_bf16_f32 v236, v212, v213
    v_cvt_pk_bf16_f32 v237, -v214, -v215
    v_pk_mul_f32 v[192:193], v[220:221], v[36:37]
    v_pk_mul_f32 v[194:195], v[220:221], v[38:39]
    v_pk_fma_f32 v[216:217], v[222:223], v[38:39], v[192:193] neg_lo:[1,0,0] neg_hi:[1,0,0]
    v_pk_fma_f32 v[218:219], v[222:223], v[36:37], v[194:195]
    ds_write2_b64 v15, v[234:235], v[236:237] offset0:0 offset1:66
    s_add_u32 s85, s85, s83
    s_waitcnt vmcnt(10)
    v_pk_mul_f32 v[192:193], v[216:217], v[36:37]
    v_pk_mul_f32 v[194:195], v[216:217], v[38:39]
    v_pk_fma_f32 v[220:221], v[218:219], v[38:39], v[192:193] neg_lo:[1,0,0] neg_hi:[1,0,0]
    v_pk_fma_f32 v[222:223], v[218:219], v[36:37], v[194:195]
    v_pk_mul_f32 v[192:193], v[220:221], v[36:37]
    v_pk_mul_f32 v[194:195], v[220:221], v[38:39]
    v_pk_fma_f32 v[224:225], v[222:223], v[38:39], v[192:193] neg_lo:[1,0,0] neg_hi:[1,0,0]
    v_pk_fma_f32 v[226:227], v[222:223], v[36:37], v[194:195]
    v_cvt_pk_bf16_f32 v232, v216, v217
    v_cvt_pk_bf16_f32 v233, -v218, -v219
    v_cvt_pk_bf16_f32 v238, v224, v225
    v_cvt_pk_bf16_f32 v239, -v226, -v227
    v_pk_mul_f32 v[192:193], v[216:217], v[204:205]
    v_pk_mul_f32 v[194:195], v[216:217], v[206:207]
    v_pk_fma_f32 v[208:209], v[218:219], v[206:207], v[192:193] neg_lo:[1,0,0] neg_hi:[1,0,0]
    v_pk_fma_f32 v[210:211], v[218:219], v[204:205], v[194:195]
    ds_write2_b64 v15, v[232:233], v[238:239] offset0:132 offset1:198
    v_mov_b32_e64 v13, s7
    v_add_u32 v15, 2112, v15
    v_pk_mul_f32 v[192:193], v[224:225], v[204:205]
    v_pk_mul_f32 v[194:195], v[224:225], v[206:207]
    v_pk_fma_f32 v[212:213], v[226:227], v[206:207], v[192:193] neg_lo:[1,0,0] neg_hi:[1,0,0]
    v_pk_fma_f32 v[214:215], v[226:227], v[204:205], v[194:195]
    v_cvt_pk_bf16_f32 v234, v208, v209
    v_cvt_pk_bf16_f32 v235, -v210, -v211
    v_cvt_pk_bf16_f32 v236, v212, v213
    v_cvt_pk_bf16_f32 v237, -v214, -v215
    v_pk_mul_f32 v[192:193], v[224:225], v[36:37]
    v_pk_mul_f32 v[194:195], v[224:225], v[38:39]
    v_pk_fma_f32 v[228:229], v[226:227], v[38:39], v[192:193] neg_lo:[1,0,0] neg_hi:[1,0,0]
    v_pk_fma_f32 v[230:231], v[226:227], v[36:37], v[194:195]
    ds_write2_b64 v15, v[234:235], v[236:237] offset0:0 offset1:66
    s_mov_b64 exec, 1
    buffer_store_dword v13, off, s[56:59], s39 sc1
    s_mov_b64 exec, -1
    buffer_load_dwordx4 a[160:163], v1, s[56:59], s85 offen offset:0 sc1
    v_cvt_pk_bf16_f32 v232, v220, v221
    v_cvt_pk_bf16_f32 v233, -v222, -v223
    v_cvt_pk_bf16_f32 v238, v228, v229
    v_cvt_pk_bf16_f32 v239, -v230, -v231
    v_pk_mul_f32 v[192:193], v[220:221], v[204:205]
    v_pk_mul_f32 v[194:195], v[220:221], v[206:207]
    v_pk_fma_f32 v[208:209], v[222:223], v[206:207], v[192:193] neg_lo:[1,0,0] neg_hi:[1,0,0]
    v_pk_fma_f32 v[210:211], v[222:223], v[204:205], v[194:195]
    ds_write2_b64 v15, v[232:233], v[238:239] offset0:132 offset1:198
    buffer_load_dwordx4 a[164:167], v1, s[56:59], s85 offen offset:1024 sc1
    v_add_u32 v15, 2112, v15
    v_pk_mul_f32 v[192:193], v[228:229], v[204:205]
    v_pk_mul_f32 v[194:195], v[228:229], v[206:207]
    v_pk_fma_f32 v[212:213], v[230:231], v[206:207], v[192:193] neg_lo:[1,0,0] neg_hi:[1,0,0]
    v_pk_fma_f32 v[214:215], v[230:231], v[204:205], v[194:195]
    v_cvt_pk_bf16_f32 v234, v208, v209
    v_cvt_pk_bf16_f32 v235, -v210, -v211
    v_cvt_pk_bf16_f32 v236, v212, v213
    v_cvt_pk_bf16_f32 v237, -v214, -v215
    ds_write2_b64 v15, v[234:235], v[236:237] offset0:0 offset1:66
LG_J:
Lst_3032:
    s_cbranch_execz Lst_3965
    s_nop 0
    s_mul_i32 s85, s24, 5
    s_add_u32 s85, s85, s83
    buffer_load_dwordx4 a[168:171], v1, s[56:59], s85 offen offset:2048 sc1
    s_waitcnt lgkmcnt(0)
    s_barrier
    ds_read_b128 v[208:211], v16 offset:16896
    ds_read_b128 v[212:215], v17 offset:0
    ds_read_b128 v[216:219], v16 offset:16928
    ds_read_b128 v[220:223], v17 offset:32
    ds_read_b128 v[224:227], v16 offset:16960
    ds_read_b128 v[228:231], v17 offset:64
    ds_read_b128 v[232:235], v16 offset:16992
    ds_read_b128 v[236:239], v17 offset:96
    ds_read_b128 v[240:243], v16 offset:17024
    ds_read_b128 v[244:247], v17 offset:128
    s_mul_i32 s85, s24, 5
    s_add_u32 s85, s85, s83
    buffer_load_dwordx4 a[172:175], v1, s[56:59], s85 offen offset:3072 sc1
    s_mul_i32 s85, s24, 5
    s_add_u32 s85, s85, s83
    s_add_u32 s85, s85, 4096
    s_waitcnt lgkmcnt(8)
    v_mfma_f32_32x32x16_bf16 v[192:207], v[208:211], v[212:215], 0
    ds_read_b128 v[248:251], v16 offset:17056
    ds_read_b128 v[252:255], v17 offset:160
    buffer_load_dwordx4 a[176:179], v1, s[56:59], s85 offen offset:0 sc1
    s_mul_i32 s85, s25, 5
    s_add_u32 s85, s85, s83
    s_lshr_b32 s10, s29, 10
    v_min_u32 v14, 12, v0
    s_waitcnt lgkmcnt(8)
    v_mfma_f32_32x32x16_bf16 v[192:207], v[216:219], v[220:223], v[192:207]
    ds_read_b128 v[208:211], v16 offset:17088
    ds_read_b128 v[212:215], v17 offset:192
    v_writelane_b32 v14, s10, 62
    s_lshr_b32 s10, s80, 1
    s_waitcnt lgkmcnt(8)
    v_mfma_f32_32x32x16_bf16 v[192:207], v[224:227], v[228:231], v[192:207]
    ds_read_b128 v[216:219], v16 offset:17120
    ds_read_b128 v[220:223], v17 offset:224
    buffer_load_dwordx4 a[180:183], v1, s[56:59], s85 offen offset:0 sc1
    s_lshl_b32 s10, s10, 6
    s_add_u32 s10, s10, s82
    s_waitcnt lgkmcnt(8)
    v_mfma_f32_32x32x16_bf16 v[192:207], v[232:235], v[236:239], v[192:207]
    ds_read_b128 v[224:227], v16 offset:17152
    ds_read_b128 v[228:231], v17 offset:256
    s_lshl_b32 s10, s10, 7
    s_add_u32 s10, s10, 73728
    s_waitcnt lgkmcnt(8)
    v_mfma_f32_32x32x16_bf16 v[192:207], v[240:243], v[244:247], v[192:207]
    ds_read_b128 v[232:235], v16 offset:17184
    ds_read_b128 v[236:239], v17 offset:288
    buffer_load_dwordx4 a[184:187], v1, s[56:59], s85 offen offset:1024 sc1
    v_lshl_add_u32 v14, v14, 7, s10
    s_lshl_b32 s87, s80, 2
    s_waitcnt lgkmcnt(8)
    v_mfma_f32_32x32x16_bf16 v[192:207], v[248:251], v[252:255], v[192:207]
    ds_read_b128 v[240:243], v16 offset:17216
    ds_read_b128 v[244:247], v17 offset:320
    s_add_u32 s87, s87, s41
    s_mul_i32 s87, s87, 20480
    s_waitcnt lgkmcnt(8)
    v_mfma_f32_32x32x16_bf16 v[192:207], v[208:211], v[212:215], v[192:207]
    ds_read_b128 v[248:251], v16 offset:17248
    ds_read_b128 v[252:255], v17 offset:352
    buffer_load_dwordx4 a[188:191], v1, s[56:59], s85 offen offset:2048 sc1
    s_mul_i32 s86, s81, 160
    s_add_u32 s87, s87, s86
    s_waitcnt lgkmcnt(8)
    v_mfma_f32_32x32x16_bf16 v[192:207], v[216:219], v[220:223], v[192:207]
    ds_read_b128 v[208:211], v16 offset:17280
    ds_read_b128 v[212:215], v17 offset:384
    s_mul_i32 s86, s3, 3072
    s_add_u32 s86, s86, 16384
    s_waitcnt lgkmcnt(8)
    v_mfma_f32_32x32x16_bf16 v[192:207], v[224:227], v[228:231], v[192:207]
    ds_read_b128 v[216:219], v16 offset:17312
    ds_read_b128 v[220:223], v17 offset:416
    buffer_load_dwordx4 a[192:195], v1, s[56:59], s85 offen offset:3072 sc1
    s_add_u32 s85, s85, 4096
    v_lshrrev_b32_e64 v44, 2, v0
    v_mul_u32_u24 v44, 1216, v44
    s_waitcnt lgkmcnt(8)
    v_mfma_f32_32x32x16_bf16 v[192:207], v[232:235], v[236:239], v[192:207]
    ds_read_b128 v[224:227], v16 offset:17344
    ds_read_b128 v[228:231], v17 offset:448
    v_add_u32 v44, v44, v1
    v_mov_b32 v23, s79
    s_waitcnt lgkmcnt(8)
    v_mfma_f32_32x32x16_bf16 v[192:207], v[240:243], v[244:247], v[192:207]
    ds_read_b128 v[232:235], v16 offset:17376
    ds_read_b128 v[236:239], v17 offset:480
    buffer_load_dwordx4 a[196:199], v1, s[56:59], s85 offen offset:0 sc1
    s_mul_i32 s85, s26, 5
    s_add_u32 s85, s85, s83
    v_cmp_eq_u32 vcc, 0, v0
    v_and_b32_e64 v24, 1, v0
    s_waitcnt lgkmcnt(8)
    v_mfma_f32_32x32x16_bf16 v[192:207], v[248:251], v[252:255], v[192:207]
    ds_read_b64_tr_b16 v[128:129], v29 offset:32
    ds_read_b64_tr_b16 v[130:131], v29 offset:0
    ds_read_b64_tr_b16 v[132:133], v29 offset:288
    s_nop 0
    v_cndmask_b32 v23, 0, v23, vcc
    v_cmp_eq_u32 vcc, 1, v24
    s_waitcnt lgkmcnt(9)
    v_mfma_f32_32x32x16_bf16 v[192:207], v[208:211], v[212:215], v[192:207]
    ds_read_b64_tr_b16 v[134:135], v29 offset:256
    ds_read_b64_tr_b16 v[136:137], v29 offset:544
    ds_read_b64_tr_b16 v[138:139], v29 offset:512
    buffer_load_dwordx4 a[200:203], v1, s[56:59], s85 offen offset:0 sc1
    s_waitcnt lgkmcnt(10)
    v_mfma_f32_32x32x16_bf16 v[192:207], v[216:219], v[220:223], v[192:207]
    ds_read_b64_tr_b16 v[140:141], v29 offset:800
    ds_read_b64_tr_b16 v[142:143], v29 offset:768
    ds_read_b64_tr_b16 v[144:145], v29 offset:1056
    s_waitcnt lgkmcnt(11)
    v_mfma_f32_32x32x16_bf16 v[192:207], v[224:227], v[228:231], v[192:207]
    ds_read_b64_tr_b16 v[146:147], v29 offset:1024
    ds_read_b64_tr_b16 v[148:149], v29 offset:1312
    ds_read_b64_tr_b16 v[150:151], v29 offset:1280
    buffer_load_dwordx4 a[204:207], v1, s[56:59], s85 offen offset:1024 sc1
    s_waitcnt lgkmcnt(12)
    v_mfma_f32_32x32x16_bf16 v[192:207], v[232:235], v[236:239], v[192:207]
    ds_read_b64_tr_b16 v[152:153], v29 offset:1568
    ds_read_b64_tr_b16 v[154:155], v29 offset:1536
    ds_read_b64_tr_b16 v[156:157], v29 offset:1824
    ds_read_b64_tr_b16 v[158:159], v29 offset:1792
    ds_read_b64_tr_b16 v[160:161], v29 offset:2080
    ds_read_b64_tr_b16 v[162:163], v29 offset:2048
    ds_read_b64_tr_b16 v[164:165], v29 offset:2336
    ds_read_b64_tr_b16 v[166:167], v29 offset:2304
    s_nop 3
    v_add_f32_e64 v192, v192, v23
    v_cvt_pk_bf16_f32 v32, v192, v196
    v_cvt_pk_bf16_f32 v33, v193, v197
    v_cvt_pk_bf16_f32 v34, v194, v198
    v_cvt_pk_bf16_f32 v35, v195, v199
    v_cvt_pk_bf16_f32 v36, v200, v201
    v_cvt_pk_bf16_f32 v37, v200, v202
    v_cvt_pk_bf16_f32 v38, v201, v202
    v_cndmask_b32_e64 v23, v203, v204, vcc
    v_cvt_pk_bf16_f32 v39, v203, v23
    v_cvt_pk_bf16_f32 v40, v203, v204
    v_cndmask_b32_e64 v23, v205, v206, vcc
    v_cvt_pk_bf16_f32 v41, v205, v23
    v_cvt_pk_bf16_f32 v42, v205, v206
    ds_write2st64_b32 v27, v32, v33 offset0:0 offset1:9
    s_mul_i32 s85, s26, 5
    s_add_u32 s85, s85, s83
    ds_write2st64_b32 v27, v34, v35 offset0:18 offset1:27
    buffer_load_dwordx4 a[208:211], v1, s[56:59], s85 offen offset:2048 sc1
    ds_write2st64_b32 v27, v36, v36 offset0:2 offset1:11
    buffer_load_dwordx4 a[212:215], v1, s[56:59], s85 offen offset:3072 sc1
    ds_write2st64_b32 v27, v37, v38 offset0:20 offset1:29
    s_add_u32 s85, s85, 4096
    ds_write2st64_b32 v28, v39, v40 offset0:4 offset1:13
    buffer_load_dwordx4 a[216:219], v1, s[56:59], s85 offen offset:0 sc1
    ds_write2st64_b32 v28, v40, v40 offset0:22 offset1:31
    s_mul_i32 s85, s27, 5
    ds_write2st64_b32 v28, v41, v42 offset0:5 offset1:14
    s_add_u32 s85, s85, s83
    ds_write2st64_b32 v28, v42, v42 offset0:23 offset1:32
    buffer_load_dwordx4 a[220:223], v1, s[56:59], s85 offen offset:0 sc1
    s_waitcnt lgkmcnt(0)
    s_barrier
    s_bitcmp1_b32 s3, 0
    s_cbranch_scc1 LG_h1
    ds_read_b128 v[48:51], v30 offset:4224
    ds_read_b128 v[52:55], v30 offset:4096
    ds_read_b128 v[56:59], v30 offset:3968
    ds_read_b128 v[60:63], v30 offset:3840
    ds_read_b128 v[64:67], v30 offset:3712
    ds_read_b128 v[68:71], v30 offset:3584
    ds_read_b128 v[72:75], v30 offset:896
    ds_read_b128 v[76:79], v30 offset:768
    s_mul_i32 s85, s27, 5
    s_add_u32 s85, s85, s83
    buffer_load_dwordx4 a[224:227], v1, s[56:59], s85 offen offset:1024 sc1
    s_waitcnt lgkmcnt(6)
    v_mfma_f32_16x16x32_bf16 v[16:19], v[128:131], v[48:51], 0
    ds_read_b64_tr_b16 v[168:169], v29 offset:2592
    s_lshr_b32 s32, s3, 1
    v_mfma_f32_16x16x32_bf16 v[16:19], v[132:135], v[52:55], v[16:19]
    s_lshl_b32 s38, s15, 1
    ds_read_b64_tr_b16 v[170:171], v29 offset:2560
    s_waitcnt lgkmcnt(6)
    v_mfma_f32_16x16x32_bf16 v[16:19], v[136:139], v[56:59], v[16:19]
    s_mul_i32 s85, s27, 5
    s_add_u32 s85, s85, s83
    ds_read_b128 v[48:51], v30 offset:640
    v_mfma_f32_16x16x32_bf16 v[16:19], v[140:143], v[60:63], v[16:19]
    s_add_u32 s38, s38, s32
    ds_read_b64_tr_b16 v[172:173], v29 offset:2848
    s_waitcnt lgkmcnt(6)
    v_mfma_f32_16x16x32_bf16 v[16:19], v[144:147], v[64:67], v[16:19]
    buffer_load_dwordx4 a[228:231], v1, s[56:59], s85 offen offset:2048 sc1
    v_mfma_f32_16x16x32_bf16 v[16:19], v[148:151], v[68:71], v[16:19]
    s_mul_i32 s38, s38, 4224
    ds_read_b64_tr_b16 v[174:175], v29 offset:2816
    s_waitcnt lgkmcnt(5)
    v_mfma_f32_16x16x32_bf16 v[204:207], v[128:131], v[72:75], 0
    s_add_u32 s38, s38, 5259264
    ds_read_b128 v[52:55], v30 offset:512
    v_mov_b32 v226, 0
    v_mfma_f32_16x16x32_bf16 v[204:207], v[132:135], v[76:79], v[204:207]
    s_mul_i32 s32, s32, 8224
    ds_read_b64_tr_b16 v[176:177], v29 offset:3104
    v_mov_b32_e64 v227, 0
    v_mfma_f32_16x16x32_bf16 v[216:219], v[140:143], v[76:79], 0
    s_and_b32 s33, s3, 1
    ds_read_b64_tr_b16 v[178:179], v29 offset:3072
    v_mov_b32 v214, 0
    v_mfma_f32_16x16x32_bf16 v[216:219], v[136:139], v[72:75], v[216:219]
    buffer_load_dwordx4 a[232:235], v1, s[56:59], s85 offen offset:3072 sc1
    v_mfma_f32_16x16x32_bf16 v[228:231], v[160:163], v[72:75], 0
    s_add_u32 s85, s85, 4096
    ds_read_b128 v[56:59], v30 offset:2688
    v_mov_b32_e64 v232, v18
    v_mfma_f32_16x16x32_bf16 v[228:231], v[164:167], v[76:79], v[228:231]
    s_lshl_b32 s33, s33, 10
    ds_read_b64_tr_b16 v[180:181], v29 offset:3360
    s_waitcnt lgkmcnt(4)
    v_mfma_f32_16x16x32_bf16 v[204:207], v[136:139], v[48:51], v[204:207]
    s_add_u32 s32, s32, s33
    ds_read_b64_tr_b16 v[182:183], v29 offset:3328
    v_mov_b32 v233, v19
    v_mfma_f32_16x16x32_bf16 v[204:207], v[140:143], v[52:55], v[204:207]
    buffer_load_dwordx4 a[236:239], v1, s[56:59], s85 offen offset:0 sc1
    v_mfma_f32_16x16x32_bf16 v[216:219], v[148:151], v[52:55], v[216:219]
    s_mul_i32 s85, s28, 5
    s_add_u32 s85, s85, s83
    ds_read_b128 v[60:63], v30 offset:2560
    v_mfma_f32_16x16x32_bf16 v[216:219], v[144:147], v[48:51], v[216:219]
    s_add_u32 s32, s32, 75904
    ds_read_b128 v[64:67], v30 offset:3456
    v_mov_b32_e64 v238, v18
    v_mfma_f32_16x16x32_bf16 v[228:231], v[168:171], v[48:51], v[228:231]
    ds_read_b128 v[68:71], v30 offset:3328
    v_mov_b32_e64 v239, v19
    v_mfma_f32_16x16x32_bf16 v[228:231], v[172:175], v[52:55], v[228:231]
    ds_read_b64_tr_b16 v[184:185], v29 offset:3616
    s_waitcnt lgkmcnt(3)
    v_mfma_f32_16x16x32_bf16 v[210:213], v[144:147], v[56:59], v[204:207]
    buffer_load_dwordx4 a[240:243], v1, s[56:59], s85 offen offset:0 sc1
    v_mfma_f32_16x16x32_bf16 v[210:213], v[148:151], v[60:63], v[210:213]
    ds_read_b64_tr_b16 v[186:187], v29 offset:3584
    v_add_f32 v18, v18, v16
    v_mfma_f32_16x16x32_bf16 v[222:225], v[156:159], v[60:63], v[216:219]
    ds_read_b128 v[72:75], v30 offset:2432
    v_add_f32_e64 v19, v19, v17
    v_mfma_f32_16x16x32_bf16 v[222:225], v[152:155], v[56:59], v[222:225]
    ds_read_b64_tr_b16 v[188:189], v29 offset:3872
    v_mov_b32_e64 v215, 0
    v_mfma_f32_16x16x32_bf16 v[234:237], v[176:179], v[56:59], v[228:231]
    buffer_load_dwordx4 a[244:247], v1, s[56:59], s85 offen offset:1024 sc1
    v_mfma_f32_16x16x32_bf16 v[234:237], v[180:183], v[60:63], v[234:237]
    ds_read_b64_tr_b16 v[190:191], v29 offset:3840
    s_waitcnt lgkmcnt(5)
    v_mfma_f32_16x16x32_bf16 v[222:225], v[132:135], v[68:71], v[222:225]
    ds_read_b128 v[76:79], v30 offset:2304
    v_mov_b32 v202, 0
    v_mfma_f32_16x16x32_bf16 v[222:225], v[128:131], v[64:67], v[222:225]
    ds_read_b128 v[48:51], v30 offset:1920
    v_mov_b32_e64 v203, 0
    v_mfma_f32_16x16x32_bf16 v[234:237], v[152:155], v[64:67], v[234:237]
    ds_read_b128 v[52:55], v30 offset:1792
    v_add_u32_e64 v4, 16, v0
    v_mfma_f32_16x16x32_bf16 v[234:237], v[156:159], v[68:71], v[234:237]
    ds_read_b128 v[56:59], v30 offset:0
    s_waitcnt lgkmcnt(3)
    v_mfma_f32_16x16x32_bf16 v[198:201], v[132:135], v[76:79], 0
    buffer_load_dwordx4 v[80:83], v1, s[56:59], s85 offen offset:2048 sc1
    v_mfma_f32_16x16x32_bf16 v[198:201], v[128:131], v[72:75], v[198:201]
    ds_read_b128 v[60:63], v30 offset:128
    v_subrev_u32 v5, 47, v0
    v_mfma_f32_16x16x32_bf16 v[210:213], v[152:155], v[72:75], v[210:213]
    ds_read_b128 v[64:67], v30 offset:1664
    v_cmp_lt_u32 s[36:37], 47, v0
    v_mfma_f32_16x16x32_bf16 v[210:213], v[156:159], v[76:79], v[210:213]
    buffer_load_dword v13, v14, s[56:59], 0 offen sc1
    v_mfma_f32_16x16x32_bf16 v[222:225], v[164:167], v[76:79], v[222:225]
    ds_read_b128 v[68:71], v30 offset:1536
    v_lshl_add_u32 v6, v0, 4, s32
    v_mfma_f32_16x16x32_bf16 v[222:225], v[160:163], v[72:75], v[222:225]
    v_and_b32_e64 v11, 15, v0
    v_cndmask_b32 v4, v4, v5, s[36:37]
    v_mfma_f32_16x16x32_bf16 v[234:237], v[184:187], v[72:75], v[234:237]
    v_cmp_eq_u32 s[36:37], 63, v0
    v_lshlrev_b32_e64 v11, 4, v11
    v_mfma_f32_16x16x32_bf16 v[234:237], v[188:191], v[76:79], v[234:237]
    ds_read_b128 v[72:75], v30 offset:256
    s_waitcnt lgkmcnt(5)
    v_mfma_f32_16x16x32_bf16 v[228:231], v[128:131], v[48:51], v[228:231]
    buffer_load_dwordx4 v[84:87], v1, s[56:59], s85 offen offset:3072 sc1
    v_mfma_f32_16x16x32_bf16 v[228:231], v[132:135], v[52:55], v[228:231]
    s_add_u32 s85, s85, 4096
    ds_read_b128 v[76:79], v30 offset:384
    s_waitcnt lgkmcnt(4)
    v_mfma_f32_16x16x32_bf16 v[192:195], v[128:131], v[60:63], 0
    ds_read_b128 v[48:51], v30 offset:1408
    v_and_b32_e64 v9, 12, v0
    v_mfma_f32_16x16x32_bf16 v[192:195], v[132:135], v[56:59], v[192:195]
    ds_read_b128 v[52:55], v30 offset:1280
    v_add_f32_e64 v234, v234, v16
    v_mfma_f32_16x16x32_bf16 v[204:207], v[156:159], v[56:59], v[204:207]
    buffer_load_dwordx4 v[88:91], v1, s[56:59], s85 offen offset:0 sc1
    v_mfma_f32_16x16x32_bf16 v[204:207], v[152:155], v[60:63], v[204:207]
    s_mul_i32 s85, s29, 5
    s_add_u32 s85, s85, s83
    v_add_f32_e64 v235, v235, v17
    v_mfma_f32_16x16x32_bf16 v[216:219], v[160:163], v[60:63], v[216:219]
    v_add_f32 v236, v236, v18
    v_add_f32 v237, v237, v19
    v_mfma_f32_16x16x32_bf16 v[216:219], v[164:167], v[56:59], v[216:219]
    v_lshl_add_u32 v11, v9, 4, v11
    v_bfe_u32 v9, v0, 4, 1
    v_mfma_f32_16x16x32_bf16 v[228:231], v[188:191], v[56:59], v[228:231]
    v_cndmask_b32 v4, v4, 64, s[36:37]
    v_lshl_add_u32 v4, v4, 4, s32
    v_mfma_f32_16x16x32_bf16 v[228:231], v[184:187], v[60:63], v[228:231]
    s_lshl_b32 s32, s33, 1
    ds_read_b128 v[56:59], v30 offset:1024
    s_waitcnt lgkmcnt(5)
    v_mfma_f32_16x16x32_bf16 v[228:231], v[136:139], v[64:67], v[228:231]
    buffer_load_dwordx4 v[92:95], v1, s[56:59], s85 offen offset:0 sc1
    v_mfma_f32_16x16x32_bf16 v[228:231], v[140:143], v[68:71], v[228:231]
    s_sub_u32 s32, 3072, s32
    ds_read_b128 v[60:63], v30 offset:1152
    s_waitcnt lgkmcnt(4)
    v_mfma_f32_16x16x32_bf16 v[204:207], v[148:151], v[72:75], v[204:207]
    ds_read_b128 v[64:67], v30 offset:8064
    v_add_u32 v5, s32, v4
Lst_3369:
    s_cbranch_execz L_hopback
    s_nop 0
    v_mfma_f32_16x16x32_bf16 v[204:207], v[144:147], v[76:79], v[204:207]
    buffer_load_dwordx4 v[96:99], v1, s[56:59], s85 offen offset:1024 sc1
    v_mfma_f32_16x16x32_bf16 v[216:219], v[152:155], v[76:79], v[216:219]
    ds_read_b128 v[68:71], v30 offset:7936
    v_add_u32_e64 v7, s32, v6
    v_mfma_f32_16x16x32_bf16 v[216:219], v[156:159], v[72:75], v[216:219]
    v_lshl_add_u32 v11, v9, 11, v11
    v_lshrrev_b32_e64 v9, 5, v0
    v_mfma_f32_16x16x32_bf16 v[228:231], v[180:183], v[72:75], v[228:231]
    v_lshl_add_u32 v11, v9, 6, v11
    s_lshr_b32 s33, s33, 1
    v_mfma_f32_16x16x32_bf16 v[228:231], v[176:179], v[76:79], v[228:231]
    s_lshr_b32 s32, s32, 1
    ds_read_b128 v[72:75], v30 offset:6912
    s_waitcnt lgkmcnt(5)
    v_mfma_f32_16x16x32_bf16 v[228:231], v[144:147], v[48:51], v[228:231]
    buffer_load_dwordx4 v[100:103], v1, s[56:59], s85 offen offset:2048 sc1
    v_mfma_f32_16x16x32_bf16 v[228:231], v[148:151], v[52:55], v[228:231]
    ds_read_b128 v[76:79], v30 offset:7040
    s_waitcnt lgkmcnt(4)
    v_mfma_f32_16x16x32_bf16 v[216:219], v[128:131], v[60:63], v[216:219]
    ds_read_b128 v[48:51], v30 offset:7808
    v_add_u32_e64 v11, s33, v11
    v_mfma_f32_16x16x32_bf16 v[216:219], v[132:135], v[56:59], v[216:219]
    ds_read_b128 v[52:55], v30 offset:7680
    v_add_u32_e64 v12, s32, v11
    v_mfma_f32_16x16x32_bf16 v[228:231], v[156:159], v[56:59], v[228:231]
    buffer_load_dwordx4 v[104:107], v1, s[56:59], s85 offen offset:3072 sc1
    v_mfma_f32_16x16x32_bf16 v[228:231], v[152:155], v[60:63], v[228:231]
    s_add_u32 s85, s85, 4096
    ds_read_b128 v[56:59], v30 offset:7168
    s_waitcnt lgkmcnt(5)
    v_mfma_f32_16x16x32_bf16 v[224:227], v[132:135], v[68:71], v[224:227]
    ds_read_b128 v[60:63], v30 offset:7296
    v_mov_b32 v220, 0
    v_mfma_f32_16x16x32_bf16 v[224:227], v[128:131], v[64:67], v[224:227]
    v_mov_b32 v221, 0
    v_mov_b32 v208, 0
    v_mfma_f32_16x16x32_bf16 v[236:239], v[152:155], v[64:67], v[236:239]
    v_mov_b32 v209, 0
    v_mov_b32 v196, 0
    v_mfma_f32_16x16x32_bf16 v[236:239], v[156:159], v[68:71], v[236:239]
    ds_read_b128 v[64:67], v30 offset:7552
    s_waitcnt lgkmcnt(5)
    v_mfma_f32_16x16x32_bf16 v[200:203], v[128:131], v[76:79], v[200:203]
    buffer_load_dwordx4 v[108:111], v1, s[56:59], s85 offen offset:0 sc1
    v_mfma_f32_16x16x32_bf16 v[200:203], v[132:135], v[72:75], v[200:203]
    ds_read_b128 v[68:71], v30 offset:7424
    v_add_f32 v230, v230, v16
    v_mfma_f32_16x16x32_bf16 v[212:215], v[156:159], v[72:75], v[212:215]
    v_add_f32 v231, v231, v17
    v_mov_b32 v197, 0
    v_mfma_f32_16x16x32_bf16 v[212:215], v[152:155], v[76:79], v[212:215]
    s_add_u32 m0, s86, 0
    s_nop 0
    buffer_load_dwordx4 v44, s[44:47], s87 offen offset:0 lds
    v_mfma_f32_16x16x32_bf16 v[224:227], v[160:163], v[76:79], v[224:227]
    v_mfma_f32_16x16x32_bf16 v[224:227], v[164:167], v[72:75], v[224:227]
    v_mfma_f32_16x16x32_bf16 v[236:239], v[188:191], v[72:75], v[236:239]
    v_mfma_f32_16x16x32_bf16 v[236:239], v[184:187], v[76:79], v[236:239]
    ds_read_b128 v[72:75], v30 offset:5760
    s_waitcnt lgkmcnt(5)
    v_mfma_f32_16x16x32_bf16 v[212:215], v[128:131], v[48:51], v[212:215]
    s_add_u32 m0, s86, 960
    s_nop 0
    buffer_load_dwordx4 v44, s[44:47], s87 offen offset:64 lds
    v_mfma_f32_16x16x32_bf16 v[212:215], v[132:135], v[52:55], v[212:215]
    ds_read_b128 v[76:79], v30 offset:5632
    v_mfma_f32_16x16x32_bf16 v[224:227], v[140:143], v[52:55], v[224:227]
    v_mfma_f32_16x16x32_bf16 v[224:227], v[136:139], v[48:51], v[224:227]
    v_mfma_f32_16x16x32_bf16 v[236:239], v[160:163], v[48:51], v[236:239]
    s_add_u32 m0, s86, 1920
    s_nop 0
    buffer_load_dwordx4 v44, s[44:47], s87 offen offset:128 lds
    v_mfma_f32_16x16x32_bf16 v[236:239], v[164:167], v[52:55], v[236:239]
    s_waitcnt vmcnt(10)
    ds_read_b128 v[48:51], v30 offset:4608
    s_waitcnt lgkmcnt(5)
    v_mfma_f32_16x16x32_bf16 v[212:215], v[148:151], v[56:59], v[212:215]
    v_cmp_ne_u32_e64 vcc, s7, v13
    s_cbranch_vccnz Lslow_3
Lback_4:
    v_mfma_f32_16x16x32_bf16 v[212:215], v[144:147], v[60:63], v[212:215]
    v_add_u32_e64 v2, s30, v1
    v_mfma_f32_16x16x32_bf16 v[224:227], v[152:155], v[60:63], v[224:227]
    ds_read_b128 v[52:55], v30 offset:4736
    v_mfma_f32_16x16x32_bf16 v[224:227], v[156:159], v[56:59], v[224:227]
    buffer_load_dwordx4 v[112:115], v2, s[56:59], s16 offen sc1
    v_mfma_f32_16x16x32_bf16 v[236:239], v[180:183], v[56:59], v[236:239]
    v_mfma_f32_16x16x32_bf16 v[236:239], v[176:179], v[60:63], v[236:239]
    ds_read_b128 v[56:59], v30 offset:5504
    s_waitcnt lgkmcnt(5)
    v_mfma_f32_16x16x32_bf16 v[212:215], v[136:139], v[64:67], v[212:215]
    ds_read_b128 v[60:63], v30 offset:5376
    v_mfma_f32_16x16x32_bf16 v[212:215], v[140:143], v[68:71], v[212:215]
    buffer_load_dwordx4 v[116:119], v2, s[56:59], s17 offen sc1
    v_mfma_f32_16x16x32_bf16 v[224:227], v[148:151], v[68:71], v[224:227]
    v_mfma_f32_16x16x32_bf16 v[224:227], v[144:147], v[64:67], v[224:227]
    v_mfma_f32_16x16x32_bf16 v[236:239], v[168:171], v[64:67], v[236:239]
    v_mfma_f32_16x16x32_bf16 v[236:239], v[172:175], v[68:71], v[236:239]
    ds_read_b128 v[64:67], v30 offset:4864
    s_waitcnt lgkmcnt(5)
    v_mfma_f32_16x16x32_bf16 v[218:221], v[132:135], v[76:79], v[218:221]
    buffer_load_dwordx4 v[120:123], v2, s[56:59], s18 offen sc1
    v_mfma_f32_16x16x32_bf16 v[218:221], v[128:131], v[72:75], v[218:221]
    ds_read_b128 v[68:71], v30 offset:4992
    v_mfma_f32_16x16x32_bf16 v[230:233], v[152:155], v[72:75], v[230:233]
    v_mfma_f32_16x16x32_bf16 v[230:233], v[156:159], v[76:79], v[230:233]
    ds_read_b128 v[72:75], v30 offset:5248
    s_waitcnt lgkmcnt(5)
    v_mfma_f32_16x16x32_bf16 v[194:197], v[128:131], v[52:55], v[194:197]
    buffer_load_dwordx4 v[124:127], v2, s[56:59], s19 offen sc1
    v_mfma_f32_16x16x32_bf16 v[194:197], v[132:135], v[48:51], v[194:197]
    ds_read_b128 v[76:79], v30 offset:5120
    v_mfma_f32_16x16x32_bf16 v[206:209], v[156:159], v[48:51], v[206:209]
    v_mfma_f32_16x16x32_bf16 v[206:209], v[152:155], v[52:55], v[206:209]
    v_mfma_f32_16x16x32_bf16 v[218:221], v[160:163], v[52:55], v[218:221]
    v_mfma_f32_16x16x32_bf16 v[218:221], v[164:167], v[48:51], v[218:221]
    buffer_load_dwordx4 v[240:243], v2, s[56:59], s20 offen sc1
    v_mfma_f32_16x16x32_bf16 v[230:233], v[188:191], v[48:51], v[230:233]
    v_mfma_f32_16x16x32_bf16 v[230:233], v[184:187], v[52:55], v[230:233]
    s_waitcnt lgkmcnt(4)
    v_mfma_f32_16x16x32_bf16 v[206:209], v[128:131], v[56:59], v[206:209]
    v_mfma_f32_16x16x32_bf16 v[206:209], v[132:135], v[60:63], v[206:209]
    buffer_load_dwordx4 v[244:247], v2, s[56:59], s21 offen sc1
    v_mfma_f32_16x16x32_bf16 v[218:221], v[140:143], v[60:63], v[218:221]
    v_mfma_f32_16x16x32_bf16 v[218:221], v[136:139], v[56:59], v[218:221]
    v_mfma_f32_16x16x32_bf16 v[230:233], v[160:163], v[56:59], v[230:233]
    v_mfma_f32_16x16x32_bf16 v[230:233], v[164:167], v[60:63], v[230:233]
    s_waitcnt lgkmcnt(2)
    v_mfma_f32_16x16x32_bf16 v[206:209], v[148:151], v[64:67], v[206:209]
    buffer_load_dwordx4 v[248:251], v2, s[56:59], s22 offen sc1
    v_mfma_f32_16x16x32_bf16 v[206:209], v[144:147], v[68:71], v[206:209]
    v_mfma_f32_16x16x32_bf16 v[218:221], v[152:155], v[68:71], v[218:221]
    v_mfma_f32_16x16x32_bf16 v[218:221], v[156:159], v[64:67], v[218:221]
    v_mfma_f32_16x16x32_bf16 v[230:233], v[180:183], v[64:67], v[230:233]
    buffer_load_dwordx4 v[252:255], v2, s[56:59], s23 offen sc1
    v_mfma_f32_16x16x32_bf16 v[230:233], v[176:179], v[68:71], v[230:233]
    s_waitcnt lgkmcnt(0)
    v_mfma_f32_16x16x32_bf16 v[206:209], v[136:139], v[72:75], v[206:209]
    v_mfma_f32_16x16x32_bf16 v[206:209], v[140:143], v[76:79], v[206:209]
    v_mfma_f32_16x16x32_bf16 v[218:221], v[148:151], v[76:79], v[218:221]
    v_mfma_f32_16x16x32_bf16 v[218:221], v[144:147], v[72:75], v[218:221]
    buffer_load_dwordx4 v[16:19], v2, s[56:59], s24 offen sc1
    v_mfma_f32_16x16x32_bf16 v[230:233], v[168:171], v[72:75], v[230:233]
    v_mfma_f32_16x16x32_bf16 v[230:233], v[172:175], v[76:79], v[230:233]
    buffer_load_dwordx4 v[20:23], v2, s[56:59], s25 offen sc1
    s_branch LG_g2
LG_h1:
Lst_3520:
    s_cbranch_execz L_hopback
    s_nop 0
    s_nop 0
    ds_read_b128 v[48:51], v30 offset:3968
    ds_read_b128 v[52:55], v30 offset:3840
    ds_read_b128 v[56:59], v30 offset:3712
    ds_read_b128 v[60:63], v30 offset:3584
    ds_read_b128 v[64:67], v30 offset:896
    ds_read_b128 v[68:71], v30 offset:768
    ds_read_b128 v[72:75], v30 offset:640
    ds_read_b128 v[76:79], v30 offset:512
    s_mul_i32 s85, s27, 5
    s_add_u32 s85, s85, s83
    buffer_load_dwordx4 a[224:227], v1, s[56:59], s85 offen offset:1024 sc1
    s_waitcnt lgkmcnt(6)
    v_mfma_f32_16x16x32_bf16 v[20:23], v[128:131], v[48:51], 0
    ds_read_b64_tr_b16 v[168:169], v29 offset:2592
    s_lshr_b32 s32, s3, 1
    v_mfma_f32_16x16x32_bf16 v[20:23], v[132:135], v[52:55], v[20:23]
    s_lshl_b32 s38, s15, 1
    ds_read_b64_tr_b16 v[170:171], v29 offset:2560
    s_waitcnt lgkmcnt(6)
    v_mfma_f32_16x16x32_bf16 v[16:19], v[132:135], v[60:63], 0
    s_mul_i32 s85, s27, 5
    s_add_u32 s85, s85, s83
    ds_read_b128 v[48:51], v30 offset:2688
    v_mfma_f32_16x16x32_bf16 v[16:19], v[128:131], v[56:59], v[16:19]
    buffer_load_dwordx4 a[228:231], v1, s[56:59], s85 offen offset:2048 sc1
    v_mfma_f32_16x16x32_bf16 v[20:23], v[136:139], v[56:59], v[20:23]
    s_add_u32 s38, s38, s32
    ds_read_b64_tr_b16 v[172:173], v29 offset:2848
    v_mov_b32 v214, 0
    v_mfma_f32_16x16x32_bf16 v[20:23], v[140:143], v[60:63], v[20:23]
    s_mul_i32 s38, s38, 4224
    ds_read_b64_tr_b16 v[174:175], v29 offset:2816
    s_waitcnt lgkmcnt(6)
    v_mfma_f32_16x16x32_bf16 v[216:219], v[148:151], v[68:71], 0
    s_add_u32 s38, s38, 5259264
    ds_read_b128 v[52:55], v30 offset:2560
    v_mov_b32 v215, 0
    v_mfma_f32_16x16x32_bf16 v[216:219], v[144:147], v[64:67], v[216:219]
    s_mul_i32 s32, s32, 8224
    ds_read_b128 v[56:59], v30 offset:3456
    v_mov_b32_e64 v220, v18
    v_mfma_f32_16x16x32_bf16 v[228:231], v[152:155], v[64:67], 0
    buffer_load_dwordx4 a[232:235], v1, s[56:59], s85 offen offset:3072 sc1
    v_mfma_f32_16x16x32_bf16 v[228:231], v[156:159], v[68:71], v[228:231]
    s_add_u32 s85, s85, 4096
    ds_read_b128 v[60:63], v30 offset:3328
    s_waitcnt lgkmcnt(6)
    v_mfma_f32_16x16x32_bf16 v[204:207], v[128:131], v[72:75], 0
    s_and_b32 s33, s3, 1
    ds_read_b64_tr_b16 v[176:177], v29 offset:3104
    v_mov_b32_e64 v232, v22
    v_mfma_f32_16x16x32_bf16 v[204:207], v[132:135], v[76:79], v[204:207]
    s_lshl_b32 s33, s33, 10
    ds_read_b64_tr_b16 v[178:179], v29 offset:3072
    v_mov_b32 v233, v23
    v_mfma_f32_16x16x32_bf16 v[216:219], v[156:159], v[76:79], v[216:219]
    buffer_load_dwordx4 a[236:239], v1, s[56:59], s85 offen offset:0 sc1
    v_mfma_f32_16x16x32_bf16 v[216:219], v[152:155], v[72:75], v[216:219]
    s_mul_i32 s85, s28, 5
    s_add_u32 s85, s85, s83
    ds_read_b128 v[64:67], v30 offset:2432
    v_mfma_f32_16x16x32_bf16 v[228:231], v[160:163], v[72:75], v[228:231]
    s_add_u32 s32, s32, s33
    ds_read_b64_tr_b16 v[180:181], v29 offset:3360
    v_mov_b32 v238, v22
    v_mfma_f32_16x16x32_bf16 v[228:231], v[164:167], v[76:79], v[228:231]
    s_add_u32 s32, s32, 75904
    ds_read_b64_tr_b16 v[182:183], v29 offset:3328
    s_waitcnt lgkmcnt(6)
    v_mfma_f32_16x16x32_bf16 v[198:201], v[132:135], v[52:55], 0
    ds_read_b128 v[68:71], v30 offset:2304
    v_mov_b32 v239, v23
    v_mfma_f32_16x16x32_bf16 v[198:201], v[128:131], v[48:51], v[198:201]
    buffer_load_dwordx4 a[240:243], v1, s[56:59], s85 offen offset:0 sc1
    v_mfma_f32_16x16x32_bf16 v[210:213], v[136:139], v[48:51], v[204:207]
    ds_read_b128 v[72:75], v30 offset:1664
    v_add_f32_e64 v22, v22, v20
    v_mfma_f32_16x16x32_bf16 v[210:213], v[140:143], v[52:55], v[210:213]
    ds_read_b128 v[76:79], v30 offset:1536
    v_add_f32_e64 v23, v23, v21
    v_mfma_f32_16x16x32_bf16 v[222:225], v[164:167], v[52:55], v[216:219]
    v_mov_b32 v221, v19
    v_mov_b32 v226, v18
    v_mfma_f32_16x16x32_bf16 v[222:225], v[160:163], v[48:51], v[222:225]
    buffer_load_dwordx4 a[244:247], v1, s[56:59], s85 offen offset:1024 sc1
    v_mfma_f32_16x16x32_bf16 v[234:237], v[168:171], v[48:51], v[228:231]
    v_mov_b32 v227, v19
    v_add_f32 v18, v18, v16
    v_mfma_f32_16x16x32_bf16 v[234:237], v[172:175], v[52:55], v[234:237]
    ds_read_b128 v[48:51], v30 offset:0
    s_waitcnt lgkmcnt(6)
    v_mfma_f32_16x16x32_bf16 v[222:225], v[140:143], v[60:63], v[222:225]
    ds_read_b128 v[52:55], v30 offset:128
    v_add_f32 v19, v19, v17
    v_mfma_f32_16x16x32_bf16 v[222:225], v[136:139], v[56:59], v[222:225]
    v_mov_b32 v202, 0
    v_mov_b32 v203, 0
    v_mfma_f32_16x16x32_bf16 v[234:237], v[144:147], v[56:59], v[234:237]
    buffer_load_dwordx4 v[80:83], v1, s[56:59], s85 offen offset:2048 sc1
    v_mfma_f32_16x16x32_bf16 v[234:237], v[148:151], v[60:63], v[234:237]
    ds_read_b128 v[56:59], v30 offset:1408
    s_waitcnt lgkmcnt(5)
    v_mfma_f32_16x16x32_bf16 v[198:201], v[140:143], v[68:71], v[198:201]
    ds_read_b128 v[60:63], v30 offset:1280
    v_add_u32 v4, 16, v0
    v_mfma_f32_16x16x32_bf16 v[198:201], v[136:139], v[64:67], v[198:201]
    v_subrev_u32_e64 v5, 47, v0
    v_cmp_lt_u32 s[36:37], 47, v0
    v_mfma_f32_16x16x32_bf16 v[210:213], v[144:147], v[64:67], v[210:213]
    buffer_load_dword v13, v14, s[56:59], 0 offen sc1
    v_mfma_f32_16x16x32_bf16 v[210:213], v[148:151], v[68:71], v[210:213]
    v_lshl_add_u32 v6, v0, 4, s32
    v_and_b32_e64 v11, 15, v0
    v_mfma_f32_16x16x32_bf16 v[222:225], v[172:175], v[68:71], v[222:225]
    v_cndmask_b32 v4, v4, v5, s[36:37]
    v_cmp_eq_u32 s[36:37], 63, v0
    v_mfma_f32_16x16x32_bf16 v[222:225], v[168:171], v[64:67], v[222:225]
    v_lshlrev_b32 v11, 4, v11
    v_and_b32 v9, 12, v0
    v_mfma_f32_16x16x32_bf16 v[234:237], v[176:179], v[64:67], v[234:237]
    v_lshl_add_u32 v11, v9, 4, v11
    v_bfe_u32 v9, v0, 4, 1
    v_mfma_f32_16x16x32_bf16 v[234:237], v[180:183], v[68:71], v[234:237]
    ds_read_b128 v[64:67], v30 offset:256
    s_waitcnt lgkmcnt(5)
    v_mfma_f32_16x16x32_bf16 v[228:231], v[128:131], v[72:75], v[228:231]
    buffer_load_dwordx4 v[84:87], v1, s[56:59], s85 offen offset:3072 sc1
    v_mfma_f32_16x16x32_bf16 v[228:231], v[132:135], v[76:79], v[228:231]
    s_add_u32 s85, s85, 4096
    ds_read_b128 v[68:71], v30 offset:384
    s_waitcnt lgkmcnt(4)
    v_mfma_f32_16x16x32_bf16 v[192:195], v[136:139], v[52:55], 0
    ds_read_b128 v[72:75], v30 offset:1152
    v_add_f32_e64 v222, v222, v16
    v_mfma_f32_16x16x32_bf16 v[192:195], v[140:143], v[48:51], v[192:195]
    buffer_load_dwordx4 v[88:91], v1, s[56:59], s85 offen offset:0 sc1
    v_mfma_f32_16x16x32_bf16 v[204:207], v[148:151], v[48:51], v[204:207]
    s_mul_i32 s85, s29, 5
    s_add_u32 s85, s85, s83
    ds_read_b128 v[76:79], v30 offset:1024
    v_mfma_f32_16x16x32_bf16 v[204:207], v[144:147], v[52:55], v[204:207]
    v_add_f32 v234, v234, v20
    v_add_f32 v235, v235, v21
    v_mfma_f32_16x16x32_bf16 v[216:219], v[168:171], v[52:55], v[216:219]
    v_add_f32 v236, v236, v22
    v_add_f32 v237, v237, v23
    v_mfma_f32_16x16x32_bf16 v[216:219], v[172:175], v[48:51], v[216:219]
    v_add_f32 v223, v223, v17
    v_add_f32 v224, v224, v18
    v_mfma_f32_16x16x32_bf16 v[228:231], v[180:183], v[48:51], v[228:231]
    buffer_load_dwordx4 v[92:95], v1, s[56:59], s85 offen offset:0 sc1
    v_mfma_f32_16x16x32_bf16 v[228:231], v[176:179], v[52:55], v[228:231]
    ds_read_b128 v[48:51], v30 offset:8064
    s_waitcnt lgkmcnt(5)
    v_mfma_f32_16x16x32_bf16 v[216:219], v[132:135], v[60:63], v[216:219]
    ds_read_b128 v[52:55], v30 offset:7936
    v_add_f32 v225, v225, v19
    v_mfma_f32_16x16x32_bf16 v[216:219], v[128:131], v[56:59], v[216:219]
    v_cndmask_b32 v4, v4, 64, s[36:37]
    v_lshl_add_u32 v4, v4, 4, s32
    v_mfma_f32_16x16x32_bf16 v[228:231], v[136:139], v[56:59], v[228:231]
    buffer_load_dwordx4 v[96:99], v1, s[56:59], s85 offen offset:1024 sc1
    v_mfma_f32_16x16x32_bf16 v[228:231], v[140:143], v[60:63], v[228:231]
    s_lshl_b32 s32, s33, 1
    ds_read_b128 v[56:59], v30 offset:6912
    s_waitcnt lgkmcnt(5)
    v_mfma_f32_16x16x32_bf16 v[192:195], v[128:131], v[68:71], v[192:195]
    ds_read_b128 v[60:63], v30 offset:7040
    s_sub_u32 s32, 3072, s32
    v_mfma_f32_16x16x32_bf16 v[192:195], v[132:135], v[64:67], v[192:195]
    v_add_u32 v5, s32, v4
    v_add_u32 v7, s32, v6
    v_mfma_f32_16x16x32_bf16 v[204:207], v[140:143], v[64:67], v[204:207]
    v_lshl_add_u32 v11, v9, 11, v11
    v_lshrrev_b32_e64 v9, 5, v0
    v_mfma_f32_16x16x32_bf16 v[204:207], v[136:139], v[68:71], v[204:207]
    buffer_load_dwordx4 v[100:103], v1, s[56:59], s85 offen offset:2048 sc1
    v_mfma_f32_16x16x32_bf16 v[216:219], v[160:163], v[68:71], v[216:219]
    v_lshl_add_u32 v11, v9, 6, v11
    s_lshr_b32 s33, s33, 1
    v_mfma_f32_16x16x32_bf16 v[216:219], v[164:167], v[64:67], v[216:219]
    s_lshr_b32 s32, s32, 1
    v_add_u32 v11, s33, v11
    v_add_u32 v12, s32, v11
    v_mfma_f32_16x16x32_bf16 v[228:231], v[172:175], v[64:67], v[228:231]
    v_mfma_f32_16x16x32_bf16 v[228:231], v[168:171], v[68:71], v[228:231]
    ds_read_b128 v[64:67], v30 offset:7808
    s_waitcnt lgkmcnt(5)
    v_mfma_f32_16x16x32_bf16 v[216:219], v[140:143], v[76:79], v[216:219]
    buffer_load_dwordx4 v[104:107], v1, s[56:59], s85 offen offset:3072 sc1
    v_mfma_f32_16x16x32_bf16 v[216:219], v[136:139], v[72:75], v[216:219]
    s_add_u32 s85, s85, 4096
    ds_read_b128 v[68:71], v30 offset:7680
    v_mfma_f32_16x16x32_bf16 v[228:231], v[144:147], v[72:75], v[228:231]
    v_mfma_f32_16x16x32_bf16 v[228:231], v[148:151], v[76:79], v[228:231]
    ds_read_b128 v[72:75], v30 offset:7168
    s_waitcnt lgkmcnt(5)
    v_mfma_f32_16x16x32_bf16 v[224:227], v[140:143], v[52:55], v[224:227]
    buffer_load_dwordx4 v[108:111], v1, s[56:59], s85 offen offset:0 sc1
    v_mfma_f32_16x16x32_bf16 v[224:227], v[136:139], v[48:51], v[224:227]
    ds_read_b128 v[76:79], v30 offset:7296
    v_add_f32_e64 v218, v218, v16
    v_mfma_f32_16x16x32_bf16 v[236:239], v[144:147], v[48:51], v[236:239]
    v_add_f32 v219, v219, v17
    v_mov_b32 v208, 0
    v_mfma_f32_16x16x32_bf16 v[236:239], v[148:151], v[52:55], v[236:239]
    ds_read_b128 v[48:51], v30 offset:7552
    s_waitcnt lgkmcnt(5)
    v_mfma_f32_16x16x32_bf16 v[200:203], v[136:139], v[60:63], v[200:203]
    s_add_u32 m0, s86, 0
    s_nop 0
    buffer_load_dwordx4 v44, s[44:47], s87 offen offset:0 lds
    v_mfma_f32_16x16x32_bf16 v[200:203], v[140:143], v[56:59], v[200:203]
    ds_read_b128 v[52:55], v30 offset:7424
    v_add_f32 v230, v230, v20
    v_mfma_f32_16x16x32_bf16 v[212:215], v[148:151], v[56:59], v[212:215]
    v_add_f32 v231, v231, v21
    v_mov_b32 v209, 0
    v_mfma_f32_16x16x32_bf16 v[212:215], v[144:147], v[60:63], v[212:215]
    v_mov_b32 v196, 0
    v_mov_b32 v197, 0
    v_mfma_f32_16x16x32_bf16 v[224:227], v[168:171], v[60:63], v[224:227]
    v_mfma_f32_16x16x32_bf16 v[224:227], v[172:175], v[56:59], v[224:227]
    s_add_u32 m0, s86, 960
    s_nop 0
    buffer_load_dwordx4 v44, s[44:47], s87 offen offset:64 lds
    v_mfma_f32_16x16x32_bf16 v[236:239], v[180:183], v[56:59], v[236:239]
    v_mfma_f32_16x16x32_bf16 v[236:239], v[176:179], v[60:63], v[236:239]
    ds_read_b128 v[56:59], v30 offset:5760
    s_waitcnt lgkmcnt(5)
    v_mfma_f32_16x16x32_bf16 v[224:227], v[148:151], v[68:71], v[224:227]
    ds_read_b128 v[60:63], v30 offset:5632
    v_mfma_f32_16x16x32_bf16 v[224:227], v[144:147], v[64:67], v[224:227]
    s_add_u32 m0, s86, 1920
    s_nop 0
    buffer_load_dwordx4 v44, s[44:47], s87 offen offset:128 lds
    v_mfma_f32_16x16x32_bf16 v[236:239], v[152:155], v[64:67], v[236:239]
    s_waitcnt vmcnt(10)
    v_cmp_ne_u32 vcc, s7, v13
    s_cbranch_vccnz Lslow_5
Lback_6:
    v_mfma_f32_16x16x32_bf16 v[236:239], v[156:159], v[68:71], v[236:239]
    v_add_u32 v2, s30, v1
    s_waitcnt lgkmcnt(4)
    v_mfma_f32_16x16x32_bf16 v[200:203], v[128:131], v[76:79], v[200:203]
    ds_read_b128 v[64:67], v30 offset:4608
    v_mfma_f32_16x16x32_bf16 v[200:203], v[132:135], v[72:75], v[200:203]
    ds_read_b128 v[68:71], v30 offset:4736
    v_mfma_f32_16x16x32_bf16 v[212:215], v[140:143], v[72:75], v[212:215]
    buffer_load_dwordx4 v[112:115], v2, s[56:59], s16 offen sc1
    v_mfma_f32_16x16x32_bf16 v[212:215], v[136:139], v[76:79], v[212:215]
    v_mfma_f32_16x16x32_bf16 v[224:227], v[160:163], v[76:79], v[224:227]
    v_mfma_f32_16x16x32_bf16 v[224:227], v[164:167], v[72:75], v[224:227]
    v_mfma_f32_16x16x32_bf16 v[236:239], v[172:175], v[72:75], v[236:239]
    buffer_load_dwordx4 v[116:119], v2, s[56:59], s17 offen sc1
    v_mfma_f32_16x16x32_bf16 v[236:239], v[168:171], v[76:79], v[236:239]
    ds_read_b128 v[72:75], v30 offset:5504
    s_waitcnt lgkmcnt(5)
    v_mfma_f32_16x16x32_bf16 v[212:215], v[128:131], v[48:51], v[212:215]
    ds_read_b128 v[76:79], v30 offset:5376
    v_mfma_f32_16x16x32_bf16 v[212:215], v[132:135], v[52:55], v[212:215]
    v_mfma_f32_16x16x32_bf16 v[224:227], v[156:159], v[52:55], v[224:227]
    v_mfma_f32_16x16x32_bf16 v[224:227], v[152:155], v[48:51], v[224:227]
    buffer_load_dwordx4 v[120:123], v2, s[56:59], s18 offen sc1
    v_mfma_f32_16x16x32_bf16 v[236:239], v[160:163], v[48:51], v[236:239]
    v_mfma_f32_16x16x32_bf16 v[236:239], v[164:167], v[52:55], v[236:239]
    ds_read_b128 v[48:51], v30 offset:4864
    s_waitcnt lgkmcnt(5)
    v_mfma_f32_16x16x32_bf16 v[218:221], v[140:143], v[60:63], v[218:221]
    ds_read_b128 v[52:55], v30 offset:4992
    v_mfma_f32_16x16x32_bf16 v[218:221], v[136:139], v[56:59], v[218:221]
    buffer_load_dwordx4 v[124:127], v2, s[56:59], s19 offen sc1
    v_mfma_f32_16x16x32_bf16 v[230:233], v[144:147], v[56:59], v[230:233]
    v_mfma_f32_16x16x32_bf16 v[230:233], v[148:151], v[60:63], v[230:233]
    ds_read_b128 v[56:59], v30 offset:5248
    s_waitcnt lgkmcnt(5)
    v_mfma_f32_16x16x32_bf16 v[194:197], v[136:139], v[68:71], v[194:197]
    ds_read_b128 v[60:63], v30 offset:5120
    v_mfma_f32_16x16x32_bf16 v[194:197], v[140:143], v[64:67], v[194:197]
    v_mfma_f32_16x16x32_bf16 v[206:209], v[148:151], v[64:67], v[206:209]
    buffer_load_dwordx4 v[240:243], v2, s[56:59], s20 offen sc1
    v_mfma_f32_16x16x32_bf16 v[206:209], v[144:147], v[68:71], v[206:209]
    v_mfma_f32_16x16x32_bf16 v[218:221], v[168:171], v[68:71], v[218:221]
    v_mfma_f32_16x16x32_bf16 v[218:221], v[172:175], v[64:67], v[218:221]
    v_mfma_f32_16x16x32_bf16 v[230:233], v[180:183], v[64:67], v[230:233]
    buffer_load_dwordx4 v[244:247], v2, s[56:59], s21 offen sc1
    v_mfma_f32_16x16x32_bf16 v[230:233], v[176:179], v[68:71], v[230:233]
    s_waitcnt lgkmcnt(4)
    v_mfma_f32_16x16x32_bf16 v[218:221], v[148:151], v[76:79], v[218:221]
    v_mfma_f32_16x16x32_bf16 v[218:221], v[144:147], v[72:75], v[218:221]
    v_mfma_f32_16x16x32_bf16 v[230:233], v[152:155], v[72:75], v[230:233]
    v_mfma_f32_16x16x32_bf16 v[230:233], v[156:159], v[76:79], v[230:233]
    s_waitcnt lgkmcnt(2)
    v_mfma_f32_16x16x32_bf16 v[194:197], v[128:131], v[52:55], v[194:197]
    buffer_load_dwordx4 v[248:251], v2, s[56:59], s22 offen sc1
    v_mfma_f32_16x16x32_bf16 v[194:197], v[132:135], v[48:51], v[194:197]
    v_mfma_f32_16x16x32_bf16 v[206:209], v[140:143], v[48:51], v[206:209]
    v_mfma_f32_16x16x32_bf16 v[206:209], v[136:139], v[52:55], v[206:209]
    buffer_load_dwordx4 v[252:255], v2, s[56:59], s23 offen sc1
    v_mfma_f32_16x16x32_bf16 v[218:221], v[160:163], v[52:55], v[218:221]
    v_mfma_f32_16x16x32_bf16 v[218:221], v[164:167], v[48:51], v[218:221]
    v_mfma_f32_16x16x32_bf16 v[230:233], v[172:175], v[48:51], v[230:233]
    v_mfma_f32_16x16x32_bf16 v[230:233], v[168:171], v[52:55], v[230:233]
    s_waitcnt lgkmcnt(0)
    v_mfma_f32_16x16x32_bf16 v[206:209], v[128:131], v[56:59], v[206:209]
    buffer_load_dwordx4 v[16:19], v2, s[56:59], s24 offen sc1
    v_mfma_f32_16x16x32_bf16 v[206:209], v[132:135], v[60:63], v[206:209]
    v_mfma_f32_16x16x32_bf16 v[218:221], v[156:159], v[60:63], v[218:221]
    v_mfma_f32_16x16x32_bf16 v[218:221], v[152:155], v[56:59], v[218:221]
    v_mfma_f32_16x16x32_bf16 v[230:233], v[160:163], v[56:59], v[230:233]
    buffer_load_dwordx4 v[20:23], v2, s[56:59], s25 offen sc1
    v_mfma_f32_16x16x32_bf16 v[230:233], v[164:167], v[60:63], v[230:233]
LG_g2:
Lst_3837:
    s_cbranch_execz L_hopback
    s_nop 0
    s_waitcnt vmcnt(13)
    s_waitcnt vmcnt(8)
    v_mfma_f32_16x16x32_bf16 v[128:131], a[0:3], v[112:115], 0
    buffer_load_dwordx4 v[24:27], v2, s[56:59], s26 offen sc1
    v_mfma_f32_16x16x32_bf16 v[128:131], a[20:23], v[116:119], v[128:131]
    v_add_f32 v201, v201, v196
    v_add_f32 v202, v202, v197
    v_mfma_f32_16x16x32_bf16 v[132:135], a[24:27], v[116:119], 0
    ds_write_b128 v4, v[200:203] offset:0
    v_mfma_f32_16x16x32_bf16 v[132:135], a[4:7], v[112:115], v[132:135]
    v_add_f32 v213, v213, v208
    v_add_f32 v214, v214, v209
    v_mfma_f32_16x16x32_bf16 v[136:139], a[8:11], v[112:115], 0
    ds_write_b128 v5, v[212:215] offset:0
    v_mfma_f32_16x16x32_bf16 v[136:139], a[28:31], v[116:119], v[136:139]
    buffer_load_dwordx4 v[28:31], v2, s[56:59], s27 offen sc1
    v_mfma_f32_16x16x32_bf16 v[140:143], a[32:35], v[116:119], 0
    v_add_f32 v225, v225, v220
    v_add_f32 v226, v226, v221
    v_mfma_f32_16x16x32_bf16 v[140:143], a[12:15], v[112:115], v[140:143]
    ds_write_b128 v4, v[224:227] offset:4096
    v_mfma_f32_16x16x32_bf16 v[144:147], a[16:19], v[112:115], 0
    v_add_f32 v237, v237, v232
    v_add_f32 v238, v238, v233
    v_mfma_f32_16x16x32_bf16 v[144:147], a[36:39], v[116:119], v[144:147]
    s_waitcnt vmcnt(8)
    v_mfma_f32_16x16x32_bf16 v[128:131], a[40:43], v[120:123], v[128:131]
    buffer_load_dwordx4 v[112:115], v2, s[56:59], s28 offen sc1
    v_mfma_f32_16x16x32_bf16 v[128:131], a[60:63], v[124:127], v[128:131]
    ds_write_b128 v5, v[236:239] offset:4096
    v_mfma_f32_16x16x32_bf16 v[132:135], a[64:67], v[124:127], v[132:135]
    v_add_f32 v193, v193, v198
    v_add_f32_e64 v194, v194, v199
    v_mfma_f32_16x16x32_bf16 v[132:135], a[44:47], v[120:123], v[132:135]
    v_add_f32 v195, v195, v200
    v_add_f32 v205, v205, v210
    v_mfma_f32_16x16x32_bf16 v[136:139], a[48:51], v[120:123], v[136:139]
    v_add_f32 v206, v206, v211
    v_add_f32 v207, v207, v212
    v_mfma_f32_16x16x32_bf16 v[136:139], a[68:71], v[124:127], v[136:139]
    buffer_load_dwordx4 v[116:119], v2, s[56:59], s29 offen sc1
    v_mfma_f32_16x16x32_bf16 v[140:143], a[72:75], v[124:127], v[140:143]
    v_add_f32 v217, v217, v222
    v_add_f32 v218, v218, v223
    v_mfma_f32_16x16x32_bf16 v[140:143], a[52:55], v[120:123], v[140:143]
    v_add_u32_e64 v3, s31, v1
    v_mfma_f32_16x16x32_bf16 v[144:147], a[56:59], v[120:123], v[144:147]
    s_waitcnt lgkmcnt(0)
    s_barrier
    ds_read_b128 v[48:51], v6 offset:0
    v_mfma_f32_16x16x32_bf16 v[144:147], a[76:79], v[124:127], v[144:147]
    ds_read_b128 v[56:59], v6 offset:4096
    s_waitcnt vmcnt(8)
    v_mfma_f32_16x16x32_bf16 v[128:131], a[80:83], v[240:243], v[128:131]
    buffer_load_dwordx4 v[120:123], v3, s[56:59], s16 offen sc1
    v_mfma_f32_16x16x32_bf16 v[128:131], a[100:103], v[244:247], v[128:131]
    ds_read_b128 v[52:55], v7 offset:0
    v_mfma_f32_16x16x32_bf16 v[132:135], a[104:107], v[244:247], v[132:135]
    ds_read_b128 v[60:63], v7 offset:4096
    v_add_f32 v219, v219, v224
    v_mfma_f32_16x16x32_bf16 v[132:135], a[84:87], v[240:243], v[132:135]
    v_add_f32 v229, v229, v234
    v_add_f32 v230, v230, v235
    v_mfma_f32_16x16x32_bf16 v[136:139], a[88:91], v[240:243], v[136:139]
    v_add_f32_e64 v231, v231, v236
    v_mfma_f32_16x16x32_bf16 v[136:139], a[108:111], v[244:247], v[136:139]
    buffer_load_dwordx4 v[124:127], v3, s[56:59], s17 offen sc1
    v_mfma_f32_16x16x32_bf16 v[140:143], a[112:115], v[244:247], v[140:143]
    s_waitcnt lgkmcnt(3)
    v_add_f32 v192, v192, v49
    v_add_f32_e64 v193, v193, v50
    v_mfma_f32_16x16x32_bf16 v[140:143], a[92:95], v[240:243], v[140:143]
    v_add_f32_e64 v194, v194, v51
    v_cvt_pk_bf16_f32 v64, v192, v193
    v_mfma_f32_16x16x32_bf16 v[144:147], a[96:99], v[240:243], v[144:147]
    v_cvt_pk_bf16_f32 v65, v194, v195
    s_waitcnt lgkmcnt(2)
    v_mfma_f32_16x16x32_bf16 v[144:147], a[116:119], v[244:247], v[144:147]
    v_add_f32_e64 v216, v216, v57
    s_waitcnt vmcnt(8)
    v_mfma_f32_16x16x32_bf16 v[128:131], a[120:123], v[248:251], v[128:131]
    buffer_load_dwordx4 v[240:243], v3, s[56:59], s18 offen sc1
    v_mfma_f32_16x16x32_bf16 v[128:131], a[140:143], v[252:255], v[128:131]
    v_add_f32 v217, v217, v58
    v_add_f32 v218, v218, v59
    v_mfma_f32_16x16x32_bf16 v[132:135], a[144:147], v[252:255], v[132:135]
    v_cvt_pk_bf16_f32 v66, v216, v217
    v_cvt_pk_bf16_f32 v67, v218, v219
    v_mfma_f32_16x16x32_bf16 v[132:135], a[124:127], v[248:251], v[132:135]
    v_permlane16_swap_b32 v64, v66
    v_permlane16_swap_b32 v65, v67
    v_mfma_f32_16x16x32_bf16 v[136:139], a[128:131], v[248:251], v[136:139]
    buffer_load_dwordx4 v[244:247], v3, s[56:59], s19 offen sc1
    v_mfma_f32_16x16x32_bf16 v[136:139], a[148:151], v[252:255], v[136:139]
    buffer_store_dwordx4 v[64:67], v11, s[56:59], s38 offen sc1
    v_mfma_f32_16x16x32_bf16 v[140:143], a[152:155], v[252:255], v[140:143]
    s_waitcnt lgkmcnt(1)
    v_add_f32 v204, v204, v53
    v_add_f32_e64 v205, v205, v54
    v_mfma_f32_16x16x32_bf16 v[140:143], a[132:135], v[248:251], v[140:143]
    v_add_f32_e64 v206, v206, v55
    v_cvt_pk_bf16_f32 v68, v204, v205
    v_mfma_f32_16x16x32_bf16 v[144:147], a[136:139], v[248:251], v[144:147]
    v_cvt_pk_bf16_f32 v69, v206, v207
    s_waitcnt lgkmcnt(0)
    v_mfma_f32_16x16x32_bf16 v[144:147], a[156:159], v[252:255], v[144:147]
    v_add_f32_e64 v228, v228, v61
    s_waitcnt vmcnt(9)
    v_mfma_f32_16x16x32_bf16 v[128:131], a[160:163], v[16:19], v[128:131]
    v_mfma_f32_16x16x32_bf16 v[128:131], a[180:183], v[20:23], v[128:131]
    v_add_f32 v229, v229, v62
    v_add_f32 v230, v230, v63
    v_mfma_f32_16x16x32_bf16 v[132:135], a[184:187], v[20:23], v[132:135]
    v_cvt_pk_bf16_f32 v70, v228, v229
    v_cvt_pk_bf16_f32 v71, v230, v231
    v_mfma_f32_16x16x32_bf16 v[132:135], a[164:167], v[16:19], v[132:135]
    v_permlane16_swap_b32 v68, v70
    v_permlane16_swap_b32 v69, v71
    v_mfma_f32_16x16x32_bf16 v[136:139], a[168:171], v[16:19], v[136:139]
    buffer_load_dwordx4 v[248:251], v3, s[56:59], s20 offen sc1
    v_mfma_f32_16x16x32_bf16 v[136:139], a[188:191], v[20:23], v[136:139]
    buffer_store_dwordx4 v[68:71], v12, s[56:59], s38 offen sc1
    v_mfma_f32_16x16x32_bf16 v[140:143], a[192:195], v[20:23], v[140:143]
    s_lshl_b32 s10, s12, 7
    s_add_u32 s10, s10, 204800
    s_mul_i32 s32, s41, 15360
Lst_3965:
    s_cbranch_execz L_hopback
    s_nop 0
    v_mfma_f32_16x16x32_bf16 v[140:143], a[172:175], v[16:19], v[140:143]
    s_cmp_eq_u32 s3, 0
    s_cselect_b32 s10, s10, 15040512
    v_mov_b32_e64 v15, s7
    v_mfma_f32_16x16x32_bf16 v[144:147], a[176:179], v[16:19], v[144:147]
    s_add_u32 s32, s32, 98304
    v_add_u32 v14, s32, v1
    s_add_u32 s32, s41, 1
    v_mfma_f32_16x16x32_bf16 v[144:147], a[196:199], v[20:23], v[144:147]
    s_and_b32 s32, s32, 3
    s_mul_i32 s32, s32, 15360
    s_waitcnt vmcnt(9)
    v_mfma_f32_16x16x32_bf16 v[128:131], a[200:203], v[24:27], v[128:131]
    s_add_u32 s32, s32, 98304
    v_add_u32 v8, s32, v1
    s_add_u32 s32, s41, 2
    v_mfma_f32_16x16x32_bf16 v[128:131], a[220:223], v[28:31], v[128:131]
    s_and_b32 s32, s32, 3
    s_mul_i32 s32, s32, 15360
    s_add_u32 s32, s32, 103424
    v_mfma_f32_16x16x32_bf16 v[132:135], a[224:227], v[28:31], v[132:135]
    buffer_load_dwordx4 v[252:255], v3, s[56:59], s21 offen sc1
    v_mfma_f32_16x16x32_bf16 v[132:135], a[204:207], v[24:27], v[132:135]
    v_add_u32_e64 v9, s32, v1
    s_add_u32 s32, s41, 3
    v_mfma_f32_16x16x32_bf16 v[136:139], a[208:211], v[24:27], v[136:139]
    s_and_b32 s32, s32, 3
    s_mul_i32 s32, s32, 15360
    s_add_u32 s32, s32, 108544
    v_mfma_f32_16x16x32_bf16 v[136:139], a[228:231], v[28:31], v[136:139]
    v_add_u32 v10, s32, v1
    v_and_b32_e64 v34, 15, v0
    v_mfma_f32_16x16x32_bf16 v[140:143], a[232:235], v[28:31], v[140:143]
    buffer_load_dwordx4 v[16:19], v3, s[56:59], s22 offen sc1
    v_mfma_f32_16x16x32_bf16 v[140:143], a[212:215], v[24:27], v[140:143]
    v_lshrrev_b32_e64 v35, 4, v0
    v_mul_u32_u24 v47, 1280, v34
    v_mfma_f32_16x16x32_bf16 v[144:147], a[216:219], v[24:27], v[144:147]
    v_lshl_add_u32 v46, v35, 4, v47
    v_lshl_add_u32 v47, v35, 3, v47
    v_mfma_f32_16x16x32_bf16 v[144:147], a[236:239], v[28:31], v[144:147]
    v_lshl_add_u32 v34, v34, 6, s86
    s_waitcnt vmcnt(9)
    v_mfma_f32_16x16x32_bf16 v[128:131], a[240:243], v[112:115], v[128:131]
    v_lshl_add_u32 v33, v35, 3, v34
    v_lshl_add_u32 v34, v35, 4, v34
    v_mfma_f32_16x16x32_bf16 v[128:131], v[92:95], v[116:119], v[128:131]
    buffer_load_dwordx4 v[20:23], v3, s[56:59], s23 offen sc1
    v_mfma_f32_16x16x32_bf16 v[132:135], v[96:99], v[116:119], v[132:135]
    ds_read_b128 v[36:39], v34
    v_mfma_f32_16x16x32_bf16 v[132:135], a[244:247], v[112:115], v[132:135]
    ds_read_b128 v[40:43], v34 offset:1024
    v_mfma_f32_16x16x32_bf16 v[136:139], v[80:83], v[112:115], v[136:139]
    ds_read_b64 v[44:45], v33 offset:2048
    v_mfma_f32_16x16x32_bf16 v[136:139], v[100:103], v[116:119], v[136:139]
    buffer_load_dwordx4 v[24:27], v3, s[56:59], s24 offen sc1
    v_mfma_f32_16x16x32_bf16 v[140:143], v[104:107], v[116:119], v[140:143]
    v_mfma_f32_16x16x32_bf16 v[140:143], v[84:87], v[112:115], v[140:143]
    v_mfma_f32_16x16x32_bf16 v[144:147], v[88:91], v[112:115], v[144:147]
    v_mfma_f32_16x16x32_bf16 v[144:147], v[108:111], v[116:119], v[144:147]
    s_waitcnt vmcnt(9)
    v_mfma_f32_16x16x32_bf16 v[148:151], a[0:3], v[120:123], 0
    buffer_load_dwordx4 v[28:31], v3, s[56:59], s25 offen sc1
    v_mfma_f32_16x16x32_bf16 v[148:151], a[20:23], v[124:127], v[148:151]
    v_mfma_f32_16x16x32_bf16 v[152:155], a[24:27], v[124:127], 0
    ds_write_b128 v8, v[128:131] offset:0
    v_mfma_f32_16x16x32_bf16 v[152:155], a[4:7], v[120:123], v[152:155]
    s_waitcnt lgkmcnt(1)
    v_lshlrev_b32 v208, 16, v36
    v_and_b32_e64 v209, s6, v36
    v_mfma_f32_16x16x32_bf16 v[156:159], a[8:11], v[120:123], 0
    buffer_load_dwordx4 v[112:115], v3, s[56:59], s26 offen sc1
    v_mfma_f32_16x16x32_bf16 v[156:159], a[28:31], v[124:127], v[156:159]
    v_lshlrev_b32 v210, 16, v37
    v_and_b32 v211, s6, v37
    v_mfma_f32_16x16x32_bf16 v[160:163], a[32:35], v[124:127], 0
    ds_write_b128 v8, v[132:135] offset:1024
    v_mfma_f32_16x16x32_bf16 v[160:163], a[12:15], v[120:123], v[160:163]
    v_lshlrev_b32 v212, 16, v38
    v_and_b32 v213, s6, v38
    v_mfma_f32_16x16x32_bf16 v[164:167], a[16:19], v[120:123], 0
    buffer_load_dwordx4 v[116:119], v3, s[56:59], s27 offen sc1
    v_mfma_f32_16x16x32_bf16 v[164:167], a[36:39], v[124:127], v[164:167]
    v_lshlrev_b32 v214, 16, v39
    s_waitcnt vmcnt(10)
    v_mfma_f32_16x16x32_bf16 v[148:151], a[40:43], v[240:243], v[148:151]
    v_and_b32 v215, s6, v39
    v_lshlrev_b32 v216, 16, v40
    v_mfma_f32_16x16x32_bf16 v[148:151], a[60:63], v[244:247], v[148:151]
    ds_write_b128 v8, v[136:139] offset:2048
    v_mfma_f32_16x16x32_bf16 v[152:155], a[64:67], v[244:247], v[152:155]
    v_and_b32 v217, s6, v40
    v_lshlrev_b32 v218, 16, v41
    v_mfma_f32_16x16x32_bf16 v[152:155], a[44:47], v[240:243], v[152:155]
    buffer_load_dwordx4 v[120:123], v3, s[56:59], s28 offen sc1
    v_mfma_f32_16x16x32_bf16 v[156:159], a[48:51], v[240:243], v[156:159]
    v_and_b32 v219, s6, v41
    v_lshlrev_b32 v220, 16, v42
    v_mfma_f32_16x16x32_bf16 v[156:159], a[68:71], v[244:247], v[156:159]
    v_and_b32 v221, s6, v42
    v_lshlrev_b32 v222, 16, v43
    v_mfma_f32_16x16x32_bf16 v[160:163], a[72:75], v[244:247], v[160:163]
    ds_write_b128 v8, v[140:143] offset:3072
    v_mfma_f32_16x16x32_bf16 v[160:163], a[52:55], v[240:243], v[160:163]
    s_waitcnt vmcnt(8)
    s_barrier
    v_add_u32_e64 v2, s40, v1
    v_mfma_f32_16x16x32_bf16 v[164:167], a[56:59], v[240:243], v[164:167]
    buffer_load_dwordx4 v[124:127], v2, s[56:59], s16 offen sc1
    v_mfma_f32_16x16x32_bf16 v[164:167], a[76:79], v[244:247], v[164:167]
    v_and_b32 v223, s6, v43
    s_waitcnt vmcnt(8)
    v_mfma_f32_16x16x32_bf16 v[148:151], a[80:83], v[248:251], v[148:151]
    s_mov_b64 exec, 1
    buffer_store_dword v15, off, s[56:59], s10 sc1
    s_mov_b64 exec, -1
    v_mfma_f32_16x16x32_bf16 v[148:151], a[100:103], v[252:255], v[148:151]
    ds_write_b128 v8, v[144:147] offset:4096
    v_mfma_f32_16x16x32_bf16 v[152:155], a[104:107], v[252:255], v[152:155]
    v_lshlrev_b32 v224, 16, v44
    v_and_b32 v225, s6, v44
    v_mfma_f32_16x16x32_bf16 v[152:155], a[84:87], v[248:251], v[152:155]
    v_lshlrev_b32 v226, 16, v45
    v_and_b32 v227, s6, v45
    v_mfma_f32_16x16x32_bf16 v[156:159], a[88:91], v[248:251], v[156:159]
    s_cmp_lt_u32 s3, 2
    s_cselect_b32 s34, 2, 1
    v_lshrrev_b32_e64 v4, 4, v0
    v_mfma_f32_16x16x32_bf16 v[156:159], a[108:111], v[252:255], v[156:159]
    buffer_load_dwordx4 v[240:243], v2, s[56:59], s17 offen sc1
    v_mfma_f32_16x16x32_bf16 v[160:163], a[112:115], v[252:255], v[160:163]
    v_min_u32_e64 v4, s34, v4
    v_lshl_add_u32 v4, v4, 2, s3
    v_mfma_f32_16x16x32_bf16 v[160:163], a[92:95], v[248:251], v[160:163]
    v_bfe_u32 v5, v0, 2, 2
    v_lshl_add_u32 v4, v4, 2, v5
    v_mfma_f32_16x16x32_bf16 v[164:167], a[96:99], v[248:251], v[164:167]
    v_mul_u32_u24 v5, 86, v4
    v_lshrrev_b32_e64 v5, 8, v5
    v_mfma_f32_16x16x32_bf16 v[164:167], a[116:119], v[252:255], v[164:167]
    v_add_u32 v5, 18, v5
    s_waitcnt vmcnt(8)
    v_mfma_f32_16x16x32_bf16 v[148:151], a[120:123], v[16:19], v[148:151]
    buffer_load_dwordx4 v[244:247], v2, s[56:59], s18 offen sc1
    v_mfma_f32_16x16x32_bf16 v[148:151], a[140:143], v[20:23], v[148:151]
    v_lshrrev_b32 v7, 1, v4
    v_add_u32 v7, 12, v7
    v_mfma_f32_16x16x32_bf16 v[152:155], a[144:147], v[20:23], v[152:155]
    v_max_u32 v5, v5, v7
    v_min_u32 v4, v4, v5
    v_mfma_f32_16x16x32_bf16 v[152:155], a[124:127], v[16:19], v[152:155]
    buffer_load_dwordx4 v[248:251], v2, s[56:59], s19 offen sc1
    v_mfma_f32_16x16x32_bf16 v[156:159], a[128:131], v[16:19], v[156:159]
    s_lshl_b32 s34, s81, 12
    s_add_u32 s34, s34, 204800
    v_lshl_add_u32 v4, v4, 7, s34
    v_mfma_f32_16x16x32_bf16 v[156:159], a[148:151], v[20:23], v[156:159]
    v_lshrrev_b32 v34, 4, v0
    v_bfe_u32 v35, v0, 2, 2
    v_mfma_f32_16x16x32_bf16 v[160:163], a[152:155], v[20:23], v[160:163]
    v_lshl_add_u32 v32, v34, 3, v35
    v_lshl_add_u32 v33, v34, 2, v35
    v_mfma_f32_16x16x32_bf16 v[160:163], a[132:135], v[16:19], v[160:163]
    v_mul_u32_u24 v32, 128, v32
    v_mul_u32_u24 v33, 128, v33
    v_mfma_f32_16x16x32_bf16 v[164:167], a[136:139], v[16:19], v[164:167]
    buffer_load_dwordx4 v[252:255], v2, s[56:59], s20 offen sc1
    v_mfma_f32_16x16x32_bf16 v[164:167], a[156:159], v[20:23], v[164:167]
    v_and_b32 v34, 1, v0
    s_waitcnt vmcnt(9)
    v_mfma_f32_16x16x32_bf16 v[148:151], a[160:163], v[24:27], v[148:151]
    v_and_b32 v35, 2, v0
    s_lshl_b32 s8, s41, 4
    v_mfma_f32_16x16x32_bf16 v[148:151], a[180:183], v[28:31], v[148:151]
    v_lshl_add_u32 v34, v34, 3, s8
    v_lshl_add_u32 v34, v35, 5, v34
    v_mfma_f32_16x16x32_bf16 v[152:155], a[184:187], v[28:31], v[152:155]
    buffer_load_dwordx4 v[16:19], v2, s[56:59], s21 offen sc1
    v_mfma_f32_16x16x32_bf16 v[152:155], a[164:167], v[24:27], v[152:155]
    v_add_u32 v32, v32, v34
    v_add_u32 v33, v33, v34
    v_mfma_f32_16x16x32_bf16 v[156:159], a[168:171], v[24:27], v[156:159]
    s_mul_i32 s8, s81, 10
    s_add_u32 s8, s8, s3
    s_mul_i32 s8, s8, 33792
    v_mfma_f32_16x16x32_bf16 v[156:159], a[188:191], v[28:31], v[156:159]
    s_lshl_b32 s9, s80, 7
    s_add_u32 s8, s8, s9
    s_add_u32 s8, s8, 5259264
    v_mfma_f32_16x16x32_bf16 v[160:163], a[192:195], v[28:31], v[160:163]
    s_add_u32 s9, s8, 135168
    s_add_u32 s10, s8, 270336
    v_mfma_f32_16x16x32_bf16 v[160:163], a[172:175], v[24:27], v[160:163]
    buffer_load_dwordx4 v[20:23], v2, s[56:59], s22 offen sc1
    v_mfma_f32_16x16x32_bf16 v[164:167], a[176:179], v[24:27], v[164:167]
    s_cmp_lt_u32 s3, 2
    s_cselect_b32 s10, s10, 15040512
    v_lshrrev_b32 v34, 3, v0
    v_mfma_f32_16x16x32_bf16 v[164:167], a[196:199], v[28:31], v[164:167]
    v_and_b32 v35, 7, v0
    s_waitcnt vmcnt(8)
    v_mfma_f32_16x16x32_bf16 v[148:151], a[200:203], v[112:115], v[148:151]
    v_mul_u32_u24 v34, 4224, v34
    v_lshl_add_u32 v13, v35, 4, v34
    v_mfma_f32_16x16x32_bf16 v[148:151], a[220:223], v[116:119], v[148:151]
    buffer_load_dwordx4 v[24:27], v2, s[56:59], s23 offen sc1
    v_mfma_f32_16x16x32_bf16 v[148:151], a[240:243], v[120:123], v[148:151]
    s_lshl_b32 s35, s3, 10
    v_mfma_f32_16x16x32_bf16 v[152:155], a[244:247], v[120:123], v[152:155]
    v_mfma_f32_16x16x32_bf16 v[152:155], a[224:227], v[116:119], v[152:155]
    v_mfma_f32_16x16x32_bf16 v[152:155], a[204:207], v[112:115], v[152:155]
    buffer_load_dwordx4 v[28:31], v2, s[56:59], s24 offen sc1
    v_mfma_f32_16x16x32_bf16 v[156:159], a[208:211], v[112:115], v[156:159]
    v_mfma_f32_16x16x32_bf16 v[156:159], a[228:231], v[116:119], v[156:159]
    v_mfma_f32_16x16x32_bf16 v[156:159], v[80:83], v[120:123], v[156:159]
    v_mfma_f32_16x16x32_bf16 v[160:163], v[84:87], v[120:123], v[160:163]
    v_mfma_f32_16x16x32_bf16 v[160:163], a[232:235], v[116:119], v[160:163]
    v_mfma_f32_16x16x32_bf16 v[160:163], a[212:215], v[112:115], v[160:163]
    v_mfma_f32_16x16x32_bf16 v[164:167], a[216:219], v[112:115], v[164:167]
    buffer_load_dwordx4 v[112:115], v2, s[56:59], s25 offen sc1
    v_mfma_f32_16x16x32_bf16 v[164:167], a[236:239], v[116:119], v[164:167]
    v_mfma_f32_16x16x32_bf16 v[164:167], v[88:91], v[120:123], v[164:167]
    s_waitcnt vmcnt(8)
    v_mfma_f32_16x16x32_bf16 v[128:131], a[0:3], v[124:127], 0
    buffer_load_dwordx4 v[116:119], v2, s[56:59], s26 offen sc1
    v_mfma_f32_16x16x32_bf16 v[128:131], a[20:23], v[240:243], v[128:131]
    v_mfma_f32_16x16x32_bf16 v[132:135], a[24:27], v[240:243], 0
    ds_write_b128 v9, v[148:151] offset:0
    v_mfma_f32_16x16x32_bf16 v[132:135], a[4:7], v[124:127], v[132:135]
    v_mfma_f32_16x16x32_bf16 v[136:139], a[8:11], v[124:127], 0
    buffer_load_dwordx4 v[120:123], v2, s[56:59], s27 offen sc1
    v_mfma_f32_16x16x32_bf16 v[136:139], a[28:31], v[240:243], v[136:139]
    v_mfma_f32_16x16x32_bf16 v[140:143], a[32:35], v[240:243], 0
    ds_write_b128 v9, v[152:155] offset:1024
    v_mfma_f32_16x16x32_bf16 v[140:143], a[12:15], v[124:127], v[140:143]
    v_mfma_f32_16x16x32_bf16 v[144:147], a[16:19], v[124:127], 0
    v_mfma_f32_16x16x32_bf16 v[144:147], a[36:39], v[240:243], v[144:147]
    s_waitcnt vmcnt(8)
    v_mfma_f32_16x16x32_bf16 v[128:131], a[40:43], v[244:247], v[128:131]
    buffer_load_dwordx4 v[124:127], v2, s[56:59], s28 offen sc1
    v_mfma_f32_16x16x32_bf16 v[128:131], a[60:63], v[248:251], v[128:131]
    ds_write_b128 v9, v[156:159] offset:2048
    v_mfma_f32_16x16x32_bf16 v[132:135], a[64:67], v[248:251], v[132:135]
    v_mfma_f32_16x16x32_bf16 v[132:135], a[44:47], v[244:247], v[132:135]
    buffer_load_dwordx4 v[240:243], v2, s[56:59], s29 offen sc1
    v_mfma_f32_16x16x32_bf16 v[136:139], a[48:51], v[244:247], v[136:139]
    v_mfma_f32_16x16x32_bf16 v[136:139], a[68:71], v[248:251], v[136:139]
    v_mfma_f32_16x16x32_bf16 v[140:143], a[72:75], v[248:251], v[140:143]
    ds_write_b128 v9, v[160:163] offset:3072
    v_mfma_f32_16x16x32_bf16 v[140:143], a[52:55], v[244:247], v[140:143]
    v_add_u32 v3, s84, v1
    v_mfma_f32_16x16x32_bf16 v[144:147], a[56:59], v[244:247], v[144:147]
    buffer_load_dwordx4 v[244:247], v3, s[56:59], s16 offen sc1
    v_mfma_f32_16x16x32_bf16 v[144:147], a[76:79], v[248:251], v[144:147]
    s_waitcnt vmcnt(9)
    v_mfma_f32_16x16x32_bf16 v[128:131], a[80:83], v[252:255], v[128:131]
    v_mfma_f32_16x16x32_bf16 v[128:131], a[100:103], v[16:19], v[128:131]
    ds_write_b128 v9, v[164:167] offset:4096
    v_mfma_f32_16x16x32_bf16 v[132:135], a[104:107], v[16:19], v[132:135]
    buffer_load_dwordx4 v[248:251], v3, s[56:59], s17 offen sc1
    v_mfma_f32_16x16x32_bf16 v[132:135], a[84:87], v[252:255], v[132:135]
    v_mfma_f32_16x16x32_bf16 v[136:139], a[88:91], v[252:255], v[136:139]
    v_mfma_f32_16x16x32_bf16 v[136:139], a[108:111], v[16:19], v[136:139]
    s_waitcnt lgkmcnt(0)
    s_barrier
    ds_read_b128 v[168:171], v14 offset:0
    v_mfma_f32_16x16x32_bf16 v[140:143], a[112:115], v[16:19], v[140:143]
    ds_read_b128 v[172:175], v14 offset:1024
    v_mfma_f32_16x16x32_bf16 v[140:143], a[92:95], v[252:255], v[140:143]
    ds_read_b128 v[176:179], v14 offset:2048
    v_mfma_f32_16x16x32_bf16 v[144:147], a[96:99], v[252:255], v[144:147]
    buffer_load_dwordx4 v[252:255], v3, s[56:59], s18 offen sc1
    v_mfma_f32_16x16x32_bf16 v[144:147], a[116:119], v[16:19], v[144:147]
    ds_read_b128 v[180:183], v14 offset:3072
    s_waitcnt vmcnt(9)
    v_mfma_f32_16x16x32_bf16 v[128:131], a[120:123], v[20:23], v[128:131]
    buffer_load_dword v6, v4, s[56:59], 0 offen sc1
    v_mfma_f32_16x16x32_bf16 v[128:131], a[140:143], v[24:27], v[128:131]
    ds_read_b128 v[184:187], v14 offset:4096
    v_mfma_f32_16x16x32_bf16 v[132:135], a[144:147], v[24:27], v[132:135]
    ds_read_b128 v[188:191], v14 offset:5120
    v_mfma_f32_16x16x32_bf16 v[132:135], a[124:127], v[20:23], v[132:135]
    ds_read_b128 v[192:195], v14 offset:6144
    v_mfma_f32_16x16x32_bf16 v[136:139], a[128:131], v[20:23], v[136:139]
    buffer_load_dwordx4 v[16:19], v3, s[56:59], s19 offen sc1
    v_mfma_f32_16x16x32_bf16 v[136:139], a[148:151], v[24:27], v[136:139]
    ds_read_b128 v[196:199], v14 offset:7168
    v_mfma_f32_16x16x32_bf16 v[140:143], a[152:155], v[24:27], v[140:143]
    ds_read_b128 v[200:203], v14 offset:8192
    v_mfma_f32_16x16x32_bf16 v[140:143], a[132:135], v[20:23], v[140:143]
    ds_read_b128 v[204:207], v14 offset:9216
    v_mfma_f32_16x16x32_bf16 v[144:147], a[136:139], v[20:23], v[144:147]
    buffer_load_dwordx4 v[20:23], v3, s[56:59], s20 offen sc1
    v_mfma_f32_16x16x32_bf16 v[144:147], a[156:159], v[24:27], v[144:147]
    s_waitcnt vmcnt(10)
    v_mfma_f32_16x16x32_bf16 v[128:131], a[160:163], v[28:31], v[128:131]
    v_mfma_f32_16x16x32_bf16 v[128:131], a[180:183], v[112:115], v[128:131]
    s_waitcnt lgkmcnt(0)
    v_add_f32 v188, v168, v188
    v_add_f32 v189, v169, v189
    v_mfma_f32_16x16x32_bf16 v[132:135], a[184:187], v[112:115], v[132:135]
    v_add_f32 v190, v170, v190
    v_add_f32 v191, v171, v191
    v_mfma_f32_16x16x32_bf16 v[132:135], a[164:167], v[28:31], v[132:135]
    buffer_load_dwordx4 v[24:27], v3, s[56:59], s21 offen sc1
    v_mfma_f32_16x16x32_bf16 v[136:139], a[168:171], v[28:31], v[136:139]
    v_add_f32 v192, v172, v192
    v_add_f32 v193, v173, v193
    v_mfma_f32_16x16x32_bf16 v[136:139], a[188:191], v[112:115], v[136:139]
    v_add_f32 v194, v174, v194
    v_add_f32 v195, v175, v195
    v_mfma_f32_16x16x32_bf16 v[140:143], a[192:195], v[112:115], v[140:143]
    v_add_f32 v196, v176, v196
    v_add_f32 v197, v177, v197
    v_mfma_f32_16x16x32_bf16 v[140:143], a[172:175], v[28:31], v[140:143]
    v_add_f32 v198, v178, v198
    v_add_f32 v199, v179, v199
    v_mfma_f32_16x16x32_bf16 v[144:147], a[176:179], v[28:31], v[144:147]
    buffer_load_dwordx4 v[28:31], v3, s[56:59], s22 offen sc1
    v_mfma_f32_16x16x32_bf16 v[144:147], a[196:199], v[112:115], v[144:147]
    v_add_f32 v200, v180, v200
    s_waitcnt vmcnt(10)
    v_mfma_f32_16x16x32_bf16 v[128:131], a[200:203], v[116:119], v[128:131]
    v_add_f32 v201, v181, v201
    v_add_f32 v202, v182, v202
    v_mfma_f32_16x16x32_bf16 v[128:131], a[220:223], v[120:123], v[128:131]
    v_add_f32 v203, v183, v203
    v_add_f32 v204, v184, v204
    v_mfma_f32_16x16x32_bf16 v[132:135], a[224:227], v[120:123], v[132:135]
    buffer_load_dwordx4 v[112:115], v3, s[56:59], s23 offen sc1
    v_mfma_f32_16x16x32_bf16 v[132:135], a[204:207], v[116:119], v[132:135]
    v_add_f32 v205, v185, v205
    v_add_f32 v206, v186, v206
    v_mfma_f32_16x16x32_bf16 v[136:139], a[208:211], v[116:119], v[136:139]
    v_add_f32_e64 v207, v187, v207
    v_mfma_f32_16x16x32_bf16 v[136:139], a[228:231], v[120:123], v[136:139]
    v_mfma_f32_16x16x32_bf16 v[140:143], a[232:235], v[120:123], v[140:143]
    v_mfma_f32_16x16x32_bf16 v[140:143], a[212:215], v[116:119], v[140:143]
    v_mfma_f32_16x16x32_bf16 v[144:147], a[216:219], v[116:119], v[144:147]
    s_waitcnt vmcnt(5)
    v_cmp_ne_u32_e64 vcc, s7, v6
    s_cbranch_vccnz Lslow_7
Lback_8:
    v_mfma_f32_16x16x32_bf16 v[144:147], a[236:239], v[120:123], v[144:147]
    v_mfma_f32_16x16x32_bf16 v[128:131], a[240:243], v[124:127], v[128:131]
    s_add_u32 m0, s35, 0
    s_nop 0
    buffer_load_dwordx4 v13, s[56:59], s8 offen sc1 lds
    v_mfma_f32_16x16x32_bf16 v[128:131], v[92:95], v[240:243], v[128:131]
    v_mfma_f32_16x16x32_bf16 v[132:135], v[96:99], v[240:243], v[132:135]
    v_mfma_f32_16x16x32_bf16 v[132:135], a[244:247], v[124:127], v[132:135]
    v_mfma_f32_16x16x32_bf16 v[136:139], v[80:83], v[124:127], v[136:139]
    v_mfma_f32_16x16x32_bf16 v[136:139], v[100:103], v[240:243], v[136:139]
    s_add_u32 m0, s35, 4096
    s_nop 0
    buffer_load_dwordx4 v13, s[56:59], s9 offen sc1 lds
    v_mfma_f32_16x16x32_bf16 v[140:143], v[104:107], v[240:243], v[140:143]
    v_mfma_f32_16x16x32_bf16 v[140:143], v[84:87], v[124:127], v[140:143]
    v_mfma_f32_16x16x32_bf16 v[144:147], v[88:91], v[124:127], v[144:147]
    v_mfma_f32_16x16x32_bf16 v[144:147], v[108:111], v[240:243], v[144:147]
    v_mfma_f32_16x16x32_bf16 v[148:151], a[0:3], v[244:247], v[188:191]
    s_add_u32 m0, s35, 8192
    s_nop 0
    buffer_load_dwordx4 v13, s[56:59], s10 offen sc1 lds
    v_mfma_f32_16x16x32_bf16 v[148:151], a[20:23], v[248:251], v[148:151]
    v_mfma_f32_16x16x32_bf16 v[152:155], a[24:27], v[248:251], v[192:195]
    ds_write_b128 v10, v[128:131] offset:0
    v_mfma_f32_16x16x32_bf16 v[152:155], a[4:7], v[244:247], v[152:155]
    v_mfma_f32_16x16x32_bf16 v[156:159], a[8:11], v[244:247], v[196:199]
    v_mfma_f32_16x16x32_bf16 v[156:159], a[28:31], v[248:251], v[156:159]
    buffer_load_dwordx4 v[116:119], v3, s[56:59], s24 offen sc1
    v_mfma_f32_16x16x32_bf16 v[160:163], a[32:35], v[248:251], v[200:203]
    ds_write_b128 v10, v[132:135] offset:1024
    v_mfma_f32_16x16x32_bf16 v[160:163], a[12:15], v[244:247], v[160:163]
    v_mfma_f32_16x16x32_bf16 v[164:167], a[16:19], v[244:247], v[204:207]
    v_mfma_f32_16x16x32_bf16 v[164:167], a[36:39], v[248:251], v[164:167]
    s_waitcnt vmcnt(8)
    v_mfma_f32_16x16x32_bf16 v[148:151], a[40:43], v[252:255], v[148:151]
    buffer_load_dwordx4 v[120:123], v3, s[56:59], s25 offen sc1
    v_mfma_f32_16x16x32_bf16 v[148:151], a[60:63], v[16:19], v[148:151]
    ds_write_b128 v10, v[136:139] offset:2048
    v_mfma_f32_16x16x32_bf16 v[152:155], a[64:67], v[16:19], v[152:155]
    v_mfma_f32_16x16x32_bf16 v[152:155], a[44:47], v[252:255], v[152:155]
    v_mfma_f32_16x16x32_bf16 v[156:159], a[48:51], v[252:255], v[156:159]
    buffer_load_dwordx4 v[124:127], v3, s[56:59], s26 offen sc1
    v_mfma_f32_16x16x32_bf16 v[156:159], a[68:71], v[16:19], v[156:159]
    v_mfma_f32_16x16x32_bf16 v[160:163], a[72:75], v[16:19], v[160:163]
    ds_write_b128 v10, v[140:143] offset:3072
    v_mfma_f32_16x16x32_bf16 v[160:163], a[52:55], v[252:255], v[160:163]
    v_mfma_f32_16x16x32_bf16 v[164:167], a[56:59], v[252:255], v[164:167]
    buffer_load_dwordx4 v[240:243], v3, s[56:59], s27 offen sc1
    v_mfma_f32_16x16x32_bf16 v[164:167], a[76:79], v[16:19], v[164:167]
    s_waitcnt vmcnt(9)
    v_mfma_f32_16x16x32_bf16 v[148:151], a[80:83], v[20:23], v[148:151]
    buffer_load_dwordx4 v[244:247], v3, s[56:59], s28 offen sc1
    v_mfma_f32_16x16x32_bf16 v[148:151], a[100:103], v[24:27], v[148:151]
    ds_write_b128 v10, v[144:147] offset:4096
    v_mfma_f32_16x16x32_bf16 v[152:155], a[104:107], v[24:27], v[152:155]
    v_mfma_f32_16x16x32_bf16 v[152:155], a[84:87], v[20:23], v[152:155]
    v_mfma_f32_16x16x32_bf16 v[156:159], a[88:91], v[20:23], v[156:159]
    v_mfma_f32_16x16x32_bf16 v[156:159], a[108:111], v[24:27], v[156:159]
    v_mfma_f32_16x16x32_bf16 v[160:163], a[112:115], v[24:27], v[160:163]
    v_mfma_f32_16x16x32_bf16 v[160:163], a[92:95], v[20:23], v[160:163]
    v_mfma_f32_16x16x32_bf16 v[164:167], a[96:99], v[20:23], v[164:167]
    v_mfma_f32_16x16x32_bf16 v[164:167], a[116:119], v[24:27], v[164:167]
    s_waitcnt vmcnt(8)
    v_mfma_f32_16x16x32_bf16 v[148:151], a[120:123], v[28:31], v[148:151]
    v_mfma_f32_16x16x32_bf16 v[148:151], a[140:143], v[112:115], v[148:151]
    v_mfma_f32_16x16x32_bf16 v[152:155], a[144:147], v[112:115], v[152:155]
    v_mfma_f32_16x16x32_bf16 v[152:155], a[124:127], v[28:31], v[152:155]
    v_mfma_f32_16x16x32_bf16 v[156:159], a[128:131], v[28:31], v[156:159]
    v_mfma_f32_16x16x32_bf16 v[156:159], a[148:151], v[112:115], v[156:159]
    v_mfma_f32_16x16x32_bf16 v[160:163], a[152:155], v[112:115], v[160:163]
    v_mfma_f32_16x16x32_bf16 v[160:163], a[132:135], v[28:31], v[160:163]
    v_mfma_f32_16x16x32_bf16 v[164:167], a[136:139], v[28:31], v[164:167]
    s_waitcnt vmcnt(5) lgkmcnt(0)
    s_barrier
    ds_read_b64_tr_b16 v[228:229], v32 offset:0
    v_mfma_f32_16x16x32_bf16 v[164:167], a[156:159], v[112:115], v[164:167]
    ds_read_b64_tr_b16 v[230:231], v32 offset:512
    s_waitcnt vmcnt(3)
    v_mfma_f32_16x16x32_bf16 v[148:151], a[160:163], v[116:119], v[148:151]
    ds_read_b64_tr_b16 v[232:233], v32 offset:4096
    v_mfma_f32_16x16x32_bf16 v[148:151], a[180:183], v[120:123], v[148:151]
    ds_read_b64_tr_b16 v[234:235], v32 offset:4608
    v_mfma_f32_16x16x32_bf16 v[152:155], a[184:187], v[120:123], v[152:155]
    ds_read_b64_tr_b16 v[236:237], v33 offset:8192
    v_mfma_f32_16x16x32_bf16 v[152:155], a[164:167], v[116:119], v[152:155]
    ds_read_b128 v[168:171], v14 offset:10240
    v_mfma_f32_16x16x32_bf16 v[156:159], a[168:171], v[116:119], v[156:159]
    ds_read_b128 v[172:175], v14 offset:11264
    v_mfma_f32_16x16x32_bf16 v[156:159], a[188:191], v[120:123], v[156:159]
    ds_read_b128 v[176:179], v14 offset:12288
    v_mfma_f32_16x16x32_bf16 v[160:163], a[192:195], v[120:123], v[160:163]
    ds_read_b128 v[180:183], v14 offset:13312
    v_mfma_f32_16x16x32_bf16 v[160:163], a[172:175], v[116:119], v[160:163]
    ds_read_b128 v[184:187], v14 offset:14336
    s_waitcnt lgkmcnt(5)
    v_mfma_f32_16x16x32_bf16 v[164:167], a[176:179], v[116:119], v[164:167]
    v_lshlrev_b32 v48, 16, v228
    v_and_b32_e64 v49, s6, v228
    v_mfma_f32_16x16x32_bf16 v[164:167], a[196:199], v[120:123], v[164:167]
    v_lshlrev_b32 v50, 16, v229
    s_waitcnt vmcnt(0)
    v_mfma_f32_16x16x32_bf16 v[164:167], a[216:219], v[124:127], v[164:167]
    v_and_b32 v51, s6, v229
    v_lshlrev_b32 v52, 16, v230
    v_mfma_f32_16x16x32_bf16 v[164:167], a[236:239], v[240:243], v[164:167]
    v_and_b32 v53, s6, v230
    v_lshlrev_b32 v54, 16, v231
    v_mfma_f32_16x16x32_bf16 v[164:167], v[88:91], v[244:247], v[164:167]
    v_and_b32 v55, s6, v231
    v_lshlrev_b32 v56, 16, v232
    v_mfma_f32_16x16x32_bf16 v[148:151], a[240:243], v[244:247], v[148:151]
    v_and_b32 v57, s6, v232
    v_lshlrev_b32 v58, 16, v233
    v_mfma_f32_16x16x32_bf16 v[148:151], a[220:223], v[240:243], v[148:151]
    v_and_b32 v59, s6, v233
    v_lshlrev_b32 v60, 16, v234
    v_mfma_f32_16x16x32_bf16 v[148:151], a[200:203], v[124:127], v[148:151]
    v_and_b32 v61, s6, v234
    v_lshlrev_b32 v62, 16, v235
    v_mfma_f32_16x16x32_bf16 v[152:155], a[204:207], v[124:127], v[152:155]
    v_and_b32 v63, s6, v235
    v_lshlrev_b32 v64, 16, v236
    v_mfma_f32_16x16x32_bf16 v[152:155], a[224:227], v[240:243], v[152:155]
    v_and_b32 v65, s6, v236
    v_lshlrev_b32 v66, 16, v237
    v_mfma_f32_16x16x32_bf16 v[152:155], a[244:247], v[244:247], v[152:155]
    v_and_b32 v67, s6, v237
    s_waitcnt lgkmcnt(0)
    v_mfma_f32_16x16x32_bf16 v[156:159], v[80:83], v[244:247], v[156:159]
    v_mfma_f32_16x16x32_bf16 v[156:159], a[228:231], v[240:243], v[156:159]
    v_mfma_f32_16x16x32_bf16 v[156:159], a[208:211], v[124:127], v[156:159]
    v_mfma_f32_16x16x32_bf16 v[160:163], a[212:215], v[124:127], v[160:163]
    v_mfma_f32_16x16x32_bf16 v[160:163], a[232:235], v[240:243], v[160:163]
    v_mfma_f32_16x16x32_bf16 v[160:163], v[84:87], v[244:247], v[160:163]
    v_mov_b32 v34, 0xbfb8aa3b
    v_pk_add_f32 v[164:165], v[164:165], v[184:185]
    v_pk_add_f32 v[166:167], v[166:167], v[186:187]
    v_pk_mul_f32 v[204:205], v[164:165], v[34:35] op_sel_hi:[1,0]
    v_pk_mul_f32 v[206:207], v[166:167], v[34:35] op_sel_hi:[1,0]
    v_exp_f32 v204, v204
    v_exp_f32 v205, v205
    v_exp_f32 v206, v206
    v_exp_f32 v207, v207
    v_pk_mul_f32 v[164:165], v[164:165], v[64:65]
    v_pk_mul_f32 v[166:167], v[166:167], v[66:67]
    v_pk_add_f32 v[204:205], v[204:205], 1.0 op_sel_hi:[1,0]
    v_pk_add_f32 v[206:207], v[206:207], 1.0 op_sel_hi:[1,0]
    v_rcp_f32 v204, v204
    v_rcp_f32 v205, v205
    v_rcp_f32 v206, v206
    v_rcp_f32 v207, v207
    v_pk_fma_f32 v[164:165], v[164:165], v[204:205], v[224:225]
    v_pk_fma_f32 v[166:167], v[166:167], v[206:207], v[226:227]
    v_cvt_pk_bf16_f32 v44, v164, v165
    v_cvt_pk_bf16_f32 v45, v166, v167
    buffer_store_dwordx2 v[44:45], v47, s[60:63], s87 offen offset:128
    v_pk_add_f32 v[148:149], v[148:149], v[168:169]
    v_pk_add_f32 v[150:151], v[150:151], v[170:171]
    v_pk_add_f32 v[152:153], v[152:153], v[172:173]
    v_pk_add_f32 v[154:155], v[154:155], v[174:175]
    v_pk_mul_f32 v[188:189], v[148:149], v[34:35] op_sel_hi:[1,0]
    v_pk_mul_f32 v[190:191], v[150:151], v[34:35] op_sel_hi:[1,0]
    v_pk_mul_f32 v[192:193], v[152:153], v[34:35] op_sel_hi:[1,0]
    v_pk_mul_f32 v[194:195], v[154:155], v[34:35] op_sel_hi:[1,0]
    v_exp_f32 v188, v188
    v_exp_f32 v189, v189
    v_exp_f32 v190, v190
    v_exp_f32 v191, v191
    v_exp_f32 v192, v192
    v_exp_f32 v193, v193
    v_exp_f32 v194, v194
    v_exp_f32 v195, v195
    v_pk_mul_f32 v[148:149], v[148:149], v[48:49]
    v_pk_mul_f32 v[150:151], v[150:151], v[50:51]
    v_pk_mul_f32 v[152:153], v[152:153], v[52:53]
    v_pk_mul_f32 v[154:155], v[154:155], v[54:55]
    v_pk_add_f32 v[188:189], v[188:189], 1.0 op_sel_hi:[1,0]
    v_pk_add_f32 v[190:191], v[190:191], 1.0 op_sel_hi:[1,0]
    v_pk_add_f32 v[192:193], v[192:193], 1.0 op_sel_hi:[1,0]
    v_pk_add_f32 v[194:195], v[194:195], 1.0 op_sel_hi:[1,0]
    v_rcp_f32 v188, v188
    v_rcp_f32 v189, v189
    v_rcp_f32 v190, v190
    v_rcp_f32 v191, v191
    v_rcp_f32 v192, v192
    v_rcp_f32 v193, v193
    v_rcp_f32 v194, v194
    v_rcp_f32 v195, v195
    v_pk_fma_f32 v[148:149], v[148:149], v[188:189], v[208:209]
    v_pk_fma_f32 v[150:151], v[150:151], v[190:191], v[210:211]
    v_pk_fma_f32 v[152:153], v[152:153], v[192:193], v[212:213]
    v_pk_fma_f32 v[154:155], v[154:155], v[194:195], v[214:215]
    v_cvt_pk_bf16_f32 v36, v148, v149
    v_cvt_pk_bf16_f32 v37, v150, v151
    v_cvt_pk_bf16_f32 v38, v152, v153
    v_cvt_pk_bf16_f32 v39, v154, v155
    buffer_store_dwordx4 v[36:39], v46, s[60:63], s87 offen offset:0
    v_pk_add_f32 v[156:157], v[156:157], v[176:177]
    v_pk_add_f32 v[158:159], v[158:159], v[178:179]
    v_pk_add_f32 v[160:161], v[160:161], v[180:181]
    v_pk_add_f32 v[162:163], v[162:163], v[182:183]
    v_pk_mul_f32 v[196:197], v[156:157], v[34:35] op_sel_hi:[1,0]
    v_pk_mul_f32 v[198:199], v[158:159], v[34:35] op_sel_hi:[1,0]
    v_pk_mul_f32 v[200:201], v[160:161], v[34:35] op_sel_hi:[1,0]
    v_pk_mul_f32 v[202:203], v[162:163], v[34:35] op_sel_hi:[1,0]
    v_exp_f32 v196, v196
    v_exp_f32 v197, v197
    v_exp_f32 v198, v198
    v_exp_f32 v199, v199
    v_exp_f32 v200, v200
    v_exp_f32 v201, v201
    v_exp_f32 v202, v202
    v_exp_f32 v203, v203
    v_pk_mul_f32 v[156:157], v[156:157], v[56:57]
    v_pk_mul_f32 v[158:159], v[158:159], v[58:59]
    v_pk_mul_f32 v[160:161], v[160:161], v[60:61]
    v_pk_mul_f32 v[162:163], v[162:163], v[62:63]
    v_pk_add_f32 v[196:197], v[196:197], 1.0 op_sel_hi:[1,0]
    v_pk_add_f32 v[198:199], v[198:199], 1.0 op_sel_hi:[1,0]
    v_pk_add_f32 v[200:201], v[200:201], 1.0 op_sel_hi:[1,0]
    v_pk_add_f32 v[202:203], v[202:203], 1.0 op_sel_hi:[1,0]
    v_rcp_f32 v196, v196
    v_rcp_f32 v197, v197
    v_rcp_f32 v198, v198
    v_rcp_f32 v199, v199
    v_rcp_f32 v200, v200
    v_rcp_f32 v201, v201
    v_rcp_f32 v202, v202
    v_rcp_f32 v203, v203
    v_pk_fma_f32 v[156:157], v[156:157], v[196:197], v[216:217]
    v_pk_fma_f32 v[158:159], v[158:159], v[198:199], v[218:219]
    v_pk_fma_f32 v[160:161], v[160:161], v[200:201], v[220:221]
    v_pk_fma_f32 v[162:163], v[162:163], v[202:203], v[222:223]
    v_cvt_pk_bf16_f32 v40, v156, v157
    v_cvt_pk_bf16_f32 v41, v158, v159
    v_cvt_pk_bf16_f32 v42, v160, v161
    v_cvt_pk_bf16_f32 v43, v162, v163
    buffer_store_dwordx4 v[40:43], v46, s[60:63], s87 offen offset:64
L_end:
    s_endpgm
L_S:
    s_mov_b32 s6, 0xffff0000
    s_mov_b32 s100, 0x20000
    s_mul_i32 s15, s4, 40
    s_add_u32 s15, s15, s5
    s_sub_u32 s10, s5, 27
    s_cselect_b32 s10, 0, s10
    s_lshl_b32 s11, s10, 1
    s_cmp_eq_u32 s10, 4
    s_subb_u32 s11, s11, 0
    s_add_u32 s15, s15, s11
    s_mov_b32 s56, s42
    s_and_b32 s57, s43, 0xffff
    s_mov_b32 s58, 15040512
    s_mov_b32 s59, 0x20000
    s_mov_b32 s60, s38
    s_and_b32 s61, s39, 0xffff
    s_mov_b32 s62, 2621440
    s_mov_b32 s63, 0x20000
    s_mov_b32 s64, s36
Lst_4571:
    s_cbranch_execz L_hopback
    s_nop 0
    s_and_b32 s65, s37, 0xffff
    s_mov_b32 s66, 2211840
    s_mov_b32 s67, 0x20000
    s_lshl_b32 s8, s15, 1
    s_lshr_b32 s9, s3, 1
    s_add_u32 s8, s8, s9
    s_lshl_b32 s8, s8, 8
    v_lshl_add_u32 v112, v0, 2, s8
    s_lshl_b32 s8, s15, 2
    s_nop 0
    s_load_dword s78, s[26:27], s8
    s_load_dword s79, s[28:29], s8
    global_load_dword v113, v112, s[18:19]
    global_load_dword v114, v112, s[20:21]
    global_load_dword v115, v112, s[22:23]
    global_load_dword v116, v112, s[24:25]
    s_add_u32 s15, s15, 1
    s_lshl_b32 s8, s15, 1
    s_lshr_b32 s9, s3, 1
    s_add_u32 s8, s8, s9
    s_lshl_b32 s8, s8, 8
    v_lshl_add_u32 v117, v0, 2, s8
    s_lshl_b32 s8, s15, 2
    s_load_dword s72, s[26:27], s8
    s_load_dword s73, s[28:29], s8
    global_load_dword v118, v117, s[18:19]
    global_load_dword v119, v117, s[20:21]
    global_load_dword v120, v117, s[22:23]
    global_load_dword v121, v117, s[24:25]
    s_cmp_lt_u32 s5, 30
    s_addc_u32 s15, s15, 0
    s_lshl_b32 s8, s15, 1
    s_lshr_b32 s9, s3, 1
    s_add_u32 s8, s8, s9
    s_lshl_b32 s8, s8, 8
    v_lshl_add_u32 v122, v0, 2, s8
    s_lshl_b32 s8, s15, 2
    s_nop 0
    s_load_dword s74, s[26:27], s8
    s_load_dword s75, s[28:29], s8
    global_load_dword v123, v122, s[18:19]
    global_load_dword v124, v122, s[20:21]
    global_load_dword v125, v122, s[22:23]
    global_load_dword v126, v122, s[24:25]
    s_lshl_b32 s8, s12, 7
    s_add_u32 s8, s8, 8192
    v_mov_b32_e64 v4, s8
    s_lshl_b32 s8, s12, 7
    s_add_u32 s8, s8, 204800
    v_writelane_b32 v4, s8, 1
    s_lshl_b32 s8, s4, 7
    s_add_u32 s8, s8, 4096
    v_writelane_b32 v4, s8, 2
    buffer_load_dword v127, v4, s[56:59], 0 offen
    s_cmp_lt_u32 s5, 30
    s_cselect_b32 s101, 3, 2
    s_sub_u32 s8, s5, 27
    s_lshl2_add_u32 s8, s8, s3
    s_and_b32 s9, s4, 3
    s_mul_i32 s9, s9, 27
    s_lshr_b32 s9, s9, 2
    s_lshl_b32 s9, s9, 7
    s_lshr_b32 s10, s4, 2
    s_lshl1_add_u32 s10, s8, s10
    s_mul_i32 s10, s10, 27648
    s_add_u32 s9, s9, s10
    s_add_u32 s77, s9, 221184
    v_lshrrev_b32_e64 v129, 3, v0
    v_mul_u32_u24 v129, 2432, v129
    v_lshl_add_u32 v129, v0, 7, v129
    buffer_load_dword v130, v129, s[48:51], s77 offen
    buffer_load_dword v131, v129, s[52:55], s77 offen offset:2048
    s_add_u32 s77, s77, 1105920
    s_sub_u32 s15, s15, s101
    s_add_u32 s15, s15, 1
    s_mov_b32 s39, 15040512
    s_mov_b32 s14, 0
    s_mul_i32 s32, s3, 16896
    s_add_u32 s32, s32, 96256
    v_lshl_add_u32 v15, v0, 3, s32
    s_lshr_b32 s32, s3, 1
    s_mul_i32 s32, s32, 33792
    s_add_u32 s32, s32, 96256
    v_lshrrev_b32_e64 v23, 5, v0
    v_lshl_add_u32 v23, v23, 4, s32
    v_and_b32 v17, 31, v0
    v_and_b32 v16, 24, v0
    v_and_b32_e64 v24, 3, v0
    v_lshl_add_u32 v16, v24, 1, v16
    v_bfe_u32 v24, v0, 2, 1
    v_add_u32 v16, v16, v24
    s_movk_i32 s32, 528
    v_mad_u32_u24 v17, v17, s32, v23
    v_mad_u32_u24 v16, v16, s32, v23
    s_mov_b64 exec, 0
    s_call_b64 s[84:85], L_hdS
    s_branch L_hopS
L_hdS:
    s_cmp_eq_u32 s3, 0
    s_cbranch_scc1 Lst_5208
    s_cmp_eq_u32 s3, 1
    s_cbranch_scc1 Lst_5242
    s_cmp_eq_u32 s3, 2
    s_cbranch_scc1 Lst_5457
    s_branch Lst_5842
L_hopS:
    s_mov_b64 exec, -1
    s_waitcnt vmcnt(15)
    v_lshlrev_b32 v60, 16, v48
    v_and_b32 v61, s6, v48
    v_lshlrev_b32 v62, 16, v49
    v_and_b32 v63, s6, v49
    v_lshlrev_b32 v64, 16, v50
    v_and_b32 v65, s6, v50
    v_lshlrev_b32 v66, 16, v51
    v_and_b32 v67, s6, v51
    v_lshlrev_b32 v68, 16, v52
    v_and_b32 v69, s6, v52
    v_lshlrev_b32 v70, 16, v53
    v_and_b32 v71, s6, v53
    v_lshlrev_b32 v72, 16, v54
    v_and_b32 v73, s6, v54
    v_lshlrev_b32 v74, 16, v55
    v_and_b32 v75, s6, v55
    v_lshlrev_b32 v76, 16, v56
    v_and_b32 v77, s6, v56
    v_lshlrev_b32 v78, 16, v57
    v_and_b32 v79, s6, v57
    v_pk_add_f32 v[80:81], v[60:61], v[62:63]
    v_pk_add_f32 v[82:83], v[64:65], v[66:67]
    v_pk_add_f32 v[84:85], v[68:69], v[70:71]
    v_pk_add_f32 v[86:87], v[72:73], v[74:75]
    v_pk_add_f32 v[88:89], v[76:77], v[78:79]
    v_pk_add_f32 v[80:81], v[80:81], v[82:83]
    v_pk_add_f32 v[84:85], v[84:85], v[86:87]
    v_pk_add_f32 v[80:81], v[80:81], v[88:89]
    v_pk_add_f32 v[80:81], v[80:81], v[84:85]
    v_add_f32 v10, v80, v81
    s_nop 1
    v_add_f32_dpp v10, v10, v10 row_ror:8 row_mask:0xf bank_mask:0xf
    s_nop 1
    v_add_f32_dpp v10, v10, v10 row_ror:4 row_mask:0xf bank_mask:0xf
    s_nop 1
    v_add_f32_dpp v10, v10, v10 row_ror:2 row_mask:0xf bank_mask:0xf
    s_nop 1
    v_add_f32_dpp v10, v10, v10 row_ror:1 row_mask:0xf bank_mask:0xf
    v_mov_b32 v11, v10
    s_nop 1
    v_permlane16_swap_b32 v11, v10
    v_add_f32_e64 v10, v10, v11
    v_mul_f32 v10, 0x3acccccd, v10
    v_cvt_pk_bf16_f32 v8, v10, v10
    v_lshlrev_b32 v8, 16, v8
    v_sub_f32 v10, v10, v8
    v_pk_add_f32 v[60:61], v[60:61], v[8:9] op_sel_hi:[1,0] neg_lo:[0,1] neg_hi:[0,1]
    v_pk_add_f32 v[62:63], v[62:63], v[8:9] op_sel_hi:[1,0] neg_lo:[0,1] neg_hi:[0,1]
    v_pk_add_f32 v[64:65], v[64:65], v[8:9] op_sel_hi:[1,0] neg_lo:[0,1] neg_hi:[0,1]
    v_pk_add_f32 v[66:67], v[66:67], v[8:9] op_sel_hi:[1,0] neg_lo:[0,1] neg_hi:[0,1]
    v_pk_add_f32 v[68:69], v[68:69], v[8:9] op_sel_hi:[1,0] neg_lo:[0,1] neg_hi:[0,1]
    v_pk_add_f32 v[70:71], v[70:71], v[8:9] op_sel_hi:[1,0] neg_lo:[0,1] neg_hi:[0,1]
    v_pk_add_f32 v[72:73], v[72:73], v[8:9] op_sel_hi:[1,0] neg_lo:[0,1] neg_hi:[0,1]
    v_pk_add_f32 v[74:75], v[74:75], v[8:9] op_sel_hi:[1,0] neg_lo:[0,1] neg_hi:[0,1]
    v_pk_add_f32 v[76:77], v[76:77], v[8:9] op_sel_hi:[1,0] neg_lo:[0,1] neg_hi:[0,1]
    v_pk_add_f32 v[78:79], v[78:79], v[8:9] op_sel_hi:[1,0] neg_lo:[0,1] neg_hi:[0,1]
    v_pk_mul_f32 v[80:81], v[60:61], v[60:61]
    v_pk_mul_f32 v[82:83], v[62:63], v[62:63]
    v_pk_fma_f32 v[80:81], v[64:65], v[64:65], v[80:81]
    v_pk_fma_f32 v[82:83], v[66:67], v[66:67], v[82:83]
    v_pk_fma_f32 v[80:81], v[68:69], v[68:69], v[80:81]
    v_pk_fma_f32 v[82:83], v[70:71], v[70:71], v[82:83]
    v_pk_fma_f32 v[80:81], v[72:73], v[72:73], v[80:81]
    v_pk_fma_f32 v[82:83], v[74:75], v[74:75], v[82:83]
    v_pk_fma_f32 v[80:81], v[76:77], v[76:77], v[80:81]
    v_pk_fma_f32 v[82:83], v[78:79], v[78:79], v[82:83]
    v_pk_add_f32 v[80:81], v[80:81], v[82:83]
    v_add_f32 v12, v80, v81
    s_nop 1
    v_add_f32_dpp v12, v12, v12 row_ror:8 row_mask:0xf bank_mask:0xf
    v_cvt_pk_bf16_f32 v48, v60, v61
    v_cvt_pk_bf16_f32 v49, v62, v63
    v_add_f32_dpp v12, v12, v12 row_ror:4 row_mask:0xf bank_mask:0xf
    v_cvt_pk_bf16_f32 v50, v64, v65
    v_cvt_pk_bf16_f32 v51, v66, v67
    v_add_f32_dpp v12, v12, v12 row_ror:2 row_mask:0xf bank_mask:0xf
    v_cvt_pk_bf16_f32 v52, v68, v69
    v_cvt_pk_bf16_f32 v53, v70, v71
    v_add_f32_dpp v12, v12, v12 row_ror:1 row_mask:0xf bank_mask:0xf
    v_cvt_pk_bf16_f32 v54, v72, v73
    v_cvt_pk_bf16_f32 v55, v74, v75
    v_mov_b32_e64 v11, v12
    v_cvt_pk_bf16_f32 v56, v76, v77
    v_cvt_pk_bf16_f32 v57, v78, v79
    v_permlane16_swap_b32 v11, v12
    v_lshlrev_b32 v60, 16, v48
    v_and_b32 v61, s6, v48
    v_add_f32 v12, v12, v11
    v_lshlrev_b32 v62, 16, v49
    v_and_b32 v63, s6, v49
    v_lshlrev_b32 v64, 16, v50
    v_and_b32 v65, s6, v50
    v_lshlrev_b32 v66, 16, v51
    v_and_b32 v67, s6, v51
    v_lshlrev_b32 v68, 16, v52
    v_and_b32 v69, s6, v52
    v_lshlrev_b32 v70, 16, v53
    v_and_b32 v71, s6, v53
    v_lshlrev_b32 v72, 16, v54
    v_and_b32 v73, s6, v54
    v_lshlrev_b32 v74, 16, v55
    v_and_b32 v75, s6, v55
    v_lshlrev_b32 v76, 16, v56
    v_and_b32 v77, s6, v56
    v_lshlrev_b32 v78, 16, v57
    v_and_b32 v79, s6, v57
    v_mul_f32 v12, 0x3acccccd, v12
    v_fma_f32 v12, -v10, v10, v12
    v_max_f32_e64 v12, 0, v12
    v_cvt_pk_bf16_f32 v12, v12, v12
    v_lshlrev_b32_e64 v12, 16, v12
    v_add_f32 v12, 0x3727c5ac, v12
    v_cvt_pk_bf16_f32 v12, v12, v12
    v_lshlrev_b32 v12, 16, v12
    v_sqrt_f32 v12, v12
    v_lshrrev_b32_e64 v4, 5, v0
    v_cvt_pk_bf16_f32 v12, v12, v12
    v_lshlrev_b32 v9, 16, v12
    v_rcp_f32 v12, v9
    s_mul_i32 s8, s3, 2688
    s_add_u32 s8, s8, 0
    v_lshl_add_u32 v4, v4, 6, s8
    v_add_u32 v2, v2, v4
    v_add_u32_e64 v3, v3, v4
    v_pk_mul_f32 v[60:61], v[60:61], v[12:13] op_sel_hi:[1,0]
    v_pk_mul_f32 v[62:63], v[62:63], v[12:13] op_sel_hi:[1,0]
    v_pk_mul_f32 v[64:65], v[64:65], v[12:13] op_sel_hi:[1,0]
    v_pk_mul_f32 v[66:67], v[66:67], v[12:13] op_sel_hi:[1,0]
    v_pk_mul_f32 v[68:69], v[68:69], v[12:13] op_sel_hi:[1,0]
    v_pk_mul_f32 v[70:71], v[70:71], v[12:13] op_sel_hi:[1,0]
    v_pk_mul_f32 v[72:73], v[72:73], v[12:13] op_sel_hi:[1,0]
    v_pk_mul_f32 v[74:75], v[74:75], v[12:13] op_sel_hi:[1,0]
    v_pk_mul_f32 v[76:77], v[76:77], v[12:13] op_sel_hi:[1,0]
    v_pk_mul_f32 v[78:79], v[78:79], v[12:13] op_sel_hi:[1,0]
    v_cvt_pk_bf16_f32 v48, v60, v61
    v_cvt_pk_bf16_f32 v49, v62, v63
    v_cvt_pk_bf16_f32 v50, v64, v65
    v_cvt_pk_bf16_f32 v51, v66, v67
    v_cvt_pk_bf16_f32 v52, v68, v69
    v_cvt_pk_bf16_f32 v53, v70, v71
    v_cvt_pk_bf16_f32 v54, v72, v73
    v_cvt_pk_bf16_f32 v55, v74, v75
    v_cvt_pk_bf16_f32 v56, v76, v77
    v_cvt_pk_bf16_f32 v57, v78, v79
    ds_write_b128 v2, v[48:51]
    ds_write_b128 v2, v[52:55] offset:512
    ds_write_b64 v3, v[56:57] offset:1024
    v_lshrrev_b32 v8, 16, v8
    v_or_b32 v8, v8, v9
    v_lshrrev_b32 v4, 5, v0
    s_lshl_b32 s8, s3, 3
    s_add_u32 s8, s8, 10752
    v_lshl_add_u32 v4, v4, 2, s8
    ds_write_b32 v4, v8
    v_bfe_u32 v4, v0, 2, 2
    v_mul_u32_u24 v4, 1344, v4
    v_and_b32_e64 v5, 3, v0
    v_lshl_add_u32 v4, v5, 3, v4
    v_lshrrev_b32_e64 v5, 4, v0
    v_lshl_add_u32 v4, v5, 5, v4
    s_lshl_b32 s8, s3, 7
    s_add_u32 s8, s8, 0
    v_add_u32 v4, s8, v4
    v_and_b32 v6, 1, v0
    v_lshlrev_b32_e64 v6, 4, v6
    v_add_u32 v6, 10752, v6
    s_waitcnt lgkmcnt(0)
    s_barrier
    ds_read_b64_tr_b16 v[48:49], v4 offset:0
    ds_read_b64_tr_b16 v[50:51], v4 offset:5376
    ds_read_b64_tr_b16 v[52:53], v4 offset:512
    ds_read_b64_tr_b16 v[54:55], v4 offset:5888
    ds_read_b64_tr_b16 v[56:57], v4 offset:1024
    ds_read_b64_tr_b16 v[58:59], v4 offset:6400
    ds_read_b128 v[60:63], v6
    s_mul_i32 s7, s7, 0x9e3779b1
    s_add_u32 s7, s7, 0x7f4a7c15
    v_lshlrev_b32_e64 v4, 4, v0
    s_mul_i32 s8, s12, 10368
    s_lshl_b32 s9, s3, 10
    s_add_u32 s8, s8, s9
    s_add_u32 s8, s8, 393216
    s_add_u32 s9, s8, 4096
    s_add_u32 s10, s8, 8192
    s_cmp_lt_u32 s3, 2
    s_cselect_b32 s10, s10, 15040512
    s_waitcnt lgkmcnt(0)
    buffer_store_dwordx4 v[48:51], v4, s[56:59], s8 offen sc1
    buffer_store_dwordx4 v[52:55], v4, s[56:59], s9 offen sc1
    buffer_store_dwordx4 v[56:59], v4, s[56:59], s10 offen sc1
    s_lshl_b32 s8, s12, 7
    s_add_u32 s8, s8, 360448
    s_cmp_eq_u32 s3, 2
    s_cselect_b32 s8, s8, 15040512
    s_mov_b64 exec, 0xff
    buffer_store_dwordx4 v[60:63], v4, s[56:59], s8 offen sc1
    s_mov_b64 exec, -1
    s_mul_i32 s8, s4, 276480
    s_sub_u32 s9, s5, 27
    s_lshl2_add_u32 s9, s9, s3
    s_mul_i32 s9, s9, 13824
    s_add_u32 s8, s8, s9
    s_add_u32 s8, s8, 0
    s_add_u32 s9, s8, 6912
    v_min_u32 v4, 53, v0
    v_lshlrev_b32_e64 v4, 7, v4
    buffer_load_dword v134, v4, s[64:67], s8 offen
    buffer_load_dword v135, v4, s[64:67], s9 offen
    s_mul_i32 s32, s4, 7
    s_lshr_b32 s32, s32, 2
    s_lshl_b32 s16, s32, 10
    s_add_u32 s32, s16, 1024
    s_sub_u32 s33, s32, 13312
    s_min_u32 s17, s32, s33
    s_add_u32 s32, s16, 2048
    s_sub_u32 s33, s32, 13312
    s_min_u32 s18, s32, s33
    s_add_u32 s32, s16, 3072
    s_sub_u32 s33, s32, 13312
    s_min_u32 s19, s32, s33
    s_add_u32 s32, s16, 4096
    s_sub_u32 s33, s32, 13312
    s_min_u32 s20, s32, s33
    s_add_u32 s32, s16, 5120
    s_sub_u32 s33, s32, 13312
    s_min_u32 s21, s32, s33
    s_add_u32 s32, s16, 6144
    s_sub_u32 s33, s32, 13312
    s_min_u32 s22, s32, s33
    s_add_u32 s32, s16, 7168
    s_sub_u32 s33, s32, 13312
    s_min_u32 s23, s32, s33
    s_add_u32 s32, s16, 8192
    s_sub_u32 s33, s32, 13312
    s_min_u32 s24, s32, s33
    s_add_u32 s32, s16, 9216
    s_sub_u32 s33, s32, 13312
    s_min_u32 s25, s32, s33
    s_add_u32 s32, s16, 10240
    s_sub_u32 s33, s32, 13312
    s_min_u32 s26, s32, s33
    s_add_u32 s32, s16, 11264
    s_sub_u32 s33, s32, 13312
    s_min_u32 s27, s32, s33
    s_add_u32 s32, s16, 12288
    s_sub_u32 s33, s32, 13312
    s_min_u32 s28, s32, s33
    s_lshr_b32 s32, s3, 1
    s_mul_i32 s33, s3, 13
    s_sub_u32 s32, s32, s33
    s_add_u32 s32, s32, 52
    s_lshl_b32 s29, s32, 10
    s_waitcnt vmcnt(9)
    s_lshr_b32 s32, s3, 1
    s_lshl_b32 s32, s32, 4
    s_lshr_b32 s78, s78, s32
    s_lshl_b32 s78, s78, 16
    s_lshr_b32 s79, s79, s32
    s_lshl_b32 s79, s79, 16
    s_mov_b32 s33, 0x3fb8aa3b
    v_mov_b32 v4, s78
    v_lshlrev_b32 v9, 16, v113
    v_and_b32 v10, s6, v113
    v_mul_f32 v4, s33, v4
    v_mul_f32 v9, s33, v9
    v_mul_f32 v10, s33, v10
    v_exp_f32 v4, v4
    v_exp_f32 v9, v9
    v_exp_f32 v10, v10
    v_lshlrev_b32 v11, 16, v114
    v_and_b32 v12, s6, v114
    v_cvt_pk_bf16_f32 v4, v4, v4
    v_cvt_pk_bf16_f32 v10, v9, v10
    v_lshlrev_b32 v4, 16, v4
    v_lshlrev_b32 v9, 16, v10
    v_and_b32 v10, s6, v10
    v_mul_f32 v11, v11, v4
    v_mul_f32 v12, v12, v4
    v_mul_f32 v9, v9, v4
    v_mul_f32 v10, v10, v4
    v_mul_f32 v11, 0.15915494, v11
    v_mul_f32 v12, 0.15915494, v12
    v_mul_f32 v9, s33, v9
    v_mul_f32 v10, s33, v10
    v_add_f32 v4, v4, v4
    v_lshlrev_b32 v40, 16, v115
    v_and_b32 v41, s6, v115
    v_lshlrev_b32 v42, 16, v116
    v_and_b32_e64 v43, s6, v116
    s_bitcmp1_b32 s3, 0
    s_cselect_b32 s32, 1.0, 0x41000000
    s_mov_b32 s33, 0x43800000
    v_mul_f32 v40, v40, v4
    v_mul_f32 v41, v41, v4
    v_mul_f32 v42, v42, v4
    v_mul_f32 v43, v43, v4
    v_mul_f32 v13, s32, v9
    v_mul_f32 v14, s32, v10
    v_mul_f32 v34, s32, v11
    v_mul_f32 v35, s32, v12
    v_exp_f32_e64 v13, -v13
    v_exp_f32_e64 v14, -v14
    v_fract_f32 v34, v34
    v_fract_f32 v35, v35
    v_cos_f32 v32, v34
    v_cos_f32 v33, v35
    v_sin_f32 v34, v34
    v_sin_f32 v35, v35
    v_mul_f32 v32, v32, v13
    v_mul_f32 v33, v33, v14
    v_mul_f32 v34, v34, v13
    v_mul_f32 v35, v35, v14
    v_mul_f32 v13, s33, v9
    v_mul_f32 v14, s33, v10
    v_mul_f32 v38, s33, v11
    v_mul_f32 v39, s33, v12
    v_exp_f32_e64 v13, -v13
    v_exp_f32_e64 v14, -v14
    v_fract_f32 v38, v38
    v_fract_f32 v39, v39
    v_cos_f32 v36, v38
    v_cos_f32 v37, v39
    v_sin_f32 v38, v38
    v_sin_f32 v39, v39
    v_mul_f32 v36, v36, v13
    v_mul_f32 v37, v37, v14
    v_mul_f32 v38, v38, v13
    v_mul_f32 v39, v39, v14
LS_it:
    s_bitcmp1_b32 s3, 0
    s_cbranch_scc1 LS_H
    v_mov_b32 v200, 0x3f803f80
    v_mov_b32_e64 v201, 0
    v_cvt_pk_bf16_f32 v202, v32, v33
    v_cvt_pk_bf16_f32 v203, v34, v35
    v_pk_mul_f32 v[196:197], v[32:33], v[32:33]
    v_pk_mul_f32 v[198:199], v[32:33], v[34:35]
    v_pk_fma_f32 v[192:193], v[34:35], v[34:35], v[196:197] neg_lo:[1,0,0] neg_hi:[1,0,0]
    v_pk_fma_f32 v[194:195], v[34:35], v[32:33], v[198:199]
    ds_write2_b64 v15, v[200:201], v[202:203] offset0:0 offset1:66
    v_cvt_pk_bf16_f32 v204, v192, v193
    v_cvt_pk_bf16_f32 v205, v194, v195
    v_pk_mul_f32 v[196:197], v[192:193], v[32:33]
    v_pk_mul_f32 v[198:199], v[192:193], v[34:35]
    v_pk_fma_f32 v[192:193], v[194:195], v[34:35], v[196:197] neg_lo:[1,0,0] neg_hi:[1,0,0]
    v_pk_fma_f32 v[194:195], v[194:195], v[32:33], v[198:199]
    v_cvt_pk_bf16_f32 v206, v192, v193
    v_cvt_pk_bf16_f32 v207, v194, v195
    v_pk_mul_f32 v[196:197], v[192:193], v[32:33]
    v_pk_mul_f32 v[198:199], v[192:193], v[34:35]
    v_pk_fma_f32 v[192:193], v[194:195], v[34:35], v[196:197] neg_lo:[1,0,0] neg_hi:[1,0,0]
    v_pk_fma_f32 v[194:195], v[194:195], v[32:33], v[198:199]
    ds_write2_b64 v15, v[204:205], v[206:207] offset0:132 offset1:198
    v_add_u32 v15, 2112, v15
    v_cvt_pk_bf16_f32 v200, v192, v193
    v_cvt_pk_bf16_f32 v201, v194, v195
    v_pk_mul_f32 v[196:197], v[192:193], v[32:33]
    v_pk_mul_f32 v[198:199], v[192:193], v[34:35]
    v_pk_fma_f32 v[192:193], v[194:195], v[34:35], v[196:197] neg_lo:[1,0,0] neg_hi:[1,0,0]
    v_pk_fma_f32 v[194:195], v[194:195], v[32:33], v[198:199]
    v_cvt_pk_bf16_f32 v202, v192, v193
    v_cvt_pk_bf16_f32 v203, v194, v195
    v_pk_mul_f32 v[196:197], v[192:193], v[32:33]
    v_pk_mul_f32 v[198:199], v[192:193], v[34:35]
    v_pk_fma_f32 v[192:193], v[194:195], v[34:35], v[196:197] neg_lo:[1,0,0] neg_hi:[1,0,0]
    v_pk_fma_f32 v[194:195], v[194:195], v[32:33], v[198:199]
    ds_write2_b64 v15, v[200:201], v[202:203] offset0:0 offset1:66
    v_cvt_pk_bf16_f32 v204, v192, v193
    v_cvt_pk_bf16_f32 v205, v194, v195
    v_pk_mul_f32 v[196:197], v[192:193], v[32:33]
    v_pk_mul_f32 v[198:199], v[192:193], v[34:35]
    v_pk_fma_f32 v[192:193], v[194:195], v[34:35], v[196:197] neg_lo:[1,0,0] neg_hi:[1,0,0]
    v_pk_fma_f32 v[194:195], v[194:195], v[32:33], v[198:199]
    v_cvt_pk_bf16_f32 v206, v192, v193
    v_cvt_pk_bf16_f32 v207, v194, v195
    v_pk_mul_f32 v[196:197], v[192:193], v[32:33]
    v_pk_mul_f32 v[198:199], v[192:193], v[34:35]
    v_pk_fma_f32 v[192:193], v[194:195], v[34:35], v[196:197] neg_lo:[1,0,0] neg_hi:[1,0,0]
    v_pk_fma_f32 v[194:195], v[194:195], v[32:33], v[198:199]
    ds_write2_b64 v15, v[204:205], v[206:207] offset0:132 offset1:198
    v_add_u32 v15, 2112, v15
    v_cvt_pk_bf16_f32 v200, v192, v193
    v_cvt_pk_bf16_f32 v201, v194, v195
    v_pk_mul_f32 v[196:197], v[192:193], v[32:33]
    v_pk_mul_f32 v[198:199], v[192:193], v[34:35]
    v_pk_fma_f32 v[192:193], v[194:195], v[34:35], v[196:197] neg_lo:[1,0,0] neg_hi:[1,0,0]
    v_pk_fma_f32 v[194:195], v[194:195], v[32:33], v[198:199]
    v_cvt_pk_bf16_f32 v202, v192, v193
    v_cvt_pk_bf16_f32 v203, v194, v195
    v_pk_mul_f32 v[196:197], v[192:193], v[32:33]
    v_pk_mul_f32 v[198:199], v[192:193], v[34:35]
    v_pk_fma_f32 v[192:193], v[194:195], v[34:35], v[196:197] neg_lo:[1,0,0] neg_hi:[1,0,0]
    v_pk_fma_f32 v[194:195], v[194:195], v[32:33], v[198:199]
    ds_write2_b64 v15, v[200:201], v[202:203] offset0:0 offset1:66
    v_cvt_pk_bf16_f32 v204, v192, v193
    v_cvt_pk_bf16_f32 v205, v194, v195
    v_pk_mul_f32 v[196:197], v[192:193], v[32:33]
    v_pk_mul_f32 v[198:199], v[192:193], v[34:35]
    v_pk_fma_f32 v[192:193], v[194:195], v[34:35], v[196:197] neg_lo:[1,0,0] neg_hi:[1,0,0]
    v_pk_fma_f32 v[194:195], v[194:195], v[32:33], v[198:199]
    v_cvt_pk_bf16_f32 v206, v192, v193
    v_cvt_pk_bf16_f32 v207, v194, v195
    v_pk_mul_f32 v[196:197], v[192:193], v[32:33]
    v_pk_mul_f32 v[198:199], v[192:193], v[34:35]
    s_cmp_eq_u32 s14, 0
    s_cbranch_scc0 Lc_9
    s_waitcnt vmcnt(2)
    s_barrier
    s_lshl_b32 s10, s12, 7
    s_add_u32 s10, s10, 8192
    s_cmp_eq_u32 s3, 0
    s_cselect_b32 s10, s10, 15040512
    v_mov_b32 v4, s7
    s_mov_b64 exec, 1
    buffer_store_dword v4, off, s[56:59], s10 sc1
    s_mov_b64 exec, -1
Lc_9:
    v_pk_fma_f32 v[192:193], v[194:195], v[34:35], v[196:197] neg_lo:[1,0,0] neg_hi:[1,0,0]
    v_pk_fma_f32 v[194:195], v[194:195], v[32:33], v[198:199]
    s_cmp_eq_u32 s14, 1
    s_cbranch_scc0 Lc_10
    s_nop 0
    buffer_load_dword v2, v3, s[56:59], 0 offen sc1
Lc_10:
    ds_write2_b64 v15, v[204:205], v[206:207] offset0:132 offset1:198
    v_add_u32 v15, 2112, v15
    v_cvt_pk_bf16_f32 v200, v192, v193
    v_cvt_pk_bf16_f32 v201, v194, v195
    v_pk_mul_f32 v[196:197], v[192:193], v[32:33]
    v_pk_mul_f32 v[198:199], v[192:193], v[34:35]
    v_pk_fma_f32 v[192:193], v[194:195], v[34:35], v[196:197] neg_lo:[1,0,0] neg_hi:[1,0,0]
    v_pk_fma_f32 v[194:195], v[194:195], v[32:33], v[198:199]
    v_cvt_pk_bf16_f32 v202, v192, v193
    v_cvt_pk_bf16_f32 v203, v194, v195
    v_pk_mul_f32 v[196:197], v[192:193], v[32:33]
    v_pk_mul_f32 v[198:199], v[192:193], v[34:35]
    v_pk_fma_f32 v[192:193], v[194:195], v[34:35], v[196:197] neg_lo:[1,0,0] neg_hi:[1,0,0]
    v_pk_fma_f32 v[194:195], v[194:195], v[32:33], v[198:199]
    ds_write2_b64 v15, v[200:201], v[202:203] offset0:0 offset1:66
    v_cvt_pk_bf16_f32 v204, v192, v193
    v_cvt_pk_bf16_f32 v205, v194, v195
    v_pk_mul_f32 v[196:197], v[192:193], v[32:33]
    v_pk_mul_f32 v[198:199], v[192:193], v[34:35]
    v_pk_fma_f32 v[192:193], v[194:195], v[34:35], v[196:197] neg_lo:[1,0,0] neg_hi:[1,0,0]
    v_pk_fma_f32 v[194:195], v[194:195], v[32:33], v[198:199]
    v_cvt_pk_bf16_f32 v206, v192, v193
    v_cvt_pk_bf16_f32 v207, v194, v195
    v_pk_mul_f32 v[196:197], v[192:193], v[32:33]
    v_pk_mul_f32 v[198:199], v[192:193], v[34:35]
    v_pk_fma_f32 v[192:193], v[194:195], v[34:35], v[196:197] neg_lo:[1,0,0] neg_hi:[1,0,0]
    v_pk_fma_f32 v[194:195], v[194:195], v[32:33], v[198:199]
    ds_write2_b64 v15, v[204:205], v[206:207] offset0:132 offset1:198
    v_add_u32 v15, 2112, v15
    v_cvt_pk_bf16_f32 v200, v192, v193
    v_cvt_pk_bf16_f32 v201, v194, v195
    v_pk_mul_f32 v[196:197], v[192:193], v[32:33]
    v_pk_mul_f32 v[198:199], v[192:193], v[34:35]
    v_pk_fma_f32 v[192:193], v[194:195], v[34:35], v[196:197] neg_lo:[1,0,0] neg_hi:[1,0,0]
    v_pk_fma_f32 v[194:195], v[194:195], v[32:33], v[198:199]
    v_cvt_pk_bf16_f32 v202, v192, v193
    v_cvt_pk_bf16_f32 v203, v194, v195
    v_pk_mul_f32 v[196:197], v[192:193], v[32:33]
    v_pk_mul_f32 v[198:199], v[192:193], v[34:35]
    v_pk_fma_f32 v[192:193], v[194:195], v[34:35], v[196:197] neg_lo:[1,0,0] neg_hi:[1,0,0]
    v_pk_fma_f32 v[194:195], v[194:195], v[32:33], v[198:199]
    ds_write2_b64 v15, v[200:201], v[202:203] offset0:0 offset1:66
    v_cvt_pk_bf16_f32 v204, v192, v193
    v_cvt_pk_bf16_f32 v205, v194, v195
    v_pk_mul_f32 v[196:197], v[192:193], v[32:33]
    v_pk_mul_f32 v[198:199], v[192:193], v[34:35]
    v_pk_fma_f32 v[192:193], v[194:195], v[34:35], v[196:197] neg_lo:[1,0,0] neg_hi:[1,0,0]
    v_pk_fma_f32 v[194:195], v[194:195], v[32:33], v[198:199]
    v_cvt_pk_bf16_f32 v206, v192, v193
    v_cvt_pk_bf16_f32 v207, v194, v195
    v_pk_mul_f32 v[196:197], v[192:193], v[32:33]
    v_pk_mul_f32 v[198:199], v[192:193], v[34:35]
    v_pk_fma_f32 v[192:193], v[194:195], v[34:35], v[196:197] neg_lo:[1,0,0] neg_hi:[1,0,0]
    v_pk_fma_f32 v[194:195], v[194:195], v[32:33], v[198:199]
    ds_write2_b64 v15, v[204:205], v[206:207] offset0:132 offset1:198
    v_add_u32 v15, 2112, v15
    v_cvt_pk_bf16_f32 v200, v192, v193
    v_cvt_pk_bf16_f32 v201, v194, v195
    v_pk_mul_f32 v[196:197], v[192:193], v[32:33]
    v_pk_mul_f32 v[198:199], v[192:193], v[34:35]
    v_pk_fma_f32 v[192:193], v[194:195], v[34:35], v[196:197] neg_lo:[1,0,0] neg_hi:[1,0,0]
    v_pk_fma_f32 v[194:195], v[194:195], v[32:33], v[198:199]
    v_cvt_pk_bf16_f32 v202, v192, v193
    v_cvt_pk_bf16_f32 v203, v194, v195
    v_pk_mul_f32 v[196:197], v[192:193], v[32:33]
    v_pk_mul_f32 v[198:199], v[192:193], v[34:35]
    v_pk_fma_f32 v[192:193], v[194:195], v[34:35], v[196:197] neg_lo:[1,0,0] neg_hi:[1,0,0]
    v_pk_fma_f32 v[194:195], v[194:195], v[32:33], v[198:199]
    ds_write2_b64 v15, v[200:201], v[202:203] offset0:0 offset1:66
    v_cvt_pk_bf16_f32 v204, v192, v193
    v_cvt_pk_bf16_f32 v205, v194, v195
    v_pk_mul_f32 v[196:197], v[192:193], v[32:33]
    v_pk_mul_f32 v[198:199], v[192:193], v[34:35]
    v_pk_fma_f32 v[192:193], v[194:195], v[34:35], v[196:197] neg_lo:[1,0,0] neg_hi:[1,0,0]
    v_pk_fma_f32 v[194:195], v[194:195], v[32:33], v[198:199]
    v_cvt_pk_bf16_f32 v206, v192, v193
    v_cvt_pk_bf16_f32 v207, v194, v195
    v_pk_mul_f32 v[196:197], v[192:193], v[32:33]
    v_pk_mul_f32 v[198:199], v[192:193], v[34:35]
    v_pk_fma_f32 v[192:193], v[194:195], v[34:35], v[196:197] neg_lo:[1,0,0] neg_hi:[1,0,0]
    v_pk_fma_f32 v[194:195], v[194:195], v[32:33], v[198:199]
    ds_write2_b64 v15, v[204:205], v[206:207] offset0:132 offset1:198
    v_add_u32 v15, 2112, v15
    v_cvt_pk_bf16_f32 v200, v192, v193
    v_cvt_pk_bf16_f32 v201, v194, v195
    v_pk_mul_f32 v[196:197], v[192:193], v[32:33]
    v_pk_mul_f32 v[198:199], v[192:193], v[34:35]
    v_pk_fma_f32 v[192:193], v[194:195], v[34:35], v[196:197] neg_lo:[1,0,0] neg_hi:[1,0,0]
    v_pk_fma_f32 v[194:195], v[194:195], v[32:33], v[198:199]
    v_cvt_pk_bf16_f32 v202, v192, v193
    v_cvt_pk_bf16_f32 v203, v194, v195
    v_pk_mul_f32 v[196:197], v[192:193], v[32:33]
    v_pk_mul_f32 v[198:199], v[192:193], v[34:35]
    v_pk_fma_f32 v[192:193], v[194:195], v[34:35], v[196:197] neg_lo:[1,0,0] neg_hi:[1,0,0]
    v_pk_fma_f32 v[194:195], v[194:195], v[32:33], v[198:199]
    ds_write2_b64 v15, v[200:201], v[202:203] offset0:0 offset1:66
    v_cvt_pk_bf16_f32 v204, v192, v193
    v_cvt_pk_bf16_f32 v205, v194, v195
    v_pk_mul_f32 v[196:197], v[192:193], v[32:33]
    v_pk_mul_f32 v[198:199], v[192:193], v[34:35]
    v_pk_fma_f32 v[192:193], v[194:195], v[34:35], v[196:197] neg_lo:[1,0,0] neg_hi:[1,0,0]
    v_pk_fma_f32 v[194:195], v[194:195], v[32:33], v[198:199]
Lst_5208:
    s_cbranch_execz Lst_6196
    s_nop 0
    v_cvt_pk_bf16_f32 v206, v192, v193
    v_cvt_pk_bf16_f32 v207, v194, v195
    v_pk_mul_f32 v[196:197], v[192:193], v[32:33]
    v_pk_mul_f32 v[198:199], v[192:193], v[34:35]
    v_pk_fma_f32 v[192:193], v[194:195], v[34:35], v[196:197] neg_lo:[1,0,0] neg_hi:[1,0,0]
    v_pk_fma_f32 v[194:195], v[194:195], v[32:33], v[198:199]
    ds_write2_b64 v15, v[204:205], v[206:207] offset0:132 offset1:198
    v_add_u32 v15, 2112, v15
    v_cvt_pk_bf16_f32 v200, v192, v193
    v_cvt_pk_bf16_f32 v201, v194, v195
    v_pk_mul_f32 v[196:197], v[192:193], v[32:33]
    v_pk_mul_f32 v[198:199], v[192:193], v[34:35]
    v_pk_fma_f32 v[192:193], v[194:195], v[34:35], v[196:197] neg_lo:[1,0,0] neg_hi:[1,0,0]
    v_pk_fma_f32 v[194:195], v[194:195], v[32:33], v[198:199]
    v_cvt_pk_bf16_f32 v202, v192, v193
    v_cvt_pk_bf16_f32 v203, v194, v195
    v_pk_mul_f32 v[196:197], v[192:193], v[32:33]
    v_pk_mul_f32 v[198:199], v[192:193], v[34:35]
    v_pk_fma_f32 v[192:193], v[194:195], v[34:35], v[196:197] neg_lo:[1,0,0] neg_hi:[1,0,0]
    v_pk_fma_f32 v[194:195], v[194:195], v[32:33], v[198:199]
    ds_write2_b64 v15, v[200:201], v[202:203] offset0:0 offset1:66
    v_cvt_pk_bf16_f32 v204, v192, v193
    v_cvt_pk_bf16_f32 v205, v194, v195
    v_pk_mul_f32 v[196:197], v[192:193], v[32:33]
    v_pk_mul_f32 v[198:199], v[192:193], v[34:35]
    v_pk_fma_f32 v[192:193], v[194:195], v[34:35], v[196:197] neg_lo:[1,0,0] neg_hi:[1,0,0]
    v_pk_fma_f32 v[194:195], v[194:195], v[32:33], v[198:199]
    v_cvt_pk_bf16_f32 v206, v192, v193
    v_cvt_pk_bf16_f32 v207, v194, v195
    ds_write2_b64 v15, v[204:205], v[206:207] offset0:132 offset1:198
    s_branch LS_J
LS_H:
Lst_5242:
    s_cbranch_execz Lst_6455
    s_nop 0
    s_nop 0
    v_pk_mul_f32 v[192:193], v[32:33], v[32:33]
    v_pk_mul_f32 v[194:195], v[32:33], v[34:35]
    v_pk_fma_f32 v[196:197], v[34:35], v[34:35], v[192:193] neg_lo:[1,0,0] neg_hi:[1,0,0]
    v_pk_fma_f32 v[198:199], v[34:35], v[32:33], v[194:195]
    v_pk_mul_f32 v[192:193], v[40:41], v[36:37]
    v_pk_mul_f32 v[194:195], v[40:41], v[38:39]
    v_pk_fma_f32 v[220:221], v[42:43], v[38:39], v[192:193] neg_lo:[1,0,0] neg_hi:[1,0,0]
    v_pk_fma_f32 v[222:223], v[42:43], v[36:37], v[194:195]
    v_cvt_pk_bf16_f32 v234, v40, v41
    v_cvt_pk_bf16_f32 v235, -v42, -v43
    v_cvt_pk_bf16_f32 v238, v220, v221
    v_cvt_pk_bf16_f32 v239, -v222, -v223
    v_pk_mul_f32 v[192:193], v[40:41], v[32:33]
    v_pk_mul_f32 v[194:195], v[40:41], v[34:35]
    v_pk_fma_f32 v[208:209], v[42:43], v[34:35], v[192:193] neg_lo:[1,0,0] neg_hi:[1,0,0]
    v_pk_fma_f32 v[210:211], v[42:43], v[32:33], v[194:195]
    ds_write2_b64 v15, v[234:235], v[238:239] offset0:0 offset1:66
    v_pk_mul_f32 v[192:193], v[196:197], v[196:197]
    v_pk_mul_f32 v[194:195], v[196:197], v[198:199]
    v_pk_fma_f32 v[200:201], v[198:199], v[198:199], v[192:193] neg_lo:[1,0,0] neg_hi:[1,0,0]
    v_pk_fma_f32 v[202:203], v[198:199], v[196:197], v[194:195]
    v_cvt_pk_bf16_f32 v232, v208, v209
    v_cvt_pk_bf16_f32 v233, -v210, -v211
    v_pk_mul_f32 v[192:193], v[208:209], v[32:33]
    v_pk_mul_f32 v[194:195], v[208:209], v[34:35]
    v_pk_fma_f32 v[208:209], v[210:211], v[34:35], v[192:193] neg_lo:[1,0,0] neg_hi:[1,0,0]
    v_pk_fma_f32 v[210:211], v[210:211], v[32:33], v[194:195]
    ds_write2_b64 v15, v[232:233], v[238:239] offset0:132 offset1:198
    v_add_u32 v15, 2112, v15
    v_pk_mul_f32 v[192:193], v[220:221], v[196:197]
    v_pk_mul_f32 v[194:195], v[220:221], v[198:199]
    v_pk_fma_f32 v[212:213], v[222:223], v[198:199], v[192:193] neg_lo:[1,0,0] neg_hi:[1,0,0]
    v_pk_fma_f32 v[214:215], v[222:223], v[196:197], v[194:195]
    v_cvt_pk_bf16_f32 v234, v208, v209
    v_cvt_pk_bf16_f32 v235, -v210, -v211
    v_cvt_pk_bf16_f32 v236, v212, v213
    v_cvt_pk_bf16_f32 v237, -v214, -v215
    v_pk_mul_f32 v[192:193], v[208:209], v[32:33]
    v_pk_mul_f32 v[194:195], v[208:209], v[34:35]
    v_pk_fma_f32 v[208:209], v[210:211], v[34:35], v[192:193] neg_lo:[1,0,0] neg_hi:[1,0,0]
    v_pk_fma_f32 v[210:211], v[210:211], v[32:33], v[194:195]
    ds_write2_b64 v15, v[234:235], v[236:237] offset0:0 offset1:66
    v_pk_mul_f32 v[192:193], v[212:213], v[196:197]
    v_pk_mul_f32 v[194:195], v[212:213], v[198:199]
    v_pk_fma_f32 v[212:213], v[214:215], v[198:199], v[192:193] neg_lo:[1,0,0] neg_hi:[1,0,0]
    v_pk_fma_f32 v[214:215], v[214:215], v[196:197], v[194:195]
    v_cvt_pk_bf16_f32 v232, v208, v209
    v_cvt_pk_bf16_f32 v233, -v210, -v211
    v_cvt_pk_bf16_f32 v238, v212, v213
    v_cvt_pk_bf16_f32 v239, -v214, -v215
    v_pk_mul_f32 v[192:193], v[208:209], v[32:33]
    v_pk_mul_f32 v[194:195], v[208:209], v[34:35]
    v_pk_fma_f32 v[208:209], v[210:211], v[34:35], v[192:193] neg_lo:[1,0,0] neg_hi:[1,0,0]
    v_pk_fma_f32 v[210:211], v[210:211], v[32:33], v[194:195]
    ds_write2_b64 v15, v[232:233], v[238:239] offset0:132 offset1:198
    v_add_u32 v15, 2112, v15
    v_pk_mul_f32 v[192:193], v[200:201], v[200:201]
    v_pk_mul_f32 v[194:195], v[200:201], v[202:203]
    v_pk_fma_f32 v[204:205], v[202:203], v[202:203], v[192:193] neg_lo:[1,0,0] neg_hi:[1,0,0]
    v_pk_fma_f32 v[206:207], v[202:203], v[200:201], v[194:195]
    v_cvt_pk_bf16_f32 v234, v208, v209
    v_cvt_pk_bf16_f32 v235, -v210, -v211
    v_pk_mul_f32 v[192:193], v[208:209], v[32:33]
    v_pk_mul_f32 v[194:195], v[208:209], v[34:35]
    v_pk_fma_f32 v[208:209], v[210:211], v[34:35], v[192:193] neg_lo:[1,0,0] neg_hi:[1,0,0]
    v_pk_fma_f32 v[210:211], v[210:211], v[32:33], v[194:195]
    ds_write2_b64 v15, v[234:235], v[238:239] offset0:0 offset1:66
    v_pk_mul_f32 v[192:193], v[220:221], v[36:37]
    s_cmp_eq_u32 s14, 0
    s_cbranch_scc0 Lc_11
    s_waitcnt vmcnt(2)
    s_barrier
    s_lshl_b32 s10, s12, 7
    s_add_u32 s10, s10, 8192
    s_cmp_eq_u32 s3, 0
    s_cselect_b32 s10, s10, 15040512
    v_mov_b32 v4, s7
    s_mov_b64 exec, 1
    buffer_store_dword v4, off, s[56:59], s10 sc1
    s_mov_b64 exec, -1
Lc_11:
    v_pk_mul_f32 v[194:195], v[220:221], v[38:39]
    v_pk_fma_f32 v[216:217], v[222:223], v[38:39], v[192:193] neg_lo:[1,0,0] neg_hi:[1,0,0]
    s_cmp_eq_u32 s14, 1
    s_cbranch_scc0 Lc_12
    s_nop 0
    buffer_load_dword v2, v3, s[56:59], 0 offen sc1
Lc_12:
    v_pk_fma_f32 v[218:219], v[222:223], v[36:37], v[194:195]
    v_cvt_pk_bf16_f32 v232, v208, v209
    v_cvt_pk_bf16_f32 v233, -v210, -v211
    v_pk_mul_f32 v[192:193], v[208:209], v[32:33]
    v_pk_mul_f32 v[194:195], v[208:209], v[34:35]
    v_pk_fma_f32 v[208:209], v[210:211], v[34:35], v[192:193] neg_lo:[1,0,0] neg_hi:[1,0,0]
    v_pk_fma_f32 v[210:211], v[210:211], v[32:33], v[194:195]
    ds_write2_b64 v15, v[232:233], v[238:239] offset0:132 offset1:198
    v_add_u32 v15, 2112, v15
    v_pk_mul_f32 v[192:193], v[212:213], v[196:197]
    v_pk_mul_f32 v[194:195], v[212:213], v[198:199]
    v_pk_fma_f32 v[212:213], v[214:215], v[198:199], v[192:193] neg_lo:[1,0,0] neg_hi:[1,0,0]
    v_pk_fma_f32 v[214:215], v[214:215], v[196:197], v[194:195]
    v_cvt_pk_bf16_f32 v234, v208, v209
    v_cvt_pk_bf16_f32 v235, -v210, -v211
    v_cvt_pk_bf16_f32 v236, v212, v213
    v_cvt_pk_bf16_f32 v237, -v214, -v215
    v_pk_mul_f32 v[192:193], v[208:209], v[32:33]
    v_pk_mul_f32 v[194:195], v[208:209], v[34:35]
    v_pk_fma_f32 v[208:209], v[210:211], v[34:35], v[192:193] neg_lo:[1,0,0] neg_hi:[1,0,0]
    v_pk_fma_f32 v[210:211], v[210:211], v[32:33], v[194:195]
    ds_write2_b64 v15, v[234:235], v[236:237] offset0:0 offset1:66
    v_pk_mul_f32 v[192:193], v[212:213], v[196:197]
    v_pk_mul_f32 v[194:195], v[212:213], v[198:199]
    v_pk_fma_f32 v[212:213], v[214:215], v[198:199], v[192:193] neg_lo:[1,0,0] neg_hi:[1,0,0]
    v_pk_fma_f32 v[214:215], v[214:215], v[196:197], v[194:195]
    v_cvt_pk_bf16_f32 v232, v208, v209
    v_cvt_pk_bf16_f32 v233, -v210, -v211
    v_cvt_pk_bf16_f32 v238, v212, v213
    v_cvt_pk_bf16_f32 v239, -v214, -v215
    ds_write2_b64 v15, v[232:233], v[238:239] offset0:132 offset1:198
    v_add_u32 v15, 2112, v15
    v_pk_mul_f32 v[192:193], v[216:217], v[36:37]
    v_pk_mul_f32 v[194:195], v[216:217], v[38:39]
    v_pk_fma_f32 v[220:221], v[218:219], v[38:39], v[192:193] neg_lo:[1,0,0] neg_hi:[1,0,0]
    v_pk_fma_f32 v[222:223], v[218:219], v[36:37], v[194:195]
    v_cvt_pk_bf16_f32 v234, v216, v217
    v_cvt_pk_bf16_f32 v235, -v218, -v219
    v_cvt_pk_bf16_f32 v236, v220, v221
    v_cvt_pk_bf16_f32 v237, -v222, -v223
    v_pk_mul_f32 v[192:193], v[216:217], v[200:201]
    v_pk_mul_f32 v[194:195], v[216:217], v[202:203]
    v_pk_fma_f32 v[208:209], v[218:219], v[202:203], v[192:193] neg_lo:[1,0,0] neg_hi:[1,0,0]
    v_pk_fma_f32 v[210:211], v[218:219], v[200:201], v[194:195]
    ds_write2_b64 v15, v[234:235], v[236:237] offset0:0 offset1:66
    v_pk_mul_f32 v[192:193], v[220:221], v[200:201]
    v_pk_mul_f32 v[194:195], v[220:221], v[202:203]
    v_pk_fma_f32 v[212:213], v[222:223], v[202:203], v[192:193] neg_lo:[1,0,0] neg_hi:[1,0,0]
    v_pk_fma_f32 v[214:215], v[222:223], v[200:201], v[194:195]
    v_cvt_pk_bf16_f32 v232, v208, v209
    v_cvt_pk_bf16_f32 v233, -v210, -v211
    v_cvt_pk_bf16_f32 v238, v212, v213
    v_cvt_pk_bf16_f32 v239, -v214, -v215
    v_pk_mul_f32 v[192:193], v[208:209], v[200:201]
    v_pk_mul_f32 v[194:195], v[208:209], v[202:203]
    v_pk_fma_f32 v[208:209], v[210:211], v[202:203], v[192:193] neg_lo:[1,0,0] neg_hi:[1,0,0]
    v_pk_fma_f32 v[210:211], v[210:211], v[200:201], v[194:195]
    ds_write2_b64 v15, v[232:233], v[238:239] offset0:132 offset1:198
    v_add_u32 v15, 2112, v15
    v_pk_mul_f32 v[192:193], v[212:213], v[200:201]
    v_pk_mul_f32 v[194:195], v[212:213], v[202:203]
    v_pk_fma_f32 v[212:213], v[214:215], v[202:203], v[192:193] neg_lo:[1,0,0] neg_hi:[1,0,0]
    v_pk_fma_f32 v[214:215], v[214:215], v[200:201], v[194:195]
    v_cvt_pk_bf16_f32 v234, v208, v209
    v_cvt_pk_bf16_f32 v235, -v210, -v211
    v_cvt_pk_bf16_f32 v236, v212, v213
    v_cvt_pk_bf16_f32 v237, -v214, -v215
    v_pk_mul_f32 v[192:193], v[220:221], v[36:37]
    v_pk_mul_f32 v[194:195], v[220:221], v[38:39]
    v_pk_fma_f32 v[216:217], v[222:223], v[38:39], v[192:193] neg_lo:[1,0,0] neg_hi:[1,0,0]
    v_pk_fma_f32 v[218:219], v[222:223], v[36:37], v[194:195]
    ds_write2_b64 v15, v[234:235], v[236:237] offset0:0 offset1:66
    v_pk_mul_f32 v[192:193], v[216:217], v[36:37]
    v_pk_mul_f32 v[194:195], v[216:217], v[38:39]
    v_pk_fma_f32 v[220:221], v[218:219], v[38:39], v[192:193] neg_lo:[1,0,0] neg_hi:[1,0,0]
    v_pk_fma_f32 v[222:223], v[218:219], v[36:37], v[194:195]
    v_pk_mul_f32 v[192:193], v[220:221], v[36:37]
    v_pk_mul_f32 v[194:195], v[220:221], v[38:39]
    v_pk_fma_f32 v[224:225], v[222:223], v[38:39], v[192:193] neg_lo:[1,0,0] neg_hi:[1,0,0]
    v_pk_fma_f32 v[226:227], v[222:223], v[36:37], v[194:195]
    v_cvt_pk_bf16_f32 v232, v216, v217
    v_cvt_pk_bf16_f32 v233, -v218, -v219
    v_cvt_pk_bf16_f32 v238, v224, v225
    v_cvt_pk_bf16_f32 v239, -v226, -v227
    v_pk_mul_f32 v[192:193], v[216:217], v[204:205]
    v_pk_mul_f32 v[194:195], v[216:217], v[206:207]
    v_pk_fma_f32 v[208:209], v[218:219], v[206:207], v[192:193] neg_lo:[1,0,0] neg_hi:[1,0,0]
    v_pk_fma_f32 v[210:211], v[218:219], v[204:205], v[194:195]
    ds_write2_b64 v15, v[232:233], v[238:239] offset0:132 offset1:198
    v_add_u32 v15, 2112, v15
    v_pk_mul_f32 v[192:193], v[224:225], v[204:205]
    v_pk_mul_f32 v[194:195], v[224:225], v[206:207]
    v_pk_fma_f32 v[212:213], v[226:227], v[206:207], v[192:193] neg_lo:[1,0,0] neg_hi:[1,0,0]
    v_pk_fma_f32 v[214:215], v[226:227], v[204:205], v[194:195]
    v_cvt_pk_bf16_f32 v234, v208, v209
    v_cvt_pk_bf16_f32 v235, -v210, -v211
    v_cvt_pk_bf16_f32 v236, v212, v213
    v_cvt_pk_bf16_f32 v237, -v214, -v215
    v_pk_mul_f32 v[192:193], v[224:225], v[36:37]
    v_pk_mul_f32 v[194:195], v[224:225], v[38:39]
    v_pk_fma_f32 v[228:229], v[226:227], v[38:39], v[192:193] neg_lo:[1,0,0] neg_hi:[1,0,0]
    v_pk_fma_f32 v[230:231], v[226:227], v[36:37], v[194:195]
    ds_write2_b64 v15, v[234:235], v[236:237] offset0:0 offset1:66
    v_cvt_pk_bf16_f32 v232, v220, v221
    v_cvt_pk_bf16_f32 v233, -v222, -v223
    v_cvt_pk_bf16_f32 v238, v228, v229
    v_cvt_pk_bf16_f32 v239, -v230, -v231
    v_pk_mul_f32 v[192:193], v[220:221], v[204:205]
    v_pk_mul_f32 v[194:195], v[220:221], v[206:207]
    v_pk_fma_f32 v[208:209], v[222:223], v[206:207], v[192:193] neg_lo:[1,0,0] neg_hi:[1,0,0]
    v_pk_fma_f32 v[210:211], v[222:223], v[204:205], v[194:195]
    ds_write2_b64 v15, v[232:233], v[238:239] offset0:132 offset1:198
    v_add_u32 v15, 2112, v15
    v_pk_mul_f32 v[192:193], v[228:229], v[204:205]
    v_pk_mul_f32 v[194:195], v[228:229], v[206:207]
    v_pk_fma_f32 v[212:213], v[230:231], v[206:207], v[192:193] neg_lo:[1,0,0] neg_hi:[1,0,0]
    v_pk_fma_f32 v[214:215], v[230:231], v[204:205], v[194:195]
    v_cvt_pk_bf16_f32 v234, v208, v209
    v_cvt_pk_bf16_f32 v235, -v210, -v211
    v_cvt_pk_bf16_f32 v236, v212, v213
    v_cvt_pk_bf16_f32 v237, -v214, -v215
    ds_write2_b64 v15, v[234:235], v[236:237] offset0:0 offset1:66
LS_J:
Lst_5457:
    s_cbranch_execz Lst_6574
    s_nop 0
    s_cmp_eq_u32 s14, 0
    s_cbranch_scc0 Lc_13
    buffer_load_dword v132, v129, s[48:51], s77 offen
    buffer_load_dword v133, v129, s[52:55], s77 offen offset:2048
    s_add_u32 s77, s77, 1105920
Lc_13:
    s_cmp_eq_u32 s14, 1
    s_cbranch_scc0 Lc_16
    s_waitcnt vmcnt(0)
    v_cmp_ne_u32 vcc, s7, v2
    s_cbranch_vccnz Lslow_14
Lback_15:
Lc_16:
    s_waitcnt lgkmcnt(0)
    s_barrier
    s_cmp_eq_u32 s14, 1
    s_cbranch_scc0 Lc_17
    s_lshl_b32 s8, s15, 5
    s_mul_i32 s9, s3, 663552
    s_add_u32 s8, s8, s9
    s_add_u32 s8, s8, 393216
    s_add_u32 s9, s8, 331776
    v_lshrrev_b32 v31, 1, v0
    v_mul_u32_u24 v31, 10336, v31
    v_lshl_add_u32 v31, v0, 4, v31
    buffer_load_dwordx4 a[248:251], v31, s[56:59], s8 offen sc1
    buffer_load_dwordx4 a[252:255], v31, s[56:59], s9 offen sc1
Lc_17:
    ds_read_b128 v[208:211], v16 offset:16896
    ds_read_b128 v[212:215], v17 offset:0
    ds_read_b128 v[216:219], v16 offset:16928
    ds_read_b128 v[220:223], v17 offset:32
    ds_read_b128 v[224:227], v16 offset:16960
    ds_read_b128 v[228:231], v17 offset:64
    ds_read_b128 v[232:235], v16 offset:16992
    ds_read_b128 v[236:239], v17 offset:96
    ds_read_b128 v[240:243], v16 offset:17024
    ds_read_b128 v[244:247], v17 offset:128
    s_waitcnt lgkmcnt(8)
    v_mfma_f32_32x32x16_bf16 v[192:207], v[208:211], v[212:215], 0
    ds_read_b128 v[248:251], v16 offset:17056
    ds_read_b128 v[252:255], v17 offset:160
    s_lshl_b32 s80, s4, 2
    s_lshr_b32 s8, s5, 3
    s_add_u32 s80, s80, s8
    s_add_u32 s81, s5, s8
    s_and_b32 s81, s81, 7
    s_mul_i32 s82, s3, 13
    s_mul_i32 s83, s81, 54
    s_waitcnt lgkmcnt(8)
    v_mfma_f32_32x32x16_bf16 v[192:207], v[216:219], v[220:223], v[192:207]
    ds_read_b128 v[208:211], v16 offset:17088
    ds_read_b128 v[212:215], v17 offset:192
    s_add_u32 s83, s83, s82
    s_mul_i32 s83, s83, 5120
    s_add_u32 s83, s83, 3047424
    v_lshlrev_b32_e64 v1, 4, v0
    s_mul_i32 s41, s81, 0
    s_add_u32 s41, s41, s3
    s_and_b32 s41, s41, 3
    s_waitcnt lgkmcnt(8)
    v_mfma_f32_32x32x16_bf16 v[192:207], v[224:227], v[228:231], v[192:207]
    ds_read_b128 v[216:219], v16 offset:17120
    ds_read_b128 v[220:223], v17 offset:224
    s_add_u32 s8, s41, 1
    s_and_b32 s8, s8, 3
    s_lshl2_add_u32 s8, s80, s8
    s_mul_i32 s8, s8, 54
    s_add_u32 s8, s8, s82
    s_lshl_b32 s8, s8, 10
    s_add_u32 s30, s8, 7962624
    s_waitcnt lgkmcnt(8)
    v_mfma_f32_32x32x16_bf16 v[192:207], v[232:235], v[236:239], v[192:207]
    ds_read_b128 v[224:227], v16 offset:17152
    ds_read_b128 v[228:231], v17 offset:256
    s_add_u32 s8, s41, 2
    s_and_b32 s8, s8, 3
    s_lshl2_add_u32 s8, s80, s8
    s_mul_i32 s8, s8, 54
    s_add_u32 s8, s8, s82
    s_lshl_b32 s8, s8, 10
    s_add_u32 s31, s8, 7962624
    s_add_u32 s8, s41, 3
    s_waitcnt lgkmcnt(8)
    v_mfma_f32_32x32x16_bf16 v[192:207], v[240:243], v[244:247], v[192:207]
    ds_read_b128 v[232:235], v16 offset:17184
    ds_read_b128 v[236:239], v17 offset:288
    s_and_b32 s8, s8, 3
    s_lshl2_add_u32 s8, s80, s8
    s_mul_i32 s8, s8, 54
    s_add_u32 s8, s8, s82
    s_lshl_b32 s8, s8, 10
    s_add_u32 s40, s8, 7962624
    s_add_u32 s8, s41, 4
    s_waitcnt lgkmcnt(8)
    v_mfma_f32_32x32x16_bf16 v[192:207], v[248:251], v[252:255], v[192:207]
    ds_read_b128 v[240:243], v16 offset:17216
    ds_read_b128 v[244:247], v17 offset:320
    s_and_b32 s8, s8, 3
    s_lshl2_add_u32 s8, s80, s8
    s_mul_i32 s8, s8, 54
    s_add_u32 s8, s8, s82
    s_lshl_b32 s8, s8, 10
    s_add_u32 s84, s8, 7962624
    s_mov_b32 s71, s83
    s_waitcnt lgkmcnt(8)
    v_mfma_f32_32x32x16_bf16 v[192:207], v[208:211], v[212:215], v[192:207]
    ds_read_b128 v[248:251], v16 offset:17248
    ds_read_b128 v[252:255], v17 offset:352
    s_lshl_b32 s10, s3, 13
    s_add_u32 s10, s10, 8192
    v_lshl_add_u32 v3, v0, 7, s10
    s_lshr_b32 s10, s29, 10
    v_min_u32 v19, 12, v0
    v_writelane_b32 v19, s10, 62
    s_lshr_b32 s10, s81, 1
    s_waitcnt lgkmcnt(8)
    v_mfma_f32_32x32x16_bf16 v[192:207], v[216:219], v[220:223], v[192:207]
    ds_read_b128 v[208:211], v16 offset:17280
    ds_read_b128 v[212:215], v17 offset:384
    s_lshl_b32 s10, s10, 6
    s_add_u32 s10, s10, s82
    s_lshl_b32 s10, s10, 7
    s_add_u32 s10, s10, 40960
    v_lshl_add_u32 v19, v19, 7, s10
    s_lshr_b32 s32, s3, 1
    s_mul_i32 s33, s32, 4160
    s_add_u32 s33, s33, 67808
    s_waitcnt lgkmcnt(8)
    v_mfma_f32_32x32x16_bf16 v[192:207], v[224:227], v[228:231], v[192:207]
    ds_read_b128 v[216:219], v16 offset:17312
    ds_read_b128 v[220:223], v17 offset:416
    v_and_b32 v4, 3, v0
    v_bfe_u32 v5, v0, 2, 2
    v_sub_u32 v4, v4, v5
    v_lshrrev_b32 v5, 4, v0
    v_lshlrev_b32 v13, 3, v5
    v_sub_u32 v4, v4, v13
    v_lshl_add_u32 v29, v4, 3, s33
    s_waitcnt lgkmcnt(8)
    v_mfma_f32_32x32x16_bf16 v[192:207], v[232:235], v[236:239], v[192:207]
    ds_read_b128 v[224:227], v16 offset:17344
    ds_read_b128 v[228:231], v17 offset:448
    s_mul_i32 s33, s32, 9216
    s_add_u32 s33, s33, 49152
    v_and_b32 v4, 15, v0
    v_lshl_add_u32 v4, v5, 1, v4
    v_lshl_add_u32 v30, v4, 4, s33
    s_lshr_b32 s32, s3, 1
    s_and_b32 s33, s3, 1
    s_waitcnt lgkmcnt(8)
    v_mfma_f32_32x32x16_bf16 v[192:207], v[240:243], v[244:247], v[192:207]
    ds_read_b128 v[232:235], v16 offset:17376
    ds_read_b128 v[236:239], v17 offset:480
    s_mul_i32 s34, s32, 9216
    s_add_u32 s34, s34, 49152
    v_lshrrev_b32 v6, 4, v0
    s_mul_i32 s35, s32, 4160
    s_add_u32 s35, s35, 67584
    v_lshl_add_u32 v7, v6, 4, s35
    s_mul_i32 s35, s32, 8224
    s_waitcnt lgkmcnt(8)
    v_mfma_f32_32x32x16_bf16 v[192:207], v[248:251], v[252:255], v[192:207]
    s_add_u32 s35, s35, 75904
    v_mov_b32 v8, s35
    v_cmp_lt_u32 s[36:37], 31, v0
    v_mul_u32_u24 v6, 2048, v6
    v_lshl_add_u32 v6, v0, 4, v6
    v_cndmask_b32 v7, v7, v8, s[36:37]
    v_and_b32_e64 v8, 15, v0
    v_cmp_eq_u32 s[36:37], 15, v8
    s_waitcnt lgkmcnt(6)
    v_mfma_f32_32x32x16_bf16 v[192:207], v[208:211], v[212:215], v[192:207]
    v_add_u32 v6, s34, v6
    v_mov_b32 v10, 0
    v_mov_b32 v11, 0
    v_cndmask_b32 v6, v6, v7, s[36:37]
    s_lshl_b32 s35, s33, 3
    s_sub_u32 s34, s34, s35
    v_add_u32 v6, s35, v6
    s_waitcnt lgkmcnt(4)
    v_mfma_f32_32x32x16_bf16 v[192:207], v[216:219], v[220:223], v[192:207]
    s_add_u32 s34, s34, 240
    v_bfe_u32 v7, v0, 1, 4
    v_lshl_add_u32 v7, v7, 4, s34
    v_and_b32_e64 v12, 1, v0
    v_lshl_add_u32 v7, v12, 2, v7
    v_lshrrev_b32_e64 v9, 5, v0
    v_lshl_add_u32 v8, v9, 9, v7
    s_waitcnt lgkmcnt(2)
    v_mfma_f32_32x32x16_bf16 v[192:207], v[224:227], v[228:231], v[192:207]
    v_lshl_add_u32 v7, v9, 8, v7
    s_lshl_b32 s32, s3, 10
    s_add_u32 s32, s32, 67616
    v_mul_u32_u24 v12, 4152, v12
    v_lshl_add_u32 v12, v0, 3, v12
    v_add_u32 v12, s32, v12
    v_mov_b32_e64 v26, v12
    s_waitcnt lgkmcnt(0)
    v_mfma_f32_32x32x16_bf16 v[192:207], v[232:235], v[236:239], v[192:207]
    v_mov_b32 v27, v7
    v_mov_b32 v28, v8
    v_mov_b32 v23, s79
    v_cmp_eq_u32 vcc, 0, v0
    v_and_b32 v24, 1, v0
    s_nop 0
    v_cndmask_b32 v23, 0, v23, vcc
    v_cmp_eq_u32 vcc, 1, v24
    s_nop 3
    v_add_f32 v192, v192, v23
    v_cvt_pk_bf16_f32 v32, v192, v196
    v_cvt_pk_bf16_f32 v33, v193, v197
    v_cvt_pk_bf16_f32 v34, v194, v198
    v_cvt_pk_bf16_f32 v35, v195, v199
    v_cvt_pk_bf16_f32 v36, v200, v201
    v_cvt_pk_bf16_f32 v37, v200, v202
    v_cvt_pk_bf16_f32 v38, v201, v202
    v_cndmask_b32_e64 v23, v203, v204, vcc
    v_cvt_pk_bf16_f32 v39, v203, v23
    v_cvt_pk_bf16_f32 v40, v203, v204
    v_cndmask_b32_e64 v23, v205, v206, vcc
    v_cvt_pk_bf16_f32 v41, v205, v23
    v_cvt_pk_bf16_f32 v42, v205, v206
    s_cmp_eq_u32 s14, 1
    s_cbranch_scc1 LS_c3
    ds_write_b64 v6, v[10:11]
    ds_write2st64_b32 v27, v32, v33 offset0:0 offset1:9
    ds_write2st64_b32 v27, v34, v35 offset0:18 offset1:27
    ds_write2st64_b32 v27, v36, v36 offset0:2 offset1:11
    ds_write2st64_b32 v27, v37, v38 offset0:20 offset1:29
    ds_write2st64_b32 v28, v39, v40 offset0:4 offset1:13
    ds_write2st64_b32 v28, v40, v40 offset0:22 offset1:31
    ds_write2st64_b32 v28, v41, v42 offset0:5 offset1:14
    ds_write2st64_b32 v28, v42, v42 offset0:23 offset1:32
    s_cmp_eq_u32 s101, 2
    s_cbranch_scc1 LS_c2
    s_mov_b32 s78, s72
    s_mov_b32 s79, s73
    s_lshr_b32 s34, s3, 1
    s_lshl_b32 s34, s34, 4
    s_lshr_b32 s78, s78, s34
    s_lshl_b32 s78, s78, 16
    s_lshr_b32 s79, s79, s34
    s_lshl_b32 s79, s79, 16
    s_mov_b32 s35, 0x3fb8aa3b
    v_mov_b32 v80, s78
    v_lshlrev_b32 v85, 16, v118
    v_and_b32 v86, s6, v118
    v_mul_f32 v80, s35, v80
    v_mul_f32 v85, s35, v85
    v_mul_f32 v86, s35, v86
    v_exp_f32 v80, v80
    v_exp_f32 v85, v85
    v_exp_f32 v86, v86
    v_lshlrev_b32 v87, 16, v119
    v_and_b32_e64 v88, s6, v119
    v_cvt_pk_bf16_f32 v80, v80, v80
    v_cvt_pk_bf16_f32 v86, v85, v86
    v_lshlrev_b32 v80, 16, v80
    v_lshlrev_b32 v85, 16, v86
    v_and_b32 v86, s6, v86
    v_mul_f32 v87, v87, v80
    v_mul_f32 v88, v88, v80
    v_mul_f32 v85, v85, v80
    v_mul_f32 v86, v86, v80
    v_mul_f32 v87, 0.15915494, v87
    v_mul_f32 v88, 0.15915494, v88
    v_mul_f32 v85, s35, v85
    v_mul_f32 v86, s35, v86
    v_add_f32 v80, v80, v80
    v_lshlrev_b32 v40, 16, v120
    v_and_b32 v41, s6, v120
    v_lshlrev_b32 v42, 16, v121
    v_and_b32_e64 v43, s6, v121
    s_bitcmp1_b32 s3, 0
    s_cselect_b32 s34, 1.0, 0x41000000
    s_mov_b32 s35, 0x43800000
    v_mul_f32 v40, v40, v80
    v_mul_f32 v41, v41, v80
    v_mul_f32 v42, v42, v80
    v_mul_f32 v43, v43, v80
    v_mul_f32 v89, s34, v85
    v_mul_f32 v90, s34, v86
    v_mul_f32 v34, s34, v87
    v_mul_f32 v35, s34, v88
    v_exp_f32_e64 v89, -v89
    v_exp_f32_e64 v90, -v90
    v_fract_f32 v34, v34
    v_fract_f32 v35, v35
    v_cos_f32 v32, v34
    v_cos_f32 v33, v35
    v_sin_f32 v34, v34
    v_sin_f32 v35, v35
    v_mul_f32 v32, v32, v89
    v_mul_f32 v33, v33, v90
    v_mul_f32 v34, v34, v89
    v_mul_f32 v35, v35, v90
    v_mul_f32 v89, s35, v85
    v_mul_f32 v90, s35, v86
    v_mul_f32 v38, s35, v87
    v_mul_f32 v39, s35, v88
    v_exp_f32_e64 v89, -v89
    v_exp_f32_e64 v90, -v90
    v_fract_f32 v38, v38
    v_fract_f32 v39, v39
    v_cos_f32 v36, v38
    v_cos_f32 v37, v39
    v_sin_f32 v38, v38
    v_sin_f32 v39, v39
    v_mul_f32 v36, v36, v89
    v_mul_f32 v37, v37, v90
    v_mul_f32 v38, v38, v89
    v_mul_f32 v39, v39, v90
    s_mul_i32 s34, s3, 16896
    s_add_u32 s34, s34, 96256
    v_lshl_add_u32 v15, v0, 3, s34
    s_mov_b32 s14, 1
    s_barrier
    s_branch LS_it
LS_c2:
    buffer_load_dword v2, v3, s[56:59], 0 offen sc1
    s_waitcnt vmcnt(0)
    v_cmp_ne_u32 vcc, s7, v2
    s_cbranch_vccnz Lslow_18
Lback_19:
    s_barrier
    s_lshl_b32 s10, s4, 7
    s_add_u32 s10, s10, 4096
    s_lshl_b32 s9, s3, 8
    s_add_u32 s9, s9, s5
    s_cmp_eq_u32 s9, 31
    s_cselect_b32 s10, s10, 15040512
    s_lshl_b32 s9, s3, 8
    s_add_u32 s9, s9, s2
    s_cmp_eq_u32 s9, 504
    s_cselect_b32 s10, 0, s10
    v_mov_b32 v4, s7
    s_mov_b64 exec, 1
    buffer_store_dword v4, off, s[56:59], s10 sc1
    s_mov_b64 exec, -1
    s_lshl_b32 s8, s15, 5
    s_mul_i32 s9, s3, 663552
    s_add_u32 s8, s8, s9
    s_add_u32 s8, s8, 393216
    s_add_u32 s9, s8, 331776
    v_lshrrev_b32 v31, 1, v0
    v_mul_u32_u24 v31, 10336, v31
    v_lshl_add_u32 v31, v0, 4, v31
    buffer_load_dwordx4 a[248:251], v31, s[56:59], s8 offen sc1
    buffer_load_dwordx4 a[252:255], v31, s[56:59], s9 offen sc1
LS_c3:
    s_waitcnt vmcnt(0)
    ds_write_b128 v26, a[248:251]
    ds_write_b128 v26, a[252:255] offset:512
    s_waitcnt lgkmcnt(0)
    s_barrier
    s_bitcmp1_b32 s3, 0
    s_cbranch_scc1 LS_h1A
    s_nop 0
    ds_read_b64_tr_b16 v[128:129], v29 offset:32
    ds_read_b64_tr_b16 v[130:131], v29 offset:0
    ds_read_b64_tr_b16 v[132:133], v29 offset:288
    ds_read_b64_tr_b16 v[134:135], v29 offset:256
    ds_read_b64_tr_b16 v[136:137], v29 offset:544
    ds_read_b64_tr_b16 v[138:139], v29 offset:512
    ds_read_b64_tr_b16 v[140:141], v29 offset:800
    ds_read_b64_tr_b16 v[142:143], v29 offset:768
    ds_read_b64_tr_b16 v[144:145], v29 offset:1056
    ds_read_b64_tr_b16 v[146:147], v29 offset:1024
    ds_read_b64_tr_b16 v[148:149], v29 offset:1312
    ds_read_b64_tr_b16 v[150:151], v29 offset:1280
    ds_read_b64_tr_b16 v[160:161], v29 offset:2080
    ds_read_b64_tr_b16 v[162:163], v29 offset:2048
    ds_read_b64_tr_b16 v[164:165], v29 offset:2336
    ds_read_b64_tr_b16 v[166:167], v29 offset:2304
    ds_read_b128 v[48:51], v30 offset:4224
    ds_read_b128 v[52:55], v30 offset:4096
    ds_read_b128 v[56:59], v30 offset:3968
    ds_read_b128 v[60:63], v30 offset:3840
    ds_read_b128 v[64:67], v30 offset:3712
    ds_read_b128 v[68:71], v30 offset:3584
    ds_read_b128 v[72:75], v30 offset:896
Lst_5842:
    s_cbranch_execz Lst_7004
    s_nop 0
    ds_read_b128 v[76:79], v30 offset:768
    s_waitcnt lgkmcnt(6)
    v_mfma_f32_16x16x32_bf16 v[240:243], v[128:131], v[48:51], 0
    ds_read_b64_tr_b16 v[168:169], v29 offset:2592
    s_lshr_b32 s32, s3, 1
    v_mfma_f32_16x16x32_bf16 v[240:243], v[132:135], v[52:55], v[240:243]
    s_lshl_b32 s38, s15, 1
    ds_read_b64_tr_b16 v[170:171], v29 offset:2560
    s_waitcnt lgkmcnt(6)
    v_mfma_f32_16x16x32_bf16 v[240:243], v[136:139], v[56:59], v[240:243]
    s_add_u32 s38, s38, s32
    ds_read_b128 v[48:51], v30 offset:640
    v_mov_b32 v226, 0
    v_mfma_f32_16x16x32_bf16 v[240:243], v[140:143], v[60:63], v[240:243]
    s_mul_i32 s38, s38, 4224
    ds_read_b64_tr_b16 v[172:173], v29 offset:2848
    s_waitcnt lgkmcnt(6)
    v_mfma_f32_16x16x32_bf16 v[240:243], v[144:147], v[64:67], v[240:243]
    s_add_u32 s38, s38, 5259264
    ds_read_b64_tr_b16 v[174:175], v29 offset:2816
    v_mov_b32 v227, 0
    v_mfma_f32_16x16x32_bf16 v[240:243], v[148:151], v[68:71], v[240:243]
    s_mul_i32 s32, s32, 8224
    ds_read_b128 v[52:55], v30 offset:512
    s_waitcnt lgkmcnt(6)
    v_mfma_f32_16x16x32_bf16 v[204:207], v[128:131], v[72:75], 0
    s_and_b32 s33, s3, 1
    ds_read_b64_tr_b16 v[152:153], v29 offset:1568
    v_mov_b32_e64 v214, 0
    v_mfma_f32_16x16x32_bf16 v[204:207], v[132:135], v[76:79], v[204:207]
    s_lshl_b32 s33, s33, 10
    ds_read_b64_tr_b16 v[154:155], v29 offset:1536
    v_mov_b32 v215, 0
    v_mfma_f32_16x16x32_bf16 v[216:219], v[140:143], v[76:79], 0
    s_add_u32 s32, s32, s33
    ds_read_b64_tr_b16 v[176:177], v29 offset:3104
    v_mov_b32 v202, 0
    v_mfma_f32_16x16x32_bf16 v[216:219], v[136:139], v[72:75], v[216:219]
    s_lshl_b32 s8, s15, 5
    ds_read_b64_tr_b16 v[178:179], v29 offset:3072
    v_mov_b32 v232, v242
    v_mfma_f32_16x16x32_bf16 v[228:231], v[160:163], v[72:75], 0
    s_mul_i32 s9, s3, 663552
    ds_read_b128 v[56:59], v30 offset:2688
    v_mov_b32_e64 v233, v243
    v_mfma_f32_16x16x32_bf16 v[228:231], v[164:167], v[76:79], v[228:231]
    s_add_u32 s8, s8, s9
    ds_read_b64_tr_b16 v[156:157], v29 offset:1824
    s_waitcnt lgkmcnt(6)
    v_mfma_f32_16x16x32_bf16 v[204:207], v[136:139], v[48:51], v[204:207]
    s_add_u32 s8, s8, 393248
    ds_read_b64_tr_b16 v[158:159], v29 offset:1792
    v_mov_b32_e64 v238, v242
    v_mfma_f32_16x16x32_bf16 v[204:207], v[140:143], v[52:55], v[204:207]
    s_add_u32 s9, s8, 331776
    ds_read_b64_tr_b16 v[180:181], v29 offset:3360
    v_mov_b32_e64 v239, v243
    v_mfma_f32_16x16x32_bf16 v[216:219], v[148:151], v[52:55], v[216:219]
    s_add_u32 s32, s32, 75904
    ds_read_b64_tr_b16 v[182:183], v29 offset:3328
    v_add_f32_e64 v242, v242, v240
    v_mfma_f32_16x16x32_bf16 v[216:219], v[144:147], v[48:51], v[216:219]
    ds_read_b128 v[60:63], v30 offset:2560
    v_add_f32_e64 v243, v243, v241
    v_mfma_f32_16x16x32_bf16 v[228:231], v[168:171], v[48:51], v[228:231]
    ds_read_b128 v[64:67], v30 offset:3456
    v_mov_b32_e64 v203, 0
    v_mfma_f32_16x16x32_bf16 v[228:231], v[172:175], v[52:55], v[228:231]
    ds_read_b128 v[68:71], v30 offset:3328
    s_waitcnt lgkmcnt(2)
    v_mfma_f32_16x16x32_bf16 v[210:213], v[144:147], v[56:59], v[204:207]
    ds_read_b64_tr_b16 v[184:185], v29 offset:3616
    v_lshrrev_b32 v31, 1, v0
    v_mfma_f32_16x16x32_bf16 v[210:213], v[148:151], v[60:63], v[210:213]
    ds_read_b64_tr_b16 v[186:187], v29 offset:3584
    v_mul_u32_u24 v31, 10336, v31
    v_mfma_f32_16x16x32_bf16 v[222:225], v[156:159], v[60:63], v[216:219]
    ds_read_b128 v[72:75], v30 offset:2432
    v_lshl_add_u32 v31, v0, 4, v31
    v_mfma_f32_16x16x32_bf16 v[222:225], v[152:155], v[56:59], v[222:225]
    ds_read_b64_tr_b16 v[188:189], v29 offset:3872
    v_add_u32_e64 v4, 16, v0
    v_mfma_f32_16x16x32_bf16 v[234:237], v[176:179], v[56:59], v[228:231]
    ds_read_b64_tr_b16 v[190:191], v29 offset:3840
    v_subrev_u32_e64 v5, 47, v0
    v_mfma_f32_16x16x32_bf16 v[234:237], v[180:183], v[60:63], v[234:237]
    ds_read_b128 v[76:79], v30 offset:2304
    s_waitcnt lgkmcnt(6)
    v_mfma_f32_16x16x32_bf16 v[222:225], v[132:135], v[68:71], v[222:225]
    ds_read_b128 v[48:51], v30 offset:1920
    v_cmp_lt_u32 s[36:37], 47, v0
    v_mfma_f32_16x16x32_bf16 v[222:225], v[128:131], v[64:67], v[222:225]
    ds_read_b128 v[52:55], v30 offset:1792
    v_lshl_add_u32 v6, v0, 4, s32
    v_mfma_f32_16x16x32_bf16 v[234:237], v[152:155], v[64:67], v[234:237]
    ds_read_b128 v[56:59], v30 offset:0
    v_and_b32 v11, 15, v0
    v_mfma_f32_16x16x32_bf16 v[234:237], v[156:159], v[68:71], v[234:237]
    ds_read_b128 v[60:63], v30 offset:128
    s_waitcnt lgkmcnt(4)
    v_mfma_f32_16x16x32_bf16 v[198:201], v[132:135], v[76:79], 0
    ds_read_b128 v[64:67], v30 offset:1664
    v_cndmask_b32 v4, v4, v5, s[36:37]
    v_mfma_f32_16x16x32_bf16 v[198:201], v[128:131], v[72:75], v[198:201]
    ds_read_b128 v[68:71], v30 offset:1536
    v_cmp_eq_u32 s[36:37], 63, v0
    v_mfma_f32_16x16x32_bf16 v[210:213], v[152:155], v[72:75], v[210:213]
    buffer_load_dwordx4 a[248:251], v31, s[56:59], s8 offen sc1
    v_mfma_f32_16x16x32_bf16 v[210:213], v[156:159], v[76:79], v[210:213]
    v_lshlrev_b32 v11, 4, v11
    v_and_b32_e64 v9, 12, v0
    v_mfma_f32_16x16x32_bf16 v[222:225], v[164:167], v[76:79], v[222:225]
    v_lshl_add_u32 v11, v9, 4, v11
    v_bfe_u32 v9, v0, 4, 1
    v_mfma_f32_16x16x32_bf16 v[222:225], v[160:163], v[72:75], v[222:225]
    v_cndmask_b32 v4, v4, 64, s[36:37]
    v_lshl_add_u32 v4, v4, 4, s32
    v_mfma_f32_16x16x32_bf16 v[234:237], v[184:187], v[72:75], v[234:237]
    s_lshl_b32 s32, s33, 1
    s_sub_u32 s32, 3072, s32
    v_add_u32 v5, s32, v4
    v_mfma_f32_16x16x32_bf16 v[234:237], v[188:191], v[76:79], v[234:237]
    ds_read_b128 v[72:75], v30 offset:256
    s_waitcnt lgkmcnt(5)
    v_mfma_f32_16x16x32_bf16 v[228:231], v[128:131], v[48:51], v[228:231]
    ds_read_b128 v[76:79], v30 offset:384
    v_add_u32 v7, s32, v6
    v_mfma_f32_16x16x32_bf16 v[228:231], v[132:135], v[52:55], v[228:231]
    ds_read_b128 v[48:51], v30 offset:1408
    s_waitcnt lgkmcnt(5)
    v_mfma_f32_16x16x32_bf16 v[192:195], v[128:131], v[60:63], 0
    ds_read_b128 v[52:55], v30 offset:1280
    v_lshl_add_u32 v11, v9, 11, v11
    v_mfma_f32_16x16x32_bf16 v[192:195], v[132:135], v[56:59], v[192:195]
    v_add_f32 v234, v234, v240
    v_add_f32_e64 v235, v235, v241
    v_mfma_f32_16x16x32_bf16 v[204:207], v[156:159], v[56:59], v[204:207]
    v_add_f32 v236, v236, v242
    v_add_f32 v237, v237, v243
    v_mfma_f32_16x16x32_bf16 v[204:207], v[152:155], v[60:63], v[204:207]
    buffer_load_dwordx4 a[252:255], v31, s[56:59], s9 offen sc1
    v_mfma_f32_16x16x32_bf16 v[216:219], v[160:163], v[60:63], v[216:219]
    v_lshrrev_b32_e64 v9, 5, v0
    v_lshl_add_u32 v11, v9, 6, v11
    v_mfma_f32_16x16x32_bf16 v[216:219], v[164:167], v[56:59], v[216:219]
    s_lshr_b32 s33, s33, 1
    s_lshr_b32 s32, s32, 1
    v_add_u32_e64 v11, s33, v11
    v_mfma_f32_16x16x32_bf16 v[228:231], v[188:191], v[56:59], v[228:231]
    v_add_u32 v12, s32, v11
    s_mov_b32 s78, s74
    v_mfma_f32_16x16x32_bf16 v[228:231], v[184:187], v[60:63], v[228:231]
    s_mov_b32 s79, s75
    ds_read_b128 v[56:59], v30 offset:1024
    s_waitcnt lgkmcnt(5)
    v_mfma_f32_16x16x32_bf16 v[228:231], v[136:139], v[64:67], v[228:231]
    ds_read_b128 v[60:63], v30 offset:1152
    s_lshr_b32 s34, s3, 1
    v_mfma_f32_16x16x32_bf16 v[228:231], v[140:143], v[68:71], v[228:231]
    s_lshl_b32 s34, s34, 4
    ds_read_b128 v[64:67], v30 offset:8064
    s_waitcnt lgkmcnt(5)
    v_mfma_f32_16x16x32_bf16 v[204:207], v[148:151], v[72:75], v[204:207]
    ds_read_b128 v[68:71], v30 offset:7936
    s_lshr_b32 s78, s78, s34
    v_mfma_f32_16x16x32_bf16 v[204:207], v[144:147], v[76:79], v[204:207]
    s_lshl_b32 s78, s78, 16
    s_lshr_b32 s79, s79, s34
    s_lshl_b32 s79, s79, 16
    v_mfma_f32_16x16x32_bf16 v[216:219], v[152:155], v[76:79], v[216:219]
    s_mov_b32 s35, 0x3fb8aa3b
    v_mov_b32 v80, s78
    v_lshlrev_b32_e64 v85, 16, v123
    v_mfma_f32_16x16x32_bf16 v[216:219], v[156:159], v[72:75], v[216:219]
    v_and_b32 v86, s6, v123
    v_mul_f32 v80, s35, v80
    v_mfma_f32_16x16x32_bf16 v[228:231], v[180:183], v[72:75], v[228:231]
    v_mul_f32 v85, s35, v85
    v_mul_f32 v86, s35, v86
    v_mfma_f32_16x16x32_bf16 v[228:231], v[176:179], v[76:79], v[228:231]
    ds_read_b128 v[72:75], v30 offset:6912
    s_waitcnt lgkmcnt(5)
    v_mfma_f32_16x16x32_bf16 v[228:231], v[144:147], v[48:51], v[228:231]
    ds_read_b128 v[76:79], v30 offset:7040
    v_mfma_f32_16x16x32_bf16 v[228:231], v[148:151], v[52:55], v[228:231]
    ds_read_b128 v[48:51], v30 offset:7808
    s_waitcnt lgkmcnt(5)
    v_mfma_f32_16x16x32_bf16 v[216:219], v[128:131], v[60:63], v[216:219]
    ds_read_b128 v[52:55], v30 offset:7680
    v_mfma_f32_16x16x32_bf16 v[216:219], v[132:135], v[56:59], v[216:219]
    v_exp_f32_e64 v80, v80
    v_mfma_f32_16x16x32_bf16 v[228:231], v[156:159], v[56:59], v[228:231]
    v_exp_f32_e64 v85, v85
    v_mfma_f32_16x16x32_bf16 v[228:231], v[152:155], v[60:63], v[228:231]
    ds_read_b128 v[56:59], v30 offset:7168
    s_waitcnt lgkmcnt(5)
    v_mfma_f32_16x16x32_bf16 v[224:227], v[132:135], v[68:71], v[224:227]
    ds_read_b128 v[60:63], v30 offset:7296
    v_mov_b32 v220, 0
    v_mfma_f32_16x16x32_bf16 v[224:227], v[128:131], v[64:67], v[224:227]
    v_mov_b32 v221, 0
    v_mov_b32 v208, 0
    v_mfma_f32_16x16x32_bf16 v[236:239], v[152:155], v[64:67], v[236:239]
    v_mov_b32 v209, 0
    v_mov_b32 v196, 0
    v_mfma_f32_16x16x32_bf16 v[236:239], v[156:159], v[68:71], v[236:239]
    ds_read_b128 v[64:67], v30 offset:7552
    s_waitcnt lgkmcnt(5)
    v_mfma_f32_16x16x32_bf16 v[200:203], v[128:131], v[76:79], v[200:203]
    ds_read_b128 v[68:71], v30 offset:7424
    v_add_f32 v230, v230, v240
    v_mfma_f32_16x16x32_bf16 v[200:203], v[132:135], v[72:75], v[200:203]
    v_add_f32 v231, v231, v241
    v_mov_b32 v197, 0
    v_mfma_f32_16x16x32_bf16 v[212:215], v[156:159], v[72:75], v[212:215]
    v_exp_f32_e64 v86, v86
    v_mfma_f32_16x16x32_bf16 v[212:215], v[152:155], v[76:79], v[212:215]
    v_lshlrev_b32 v87, 16, v124
    v_and_b32 v88, s6, v124
    v_mfma_f32_16x16x32_bf16 v[224:227], v[160:163], v[76:79], v[224:227]
    v_cvt_pk_bf16_f32 v80, v80, v80
    v_cvt_pk_bf16_f32 v86, v85, v86
    v_mfma_f32_16x16x32_bf16 v[224:227], v[164:167], v[72:75], v[224:227]
    v_lshlrev_b32 v80, 16, v80
    v_lshlrev_b32 v85, 16, v86
    v_mfma_f32_16x16x32_bf16 v[236:239], v[188:191], v[72:75], v[236:239]
    v_and_b32 v86, s6, v86
    v_mul_f32 v87, v87, v80
    v_mfma_f32_16x16x32_bf16 v[236:239], v[184:187], v[76:79], v[236:239]
    ds_read_b128 v[72:75], v30 offset:5760
    s_waitcnt lgkmcnt(5)
    v_mfma_f32_16x16x32_bf16 v[212:215], v[128:131], v[48:51], v[212:215]
    ds_read_b128 v[76:79], v30 offset:5632
    v_mul_f32 v88, v88, v80
    v_mfma_f32_16x16x32_bf16 v[212:215], v[132:135], v[52:55], v[212:215]
    v_mul_f32 v85, v85, v80
    v_mul_f32 v86, v86, v80
    v_mfma_f32_16x16x32_bf16 v[224:227], v[140:143], v[52:55], v[224:227]
    v_mul_f32 v87, 0.15915494, v87
    v_mul_f32 v88, 0.15915494, v88
    v_mfma_f32_16x16x32_bf16 v[224:227], v[136:139], v[48:51], v[224:227]
    v_mul_f32 v85, s35, v85
    v_mul_f32 v86, s35, v86
    v_mfma_f32_16x16x32_bf16 v[236:239], v[160:163], v[48:51], v[236:239]
    v_add_f32 v80, v80, v80
    v_lshlrev_b32 v104, 16, v125
    v_mfma_f32_16x16x32_bf16 v[236:239], v[164:167], v[52:55], v[236:239]
    ds_read_b128 v[48:51], v30 offset:4608
    s_waitcnt lgkmcnt(5)
    v_mfma_f32_16x16x32_bf16 v[212:215], v[148:151], v[56:59], v[212:215]
    ds_read_b128 v[52:55], v30 offset:4736
    v_and_b32 v105, s6, v125
    v_mfma_f32_16x16x32_bf16 v[212:215], v[144:147], v[60:63], v[212:215]
    v_lshlrev_b32 v106, 16, v126
    v_and_b32 v107, s6, v126
    v_mfma_f32_16x16x32_bf16 v[224:227], v[152:155], v[60:63], v[224:227]
    s_bitcmp1_b32 s3, 0
    s_cselect_b32 s34, 1.0, 0x41000000
    s_mov_b32 s35, 0x43800000
    v_mfma_f32_16x16x32_bf16 v[224:227], v[156:159], v[56:59], v[224:227]
    v_mul_f32 v104, v104, v80
    v_mul_f32_e64 v105, v105, v80
    v_mfma_f32_16x16x32_bf16 v[236:239], v[180:183], v[56:59], v[236:239]
    v_mul_f32 v106, v106, v80
    v_mul_f32 v107, v107, v80
    v_mfma_f32_16x16x32_bf16 v[236:239], v[176:179], v[60:63], v[236:239]
    ds_read_b128 v[56:59], v30 offset:5504
    s_waitcnt lgkmcnt(5)
    v_mfma_f32_16x16x32_bf16 v[212:215], v[136:139], v[64:67], v[212:215]
    ds_read_b128 v[60:63], v30 offset:5376
    v_mul_f32 v89, s34, v85
    v_mfma_f32_16x16x32_bf16 v[212:215], v[140:143], v[68:71], v[212:215]
    v_mul_f32 v90, s34, v86
    v_mul_f32 v98, s34, v87
    v_mfma_f32_16x16x32_bf16 v[224:227], v[148:151], v[68:71], v[224:227]
    v_mul_f32_e64 v99, s34, v88
    v_mfma_f32_16x16x32_bf16 v[224:227], v[144:147], v[64:67], v[224:227]
    v_exp_f32_e64 v89, -v89
    v_mfma_f32_16x16x32_bf16 v[236:239], v[168:171], v[64:67], v[236:239]
    v_exp_f32_e64 v90, -v90
    v_mfma_f32_16x16x32_bf16 v[236:239], v[172:175], v[68:71], v[236:239]
    ds_read_b128 v[64:67], v30 offset:4864
    s_waitcnt lgkmcnt(5)
    v_mfma_f32_16x16x32_bf16 v[218:221], v[132:135], v[76:79], v[218:221]
    ds_read_b128 v[68:71], v30 offset:4992
    v_fract_f32 v98, v98
    v_mfma_f32_16x16x32_bf16 v[218:221], v[128:131], v[72:75], v[218:221]
    v_fract_f32_e64 v99, v99
    v_mfma_f32_16x16x32_bf16 v[230:233], v[152:155], v[72:75], v[230:233]
    v_cos_f32_e64 v96, v98
    v_mfma_f32_16x16x32_bf16 v[230:233], v[156:159], v[76:79], v[230:233]
    ds_read_b128 v[72:75], v30 offset:5248
    s_waitcnt lgkmcnt(5)
    v_mfma_f32_16x16x32_bf16 v[194:197], v[128:131], v[52:55], v[194:197]
    ds_read_b128 v[76:79], v30 offset:5120
    v_mfma_f32_16x16x32_bf16 v[194:197], v[132:135], v[48:51], v[194:197]
    v_cos_f32 v97, v99
    v_mfma_f32_16x16x32_bf16 v[206:209], v[156:159], v[48:51], v[206:209]
    v_sin_f32_e64 v98, v98
    v_mfma_f32_16x16x32_bf16 v[206:209], v[152:155], v[52:55], v[206:209]
    v_sin_f32_e64 v99, v99
    v_mfma_f32_16x16x32_bf16 v[218:221], v[160:163], v[52:55], v[218:221]
    v_mul_f32 v96, v96, v89
    v_mul_f32 v97, v97, v90
    v_mfma_f32_16x16x32_bf16 v[218:221], v[164:167], v[48:51], v[218:221]
    v_mul_f32 v98, v98, v89
    v_mul_f32 v99, v99, v90
    v_mfma_f32_16x16x32_bf16 v[230:233], v[188:191], v[48:51], v[230:233]
    buffer_load_dword v18, v19, s[56:59], 0 offen sc1
    v_mfma_f32_16x16x32_bf16 v[230:233], v[184:187], v[52:55], v[230:233]
    v_mul_f32 v89, s35, v85
    s_waitcnt lgkmcnt(4)
    v_mfma_f32_16x16x32_bf16 v[206:209], v[128:131], v[56:59], v[206:209]
    v_mul_f32 v90, s35, v86
    v_mul_f32 v102, s35, v87
    v_mfma_f32_16x16x32_bf16 v[206:209], v[132:135], v[60:63], v[206:209]
    v_mul_f32_e64 v103, s35, v88
    v_mfma_f32_16x16x32_bf16 v[218:221], v[140:143], v[60:63], v[218:221]
    v_exp_f32_e64 v89, -v89
    v_mfma_f32_16x16x32_bf16 v[218:221], v[136:139], v[56:59], v[218:221]
    v_exp_f32_e64 v90, -v90
    v_mfma_f32_16x16x32_bf16 v[230:233], v[160:163], v[56:59], v[230:233]
    v_fract_f32 v102, v102
    v_fract_f32 v103, v103
    v_mfma_f32_16x16x32_bf16 v[230:233], v[164:167], v[60:63], v[230:233]
    s_waitcnt lgkmcnt(2)
    v_mfma_f32_16x16x32_bf16 v[206:209], v[148:151], v[64:67], v[206:209]
    v_cos_f32 v100, v102
    v_mfma_f32_16x16x32_bf16 v[206:209], v[144:147], v[68:71], v[206:209]
    v_cos_f32_e64 v101, v103
    v_mfma_f32_16x16x32_bf16 v[218:221], v[152:155], v[68:71], v[218:221]
    v_sin_f32_e64 v102, v102
    v_mfma_f32_16x16x32_bf16 v[218:221], v[156:159], v[64:67], v[218:221]
    v_sin_f32_e64 v103, v103
    v_mfma_f32_16x16x32_bf16 v[230:233], v[180:183], v[64:67], v[230:233]
    v_mul_f32 v100, v100, v89
    v_mul_f32 v101, v101, v90
    v_mfma_f32_16x16x32_bf16 v[230:233], v[176:179], v[68:71], v[230:233]
    v_mul_f32 v102, v102, v89
    s_waitcnt lgkmcnt(0)
    v_mfma_f32_16x16x32_bf16 v[206:209], v[136:139], v[72:75], v[206:209]
    v_mul_f32_e64 v103, v103, v90
    s_mul_i32 s34, s3, 16896
    v_mfma_f32_16x16x32_bf16 v[206:209], v[140:143], v[76:79], v[206:209]
    s_add_u32 s34, s34, 96256
    v_lshl_add_u32 v15, v0, 3, s34
    v_mfma_f32_16x16x32_bf16 v[218:221], v[148:151], v[76:79], v[218:221]
    v_mfma_f32_16x16x32_bf16 v[218:221], v[144:147], v[72:75], v[218:221]
    v_mfma_f32_16x16x32_bf16 v[230:233], v[168:171], v[72:75], v[230:233]
    v_mfma_f32_16x16x32_bf16 v[230:233], v[172:175], v[76:79], v[230:233]
    s_branch LS_finA
LS_h1A:
Lst_6196:
    s_cbranch_execz Lst_7063
    s_nop 0
    s_nop 0
    ds_read_b64_tr_b16 v[128:129], v29 offset:32
    ds_read_b64_tr_b16 v[130:131], v29 offset:0
    ds_read_b64_tr_b16 v[132:133], v29 offset:288
    ds_read_b64_tr_b16 v[134:135], v29 offset:256
    ds_read_b64_tr_b16 v[136:137], v29 offset:544
    ds_read_b64_tr_b16 v[138:139], v29 offset:512
    ds_read_b64_tr_b16 v[140:141], v29 offset:800
    ds_read_b64_tr_b16 v[142:143], v29 offset:768
    ds_read_b64_tr_b16 v[144:145], v29 offset:1056
    ds_read_b64_tr_b16 v[146:147], v29 offset:1024
    ds_read_b64_tr_b16 v[152:153], v29 offset:1568
    ds_read_b64_tr_b16 v[154:155], v29 offset:1536
    ds_read_b64_tr_b16 v[148:149], v29 offset:1312
    ds_read_b64_tr_b16 v[150:151], v29 offset:1280
    ds_read_b64_tr_b16 v[156:157], v29 offset:1824
    ds_read_b64_tr_b16 v[158:159], v29 offset:1792
    ds_read_b64_tr_b16 v[160:161], v29 offset:2080
    ds_read_b64_tr_b16 v[162:163], v29 offset:2048
    ds_read_b64_tr_b16 v[164:165], v29 offset:2336
    ds_read_b64_tr_b16 v[166:167], v29 offset:2304
    ds_read_b128 v[48:51], v30 offset:3968
    ds_read_b128 v[52:55], v30 offset:3840
    ds_read_b128 v[56:59], v30 offset:3712
    ds_read_b128 v[60:63], v30 offset:3584
    ds_read_b128 v[64:67], v30 offset:896
    ds_read_b128 v[68:71], v30 offset:768
    ds_read_b128 v[72:75], v30 offset:640
    ds_read_b128 v[76:79], v30 offset:512
    s_waitcnt lgkmcnt(6)
    v_mfma_f32_16x16x32_bf16 v[244:247], v[128:131], v[48:51], 0
    ds_read_b64_tr_b16 v[168:169], v29 offset:2592
    s_lshr_b32 s32, s3, 1
    v_mfma_f32_16x16x32_bf16 v[244:247], v[132:135], v[52:55], v[244:247]
    s_lshl_b32 s38, s15, 1
    ds_read_b64_tr_b16 v[170:171], v29 offset:2560
    s_waitcnt lgkmcnt(6)
    v_mfma_f32_16x16x32_bf16 v[240:243], v[132:135], v[60:63], 0
    s_add_u32 s38, s38, s32
    ds_read_b128 v[48:51], v30 offset:2688
    v_mov_b32 v214, 0
    v_mfma_f32_16x16x32_bf16 v[240:243], v[128:131], v[56:59], v[240:243]
    s_mul_i32 s38, s38, 4224
    ds_read_b64_tr_b16 v[172:173], v29 offset:2848
    v_mov_b32_e64 v215, 0
    v_mfma_f32_16x16x32_bf16 v[244:247], v[136:139], v[56:59], v[244:247]
    s_add_u32 s38, s38, 5259264
    ds_read_b64_tr_b16 v[174:175], v29 offset:2816
    v_mov_b32_e64 v202, 0
    v_mfma_f32_16x16x32_bf16 v[244:247], v[140:143], v[60:63], v[244:247]
    s_mul_i32 s32, s32, 8224
    ds_read_b128 v[52:55], v30 offset:2560
    s_waitcnt lgkmcnt(6)
    v_mfma_f32_16x16x32_bf16 v[216:219], v[148:151], v[68:71], 0
    s_and_b32 s33, s3, 1
    ds_read_b128 v[56:59], v30 offset:3456
    v_mov_b32_e64 v203, 0
    v_mfma_f32_16x16x32_bf16 v[216:219], v[144:147], v[64:67], v[216:219]
    s_lshl_b32 s33, s33, 10
    ds_read_b128 v[60:63], v30 offset:3328
    v_mov_b32 v220, v242
    v_mfma_f32_16x16x32_bf16 v[228:231], v[152:155], v[64:67], 0
    s_add_u32 s32, s32, s33
    ds_read_b64_tr_b16 v[176:177], v29 offset:3104
    v_mov_b32 v221, v243
    v_mfma_f32_16x16x32_bf16 v[228:231], v[156:159], v[68:71], v[228:231]
    s_lshl_b32 s8, s15, 5
    ds_read_b64_tr_b16 v[178:179], v29 offset:3072
    v_mfma_f32_16x16x32_bf16 v[204:207], v[128:131], v[72:75], 0
    s_mul_i32 s9, s3, 663552
    ds_read_b128 v[64:67], v30 offset:2432
    v_mov_b32 v232, v246
    v_mfma_f32_16x16x32_bf16 v[204:207], v[132:135], v[76:79], v[204:207]
    s_add_u32 s8, s8, s9
    ds_read_b64_tr_b16 v[180:181], v29 offset:3360
    v_mov_b32 v233, v247
    v_mfma_f32_16x16x32_bf16 v[216:219], v[156:159], v[76:79], v[216:219]
    s_add_u32 s8, s8, 393248
    ds_read_b64_tr_b16 v[182:183], v29 offset:3328
    v_mov_b32_e64 v238, v246
    v_mfma_f32_16x16x32_bf16 v[216:219], v[152:155], v[72:75], v[216:219]
    s_add_u32 s9, s8, 331776
    ds_read_b128 v[68:71], v30 offset:2304
    v_mov_b32_e64 v239, v247
    v_mfma_f32_16x16x32_bf16 v[228:231], v[160:163], v[72:75], v[228:231]
    s_add_u32 s32, s32, 75904
    v_add_f32 v246, v246, v244
    v_add_f32 v247, v247, v245
    v_mfma_f32_16x16x32_bf16 v[228:231], v[164:167], v[76:79], v[228:231]
    ds_read_b128 v[72:75], v30 offset:1664
    s_waitcnt lgkmcnt(6)
    v_mfma_f32_16x16x32_bf16 v[198:201], v[132:135], v[52:55], 0
    ds_read_b128 v[76:79], v30 offset:1536
    v_mov_b32 v226, v242
    v_mfma_f32_16x16x32_bf16 v[198:201], v[128:131], v[48:51], v[198:201]
    v_mov_b32 v227, v243
    v_add_f32 v242, v242, v240
    v_mfma_f32_16x16x32_bf16 v[210:213], v[136:139], v[48:51], v[204:207]
    v_add_f32 v243, v243, v241
    v_lshrrev_b32 v31, 1, v0
    v_mfma_f32_16x16x32_bf16 v[210:213], v[140:143], v[52:55], v[210:213]
    v_mul_u32_u24 v31, 10336, v31
    v_lshl_add_u32 v31, v0, 4, v31
    v_mfma_f32_16x16x32_bf16 v[222:225], v[164:167], v[52:55], v[216:219]
    buffer_load_dwordx4 a[248:251], v31, s[56:59], s8 offen sc1
    v_mfma_f32_16x16x32_bf16 v[222:225], v[160:163], v[48:51], v[222:225]
    v_add_u32 v4, 16, v0
    v_subrev_u32 v5, 47, v0
    v_mfma_f32_16x16x32_bf16 v[234:237], v[168:171], v[48:51], v[228:231]
    v_cmp_lt_u32 s[36:37], 47, v0
    v_lshl_add_u32 v6, v0, 4, s32
    v_mfma_f32_16x16x32_bf16 v[234:237], v[172:175], v[52:55], v[234:237]
    ds_read_b128 v[48:51], v30 offset:0
    v_mfma_f32_16x16x32_bf16 v[222:225], v[140:143], v[60:63], v[222:225]
    ds_read_b128 v[52:55], v30 offset:128
    v_and_b32_e64 v11, 15, v0
    v_mfma_f32_16x16x32_bf16 v[222:225], v[136:139], v[56:59], v[222:225]
    buffer_load_dwordx4 a[252:255], v31, s[56:59], s9 offen sc1
    v_mfma_f32_16x16x32_bf16 v[234:237], v[144:147], v[56:59], v[234:237]
    v_cndmask_b32 v4, v4, v5, s[36:37]
    v_cmp_eq_u32 s[36:37], 63, v0
    v_mfma_f32_16x16x32_bf16 v[234:237], v[148:151], v[60:63], v[234:237]
    ds_read_b128 v[56:59], v30 offset:1408
    s_waitcnt lgkmcnt(5)
    v_mfma_f32_16x16x32_bf16 v[198:201], v[140:143], v[68:71], v[198:201]
    ds_read_b128 v[60:63], v30 offset:1280
    v_lshlrev_b32 v11, 4, v11
    v_mfma_f32_16x16x32_bf16 v[198:201], v[136:139], v[64:67], v[198:201]
    v_and_b32_e64 v9, 12, v0
    v_lshl_add_u32 v11, v9, 4, v11
    v_mfma_f32_16x16x32_bf16 v[210:213], v[144:147], v[64:67], v[210:213]
    v_bfe_u32 v9, v0, 4, 1
    v_cndmask_b32 v4, v4, 64, s[36:37]
    v_mfma_f32_16x16x32_bf16 v[210:213], v[148:151], v[68:71], v[210:213]
    v_lshl_add_u32 v4, v4, 4, s32
    s_lshl_b32 s32, s33, 1
    v_mfma_f32_16x16x32_bf16 v[222:225], v[172:175], v[68:71], v[222:225]
    s_sub_u32 s32, 3072, s32
    v_add_u32 v5, s32, v4
    v_add_u32_e64 v7, s32, v6
    v_mfma_f32_16x16x32_bf16 v[222:225], v[168:171], v[64:67], v[222:225]
    v_lshl_add_u32 v11, v9, 11, v11
    v_lshrrev_b32_e64 v9, 5, v0
    v_mfma_f32_16x16x32_bf16 v[234:237], v[176:179], v[64:67], v[234:237]
    v_lshl_add_u32 v11, v9, 6, v11
    s_lshr_b32 s33, s33, 1
    v_mfma_f32_16x16x32_bf16 v[234:237], v[180:183], v[68:71], v[234:237]
    s_lshr_b32 s32, s32, 1
    ds_read_b128 v[64:67], v30 offset:256
    s_waitcnt lgkmcnt(5)
    v_mfma_f32_16x16x32_bf16 v[228:231], v[128:131], v[72:75], v[228:231]
    ds_read_b128 v[68:71], v30 offset:384
    v_add_u32 v11, s33, v11
    v_mfma_f32_16x16x32_bf16 v[228:231], v[132:135], v[76:79], v[228:231]
    ds_read_b128 v[72:75], v30 offset:1152
    s_waitcnt lgkmcnt(5)
    v_mfma_f32_16x16x32_bf16 v[192:195], v[136:139], v[52:55], 0
    ds_read_b128 v[76:79], v30 offset:1024
    v_add_f32 v222, v222, v240
    v_mfma_f32_16x16x32_bf16 v[192:195], v[140:143], v[48:51], v[192:195]
    v_add_f32 v234, v234, v244
    v_add_f32 v235, v235, v245
    v_mfma_f32_16x16x32_bf16 v[204:207], v[148:151], v[48:51], v[204:207]
    v_add_f32 v236, v236, v246
    v_add_f32 v237, v237, v247
    v_mfma_f32_16x16x32_bf16 v[204:207], v[144:147], v[52:55], v[204:207]
    v_add_f32 v223, v223, v241
    v_add_f32 v224, v224, v242
    v_mfma_f32_16x16x32_bf16 v[216:219], v[168:171], v[52:55], v[216:219]
    v_add_f32 v225, v225, v243
    v_add_u32 v12, s32, v11
    v_mfma_f32_16x16x32_bf16 v[216:219], v[172:175], v[48:51], v[216:219]
    s_mov_b32 s78, s74
    s_mov_b32 s79, s75
    s_lshr_b32 s34, s3, 1
    v_mfma_f32_16x16x32_bf16 v[228:231], v[180:183], v[48:51], v[228:231]
    s_lshl_b32 s34, s34, 4
    s_lshr_b32 s78, s78, s34
    s_lshl_b32 s78, s78, 16
    v_mfma_f32_16x16x32_bf16 v[228:231], v[176:179], v[52:55], v[228:231]
    s_lshr_b32 s79, s79, s34
    ds_read_b128 v[48:51], v30 offset:8064
    s_waitcnt lgkmcnt(5)
    v_mfma_f32_16x16x32_bf16 v[216:219], v[132:135], v[60:63], v[216:219]
    ds_read_b128 v[52:55], v30 offset:7936
    s_lshl_b32 s79, s79, 16
    v_mfma_f32_16x16x32_bf16 v[216:219], v[128:131], v[56:59], v[216:219]
    s_mov_b32 s35, 0x3fb8aa3b
    v_mov_b32 v80, s78
    v_lshlrev_b32_e64 v85, 16, v123
    v_mfma_f32_16x16x32_bf16 v[228:231], v[136:139], v[56:59], v[228:231]
    v_and_b32 v86, s6, v123
    v_mul_f32 v80, s35, v80
    v_mfma_f32_16x16x32_bf16 v[228:231], v[140:143], v[60:63], v[228:231]
    ds_read_b128 v[56:59], v30 offset:6912
    s_waitcnt lgkmcnt(5)
    v_mfma_f32_16x16x32_bf16 v[192:195], v[128:131], v[68:71], v[192:195]
    ds_read_b128 v[60:63], v30 offset:7040
    v_mul_f32 v85, s35, v85
    v_mfma_f32_16x16x32_bf16 v[192:195], v[132:135], v[64:67], v[192:195]
    v_mul_f32_e64 v86, s35, v86
    v_mfma_f32_16x16x32_bf16 v[204:207], v[140:143], v[64:67], v[204:207]
    v_exp_f32_e64 v80, v80
    v_mfma_f32_16x16x32_bf16 v[204:207], v[136:139], v[68:71], v[204:207]
    v_exp_f32_e64 v85, v85
    v_mfma_f32_16x16x32_bf16 v[216:219], v[160:163], v[68:71], v[216:219]
    v_exp_f32_e64 v86, v86
    v_mfma_f32_16x16x32_bf16 v[216:219], v[164:167], v[64:67], v[216:219]
    v_lshlrev_b32 v87, 16, v124
    v_and_b32 v88, s6, v124
    v_mfma_f32_16x16x32_bf16 v[228:231], v[172:175], v[64:67], v[228:231]
    v_cvt_pk_bf16_f32 v80, v80, v80
    v_cvt_pk_bf16_f32 v86, v85, v86
    v_mfma_f32_16x16x32_bf16 v[228:231], v[168:171], v[68:71], v[228:231]
    ds_read_b128 v[64:67], v30 offset:7808
    s_waitcnt lgkmcnt(5)
    v_mfma_f32_16x16x32_bf16 v[216:219], v[140:143], v[76:79], v[216:219]
    ds_read_b128 v[68:71], v30 offset:7680
    v_lshlrev_b32 v80, 16, v80
    v_mfma_f32_16x16x32_bf16 v[216:219], v[136:139], v[72:75], v[216:219]
    v_lshlrev_b32 v85, 16, v86
    v_and_b32 v86, s6, v86
    v_mfma_f32_16x16x32_bf16 v[228:231], v[144:147], v[72:75], v[228:231]
    v_mul_f32 v87, v87, v80
    v_mul_f32 v88, v88, v80
    v_mfma_f32_16x16x32_bf16 v[228:231], v[148:151], v[76:79], v[228:231]
    ds_read_b128 v[72:75], v30 offset:7168
    s_waitcnt lgkmcnt(5)
    v_mfma_f32_16x16x32_bf16 v[224:227], v[140:143], v[52:55], v[224:227]
    ds_read_b128 v[76:79], v30 offset:7296
    v_mov_b32 v208, 0
    v_mfma_f32_16x16x32_bf16 v[224:227], v[136:139], v[48:51], v[224:227]
    v_add_f32 v218, v218, v240
    v_add_f32 v219, v219, v241
    v_mfma_f32_16x16x32_bf16 v[236:239], v[144:147], v[48:51], v[236:239]
    v_mov_b32 v209, 0
    v_mov_b32 v196, 0
    v_mfma_f32_16x16x32_bf16 v[236:239], v[148:151], v[52:55], v[236:239]
    ds_read_b128 v[48:51], v30 offset:7552
    s_waitcnt lgkmcnt(5)
    v_mfma_f32_16x16x32_bf16 v[200:203], v[136:139], v[60:63], v[200:203]
    ds_read_b128 v[52:55], v30 offset:7424
    v_add_f32 v230, v230, v244
    v_mfma_f32_16x16x32_bf16 v[200:203], v[140:143], v[56:59], v[200:203]
    v_add_f32 v231, v231, v245
    v_mov_b32 v197, 0
    v_mfma_f32_16x16x32_bf16 v[212:215], v[148:151], v[56:59], v[212:215]
    v_mul_f32 v85, v85, v80
    v_mul_f32 v86, v86, v80
    v_mfma_f32_16x16x32_bf16 v[212:215], v[144:147], v[60:63], v[212:215]
    v_mul_f32 v87, 0.15915494, v87
    v_mul_f32 v88, 0.15915494, v88
    v_mfma_f32_16x16x32_bf16 v[224:227], v[168:171], v[60:63], v[224:227]
    v_mul_f32 v85, s35, v85
    v_mul_f32 v86, s35, v86
    v_mfma_f32_16x16x32_bf16 v[224:227], v[172:175], v[56:59], v[224:227]
Lst_6455:
    s_cbranch_execz Lst_7348
    s_nop 0
    v_add_f32 v80, v80, v80
    v_lshlrev_b32 v104, 16, v125
    v_mfma_f32_16x16x32_bf16 v[236:239], v[180:183], v[56:59], v[236:239]
    v_and_b32 v105, s6, v125
    v_lshlrev_b32 v106, 16, v126
    v_mfma_f32_16x16x32_bf16 v[236:239], v[176:179], v[60:63], v[236:239]
    ds_read_b128 v[56:59], v30 offset:5760
    s_waitcnt lgkmcnt(5)
    v_mfma_f32_16x16x32_bf16 v[224:227], v[148:151], v[68:71], v[224:227]
    ds_read_b128 v[60:63], v30 offset:5632
    v_and_b32 v107, s6, v126
    v_mfma_f32_16x16x32_bf16 v[224:227], v[144:147], v[64:67], v[224:227]
    s_bitcmp1_b32 s3, 0
    s_cselect_b32 s34, 1.0, 0x41000000
    s_mov_b32 s35, 0x43800000
    v_mfma_f32_16x16x32_bf16 v[236:239], v[152:155], v[64:67], v[236:239]
    v_mul_f32 v104, v104, v80
    v_mul_f32_e64 v105, v105, v80
    v_mfma_f32_16x16x32_bf16 v[236:239], v[156:159], v[68:71], v[236:239]
    ds_read_b128 v[64:67], v30 offset:4608
    s_waitcnt lgkmcnt(5)
    v_mfma_f32_16x16x32_bf16 v[200:203], v[128:131], v[76:79], v[200:203]
    ds_read_b128 v[68:71], v30 offset:4736
    v_mul_f32 v106, v106, v80
    v_mfma_f32_16x16x32_bf16 v[200:203], v[132:135], v[72:75], v[200:203]
    v_mul_f32 v107, v107, v80
    v_mul_f32 v89, s34, v85
    v_mfma_f32_16x16x32_bf16 v[212:215], v[140:143], v[72:75], v[212:215]
    v_mul_f32 v90, s34, v86
    v_mul_f32 v98, s34, v87
    v_mfma_f32_16x16x32_bf16 v[212:215], v[136:139], v[76:79], v[212:215]
    v_mul_f32_e64 v99, s34, v88
    v_mfma_f32_16x16x32_bf16 v[224:227], v[160:163], v[76:79], v[224:227]
    v_exp_f32_e64 v89, -v89
    v_mfma_f32_16x16x32_bf16 v[224:227], v[164:167], v[72:75], v[224:227]
    v_exp_f32_e64 v90, -v90
    v_mfma_f32_16x16x32_bf16 v[236:239], v[172:175], v[72:75], v[236:239]
    v_fract_f32 v98, v98
    v_fract_f32 v99, v99
    v_mfma_f32_16x16x32_bf16 v[236:239], v[168:171], v[76:79], v[236:239]
    ds_read_b128 v[72:75], v30 offset:5504
    s_waitcnt lgkmcnt(5)
    v_mfma_f32_16x16x32_bf16 v[212:215], v[128:131], v[48:51], v[212:215]
    ds_read_b128 v[76:79], v30 offset:5376
    v_mfma_f32_16x16x32_bf16 v[212:215], v[132:135], v[52:55], v[212:215]
    v_cos_f32 v96, v98
    v_mfma_f32_16x16x32_bf16 v[224:227], v[156:159], v[52:55], v[224:227]
    v_cos_f32_e64 v97, v99
    v_mfma_f32_16x16x32_bf16 v[224:227], v[152:155], v[48:51], v[224:227]
    v_sin_f32_e64 v98, v98
    v_mfma_f32_16x16x32_bf16 v[236:239], v[160:163], v[48:51], v[236:239]
    v_sin_f32_e64 v99, v99
    v_mfma_f32_16x16x32_bf16 v[236:239], v[164:167], v[52:55], v[236:239]
    ds_read_b128 v[48:51], v30 offset:4864
    s_waitcnt lgkmcnt(5)
    v_mfma_f32_16x16x32_bf16 v[218:221], v[140:143], v[60:63], v[218:221]
    ds_read_b128 v[52:55], v30 offset:4992
    v_mul_f32 v96, v96, v89
    v_mfma_f32_16x16x32_bf16 v[218:221], v[136:139], v[56:59], v[218:221]
    v_mul_f32 v97, v97, v90
    v_mul_f32 v98, v98, v89
    v_mfma_f32_16x16x32_bf16 v[230:233], v[144:147], v[56:59], v[230:233]
    v_mul_f32 v99, v99, v90
    v_mul_f32 v89, s35, v85
    v_mfma_f32_16x16x32_bf16 v[230:233], v[148:151], v[60:63], v[230:233]
    ds_read_b128 v[56:59], v30 offset:5248
    s_waitcnt lgkmcnt(5)
    v_mfma_f32_16x16x32_bf16 v[194:197], v[136:139], v[68:71], v[194:197]
    ds_read_b128 v[60:63], v30 offset:5120
    v_mul_f32 v90, s35, v86
    v_mfma_f32_16x16x32_bf16 v[194:197], v[140:143], v[64:67], v[194:197]
    v_mul_f32 v102, s35, v87
    v_mul_f32 v103, s35, v88
    v_mfma_f32_16x16x32_bf16 v[206:209], v[148:151], v[64:67], v[206:209]
    v_exp_f32_e64 v89, -v89
    v_mfma_f32_16x16x32_bf16 v[206:209], v[144:147], v[68:71], v[206:209]
    v_exp_f32_e64 v90, -v90
    v_mfma_f32_16x16x32_bf16 v[218:221], v[168:171], v[68:71], v[218:221]
    buffer_load_dword v18, v19, s[56:59], 0 offen sc1
    v_mfma_f32_16x16x32_bf16 v[218:221], v[172:175], v[64:67], v[218:221]
    v_fract_f32 v102, v102
    v_fract_f32 v103, v103
    v_mfma_f32_16x16x32_bf16 v[230:233], v[180:183], v[64:67], v[230:233]
    v_cos_f32_e64 v100, v102
    v_mfma_f32_16x16x32_bf16 v[230:233], v[176:179], v[68:71], v[230:233]
    s_waitcnt lgkmcnt(4)
    v_mfma_f32_16x16x32_bf16 v[218:221], v[148:151], v[76:79], v[218:221]
    v_cos_f32 v101, v103
    v_mfma_f32_16x16x32_bf16 v[218:221], v[144:147], v[72:75], v[218:221]
    v_sin_f32_e64 v102, v102
    v_mfma_f32_16x16x32_bf16 v[230:233], v[152:155], v[72:75], v[230:233]
    v_sin_f32_e64 v103, v103
    v_mfma_f32_16x16x32_bf16 v[230:233], v[156:159], v[76:79], v[230:233]
    v_mul_f32 v100, v100, v89
    s_waitcnt lgkmcnt(2)
    v_mfma_f32_16x16x32_bf16 v[194:197], v[128:131], v[52:55], v[194:197]
    v_mul_f32 v101, v101, v90
    v_mul_f32 v102, v102, v89
    v_mfma_f32_16x16x32_bf16 v[194:197], v[132:135], v[48:51], v[194:197]
    v_mul_f32_e64 v103, v103, v90
    s_mul_i32 s34, s3, 16896
    v_mfma_f32_16x16x32_bf16 v[206:209], v[140:143], v[48:51], v[206:209]
    s_add_u32 s34, s34, 96256
    v_lshl_add_u32 v15, v0, 3, s34
    v_mfma_f32_16x16x32_bf16 v[206:209], v[136:139], v[52:55], v[206:209]
    v_mfma_f32_16x16x32_bf16 v[218:221], v[160:163], v[52:55], v[218:221]
    v_mfma_f32_16x16x32_bf16 v[218:221], v[164:167], v[48:51], v[218:221]
    v_mfma_f32_16x16x32_bf16 v[230:233], v[172:175], v[48:51], v[230:233]
    v_mfma_f32_16x16x32_bf16 v[230:233], v[168:171], v[52:55], v[230:233]
    s_waitcnt lgkmcnt(0)
    v_mfma_f32_16x16x32_bf16 v[206:209], v[128:131], v[56:59], v[206:209]
    v_mfma_f32_16x16x32_bf16 v[206:209], v[132:135], v[60:63], v[206:209]
    v_mfma_f32_16x16x32_bf16 v[218:221], v[156:159], v[60:63], v[218:221]
    v_mfma_f32_16x16x32_bf16 v[218:221], v[152:155], v[56:59], v[218:221]
    v_mfma_f32_16x16x32_bf16 v[230:233], v[160:163], v[56:59], v[230:233]
    v_mfma_f32_16x16x32_bf16 v[230:233], v[164:167], v[60:63], v[230:233]
LS_finA:
Lst_6574:
    s_cbranch_execz Lst_2565
    s_nop 0
    s_nop 7
    v_add_f32 v201, v201, v196
    v_add_f32 v202, v202, v197
    ds_write_b128 v4, v[200:203] offset:0
    v_add_f32 v213, v213, v208
    v_add_f32 v214, v214, v209
    ds_write_b128 v5, v[212:215] offset:0
    v_add_f32 v225, v225, v220
    v_add_f32 v226, v226, v221
    ds_write_b128 v4, v[224:227] offset:4096
    v_add_f32 v237, v237, v232
    v_add_f32 v238, v238, v233
    ds_write_b128 v5, v[236:239] offset:4096
    v_add_f32 v193, v193, v198
    v_add_f32 v194, v194, v199
    v_add_f32 v195, v195, v200
    v_add_f32 v205, v205, v210
    v_add_f32 v206, v206, v211
    v_add_f32 v207, v207, v212
    v_add_f32 v217, v217, v222
    v_add_f32 v218, v218, v223
    v_add_f32 v219, v219, v224
    v_add_f32 v229, v229, v234
    v_add_f32 v230, v230, v235
    v_add_f32 v231, v231, v236
    s_waitcnt lgkmcnt(0)
    s_barrier
    ds_read_b128 v[48:51], v6 offset:0
    ds_read_b128 v[56:59], v6 offset:4096
    ds_read_b128 v[52:55], v7 offset:0
    ds_read_b128 v[60:63], v7 offset:4096
    s_waitcnt vmcnt(1)
    ds_write_b128 v26, a[248:251]
    ds_write_b128 v26, a[252:255] offset:512
    s_waitcnt lgkmcnt(3)
    v_add_f32 v192, v192, v49
    v_add_f32 v193, v193, v50
    v_add_f32_e64 v194, v194, v51
    v_cvt_pk_bf16_f32 v64, v192, v193
    v_cvt_pk_bf16_f32 v65, v194, v195
    s_waitcnt lgkmcnt(2)
    v_add_f32 v216, v216, v57
    v_add_f32 v217, v217, v58
    v_add_f32 v218, v218, v59
    v_cvt_pk_bf16_f32 v66, v216, v217
    v_cvt_pk_bf16_f32 v67, v218, v219
    s_nop 0
    v_permlane16_swap_b32 v64, v66
    v_permlane16_swap_b32 v65, v67
    buffer_store_dwordx4 v[64:67], v11, s[56:59], s38 offen sc1
    s_waitcnt lgkmcnt(1)
    v_add_f32 v204, v204, v53
    v_add_f32 v205, v205, v54
    v_add_f32_e64 v206, v206, v55
    v_cvt_pk_bf16_f32 v68, v204, v205
    v_cvt_pk_bf16_f32 v69, v206, v207
    s_waitcnt lgkmcnt(0)
    v_add_f32 v228, v228, v61
    v_add_f32 v229, v229, v62
    v_add_f32 v230, v230, v63
    v_cvt_pk_bf16_f32 v70, v228, v229
    v_cvt_pk_bf16_f32 v71, v230, v231
    s_nop 0
    v_permlane16_swap_b32 v68, v70
    v_permlane16_swap_b32 v69, v71
    buffer_store_dwordx4 v[68:71], v12, s[56:59], s38 offen sc1
    s_add_u32 s15, s15, 1
    s_waitcnt vmcnt(2)
    v_cmp_ne_u32_e64 vcc, s7, v18
    s_cbranch_vccnz Lslow_20
Lback_21:
    s_cmp_eq_u32 s101, 2
    s_cbranch_scc1 LS_sp
    ds_write2st64_b32 v27, v32, v33 offset0:0 offset1:9
    ds_write2st64_b32 v27, v34, v35 offset0:18 offset1:27
    ds_write2st64_b32 v27, v36, v36 offset0:2 offset1:11
    ds_write2st64_b32 v27, v37, v38 offset0:20 offset1:29
    ds_write2st64_b32 v28, v39, v40 offset0:4 offset1:13
    ds_write2st64_b32 v28, v40, v40 offset0:22 offset1:31
    ds_write2st64_b32 v28, v41, v42 offset0:5 offset1:14
    ds_write2st64_b32 v28, v42, v42 offset0:23 offset1:32
    s_waitcnt lgkmcnt(0)
    s_barrier
    s_bitcmp1_b32 s3, 0
    s_cbranch_scc1 LS_h1B
    ds_read_b64_tr_b16 v[128:129], v29 offset:32
    ds_read_b64_tr_b16 v[130:131], v29 offset:0
    ds_read_b64_tr_b16 v[132:133], v29 offset:288
    ds_read_b64_tr_b16 v[134:135], v29 offset:256
    ds_read_b64_tr_b16 v[136:137], v29 offset:544
    ds_read_b64_tr_b16 v[138:139], v29 offset:512
    ds_read_b64_tr_b16 v[140:141], v29 offset:800
    ds_read_b64_tr_b16 v[142:143], v29 offset:768
    ds_read_b64_tr_b16 v[144:145], v29 offset:1056
    ds_read_b64_tr_b16 v[146:147], v29 offset:1024
    ds_read_b64_tr_b16 v[148:149], v29 offset:1312
    ds_read_b64_tr_b16 v[150:151], v29 offset:1280
    ds_read_b64_tr_b16 v[160:161], v29 offset:2080
    ds_read_b64_tr_b16 v[162:163], v29 offset:2048
    ds_read_b64_tr_b16 v[164:165], v29 offset:2336
    ds_read_b64_tr_b16 v[166:167], v29 offset:2304
    ds_read_b128 v[48:51], v30 offset:4224
    ds_read_b128 v[52:55], v30 offset:4096
    ds_read_b128 v[56:59], v30 offset:3968
    ds_read_b128 v[60:63], v30 offset:3840
    ds_read_b128 v[64:67], v30 offset:3712
    ds_read_b128 v[68:71], v30 offset:3584
    ds_read_b128 v[72:75], v30 offset:896
    ds_read_b128 v[76:79], v30 offset:768
    s_waitcnt lgkmcnt(6)
    v_mfma_f32_16x16x32_bf16 v[240:243], v[128:131], v[48:51], 0
    ds_read_b64_tr_b16 v[168:169], v29 offset:2592
    s_lshr_b32 s32, s3, 1
    v_mfma_f32_16x16x32_bf16 v[240:243], v[132:135], v[52:55], v[240:243]
    s_lshl_b32 s38, s15, 1
    ds_read_b64_tr_b16 v[170:171], v29 offset:2560
    s_waitcnt lgkmcnt(6)
    v_mfma_f32_16x16x32_bf16 v[240:243], v[136:139], v[56:59], v[240:243]
    s_add_u32 s38, s38, s32
    ds_read_b128 v[48:51], v30 offset:640
    v_mov_b32 v226, 0
    v_mfma_f32_16x16x32_bf16 v[240:243], v[140:143], v[60:63], v[240:243]
    s_mul_i32 s38, s38, 4224
    ds_read_b64_tr_b16 v[172:173], v29 offset:2848
    s_waitcnt lgkmcnt(6)
    v_mfma_f32_16x16x32_bf16 v[240:243], v[144:147], v[64:67], v[240:243]
    s_add_u32 s38, s38, 5259264
    ds_read_b64_tr_b16 v[174:175], v29 offset:2816
    v_mov_b32 v227, 0
    v_mfma_f32_16x16x32_bf16 v[240:243], v[148:151], v[68:71], v[240:243]
    s_mul_i32 s32, s32, 8224
    ds_read_b128 v[52:55], v30 offset:512
    s_waitcnt lgkmcnt(6)
    v_mfma_f32_16x16x32_bf16 v[204:207], v[128:131], v[72:75], 0
    s_and_b32 s33, s3, 1
    ds_read_b64_tr_b16 v[152:153], v29 offset:1568
    v_mov_b32_e64 v214, 0
    v_mfma_f32_16x16x32_bf16 v[204:207], v[132:135], v[76:79], v[204:207]
    s_lshl_b32 s33, s33, 10
    ds_read_b64_tr_b16 v[154:155], v29 offset:1536
    v_mov_b32 v215, 0
    v_mfma_f32_16x16x32_bf16 v[216:219], v[140:143], v[76:79], 0
    s_add_u32 s32, s32, s33
    ds_read_b64_tr_b16 v[176:177], v29 offset:3104
    v_mov_b32 v202, 0
    v_mfma_f32_16x16x32_bf16 v[216:219], v[136:139], v[72:75], v[216:219]
    s_lshl_b32 s8, s15, 5
    ds_read_b64_tr_b16 v[178:179], v29 offset:3072
    v_mov_b32 v232, v242
    v_mfma_f32_16x16x32_bf16 v[228:231], v[160:163], v[72:75], 0
    s_mul_i32 s9, s3, 663552
    ds_read_b128 v[56:59], v30 offset:2688
    v_mov_b32_e64 v233, v243
    v_mfma_f32_16x16x32_bf16 v[228:231], v[164:167], v[76:79], v[228:231]
    s_add_u32 s8, s8, s9
    ds_read_b64_tr_b16 v[156:157], v29 offset:1824
    s_waitcnt lgkmcnt(6)
    v_mfma_f32_16x16x32_bf16 v[204:207], v[136:139], v[48:51], v[204:207]
    s_add_u32 s8, s8, 393248
    ds_read_b64_tr_b16 v[158:159], v29 offset:1792
    v_mov_b32_e64 v238, v242
    v_mfma_f32_16x16x32_bf16 v[204:207], v[140:143], v[52:55], v[204:207]
    s_add_u32 s9, s8, 331776
    ds_read_b64_tr_b16 v[180:181], v29 offset:3360
    v_mov_b32_e64 v239, v243
    v_mfma_f32_16x16x32_bf16 v[216:219], v[148:151], v[52:55], v[216:219]
    s_add_u32 s32, s32, 75904
    ds_read_b64_tr_b16 v[182:183], v29 offset:3328
    v_add_f32_e64 v242, v242, v240
    v_mfma_f32_16x16x32_bf16 v[216:219], v[144:147], v[48:51], v[216:219]
    ds_read_b128 v[60:63], v30 offset:2560
    v_add_f32_e64 v243, v243, v241
    v_mfma_f32_16x16x32_bf16 v[228:231], v[168:171], v[48:51], v[228:231]
    ds_read_b128 v[64:67], v30 offset:3456
    v_mov_b32_e64 v203, 0
    v_mfma_f32_16x16x32_bf16 v[228:231], v[172:175], v[52:55], v[228:231]
    ds_read_b128 v[68:71], v30 offset:3328
    s_waitcnt lgkmcnt(2)
    v_mfma_f32_16x16x32_bf16 v[210:213], v[144:147], v[56:59], v[204:207]
    ds_read_b64_tr_b16 v[184:185], v29 offset:3616
    v_lshrrev_b32 v31, 1, v0
    v_mfma_f32_16x16x32_bf16 v[210:213], v[148:151], v[60:63], v[210:213]
    ds_read_b64_tr_b16 v[186:187], v29 offset:3584
    v_mul_u32_u24 v31, 10336, v31
    v_mfma_f32_16x16x32_bf16 v[222:225], v[156:159], v[60:63], v[216:219]
    ds_read_b128 v[72:75], v30 offset:2432
    v_lshl_add_u32 v31, v0, 4, v31
    v_mfma_f32_16x16x32_bf16 v[222:225], v[152:155], v[56:59], v[222:225]
    ds_read_b64_tr_b16 v[188:189], v29 offset:3872
    v_add_u32_e64 v4, 16, v0
    v_mfma_f32_16x16x32_bf16 v[234:237], v[176:179], v[56:59], v[228:231]
    ds_read_b64_tr_b16 v[190:191], v29 offset:3840
    v_subrev_u32_e64 v5, 47, v0
    v_mfma_f32_16x16x32_bf16 v[234:237], v[180:183], v[60:63], v[234:237]
    ds_read_b128 v[76:79], v30 offset:2304
    s_waitcnt lgkmcnt(6)
    v_mfma_f32_16x16x32_bf16 v[222:225], v[132:135], v[68:71], v[222:225]
    ds_read_b128 v[48:51], v30 offset:1920
    v_cmp_lt_u32 s[36:37], 47, v0
    v_mfma_f32_16x16x32_bf16 v[222:225], v[128:131], v[64:67], v[222:225]
    ds_read_b128 v[52:55], v30 offset:1792
    v_lshl_add_u32 v6, v0, 4, s32
    v_mfma_f32_16x16x32_bf16 v[234:237], v[152:155], v[64:67], v[234:237]
    ds_read_b128 v[56:59], v30 offset:0
    v_and_b32 v11, 15, v0
    v_mfma_f32_16x16x32_bf16 v[234:237], v[156:159], v[68:71], v[234:237]
    ds_read_b128 v[60:63], v30 offset:128
    s_waitcnt lgkmcnt(4)
    v_mfma_f32_16x16x32_bf16 v[198:201], v[132:135], v[76:79], 0
    ds_read_b128 v[64:67], v30 offset:1664
    v_cndmask_b32 v4, v4, v5, s[36:37]
    v_mfma_f32_16x16x32_bf16 v[198:201], v[128:131], v[72:75], v[198:201]
    ds_read_b128 v[68:71], v30 offset:1536
    v_cmp_eq_u32 s[36:37], 63, v0
    v_mfma_f32_16x16x32_bf16 v[210:213], v[152:155], v[72:75], v[210:213]
    buffer_load_dwordx4 a[248:251], v31, s[56:59], s8 offen sc1
    v_mfma_f32_16x16x32_bf16 v[210:213], v[156:159], v[76:79], v[210:213]
    v_lshlrev_b32 v11, 4, v11
    v_and_b32_e64 v9, 12, v0
    v_mfma_f32_16x16x32_bf16 v[222:225], v[164:167], v[76:79], v[222:225]
    v_lshl_add_u32 v11, v9, 4, v11
    v_bfe_u32 v9, v0, 4, 1
    v_mfma_f32_16x16x32_bf16 v[222:225], v[160:163], v[72:75], v[222:225]
    v_cndmask_b32 v4, v4, 64, s[36:37]
    v_lshl_add_u32 v4, v4, 4, s32
    v_mfma_f32_16x16x32_bf16 v[234:237], v[184:187], v[72:75], v[234:237]
    buffer_load_dwordx4 a[252:255], v31, s[56:59], s9 offen sc1
    v_mfma_f32_16x16x32_bf16 v[234:237], v[188:191], v[76:79], v[234:237]
    s_mul_i32 s85, s16, 5
    ds_read_b128 v[72:75], v30 offset:256
    s_waitcnt lgkmcnt(5)
    v_mfma_f32_16x16x32_bf16 v[228:231], v[128:131], v[48:51], v[228:231]
    s_lshl_b32 s32, s33, 1
    ds_read_b128 v[76:79], v30 offset:384
    s_add_u32 s85, s85, s83
    v_mfma_f32_16x16x32_bf16 v[228:231], v[132:135], v[52:55], v[228:231]
    s_sub_u32 s32, 3072, s32
    ds_read_b128 v[48:51], v30 offset:1408
    s_waitcnt lgkmcnt(5)
    v_mfma_f32_16x16x32_bf16 v[192:195], v[128:131], v[60:63], 0
    ds_read_b128 v[52:55], v30 offset:1280
    v_add_u32 v5, s32, v4
    v_mfma_f32_16x16x32_bf16 v[192:195], v[132:135], v[56:59], v[192:195]
    v_add_f32 v234, v234, v240
    v_add_f32 v235, v235, v241
    v_mfma_f32_16x16x32_bf16 v[204:207], v[156:159], v[56:59], v[204:207]
    v_add_f32 v236, v236, v242
    v_add_f32 v237, v237, v243
    v_mfma_f32_16x16x32_bf16 v[204:207], v[152:155], v[60:63], v[204:207]
    buffer_load_dwordx4 a[0:3], v1, s[56:59], s85 offen offset:0 sc1
    v_mfma_f32_16x16x32_bf16 v[216:219], v[160:163], v[60:63], v[216:219]
    v_add_u32_e64 v7, s32, v6
    v_lshl_add_u32 v11, v9, 11, v11
    v_mfma_f32_16x16x32_bf16 v[216:219], v[164:167], v[56:59], v[216:219]
    buffer_load_dwordx4 a[4:7], v1, s[56:59], s85 offen offset:1024 sc1
    v_mfma_f32_16x16x32_bf16 v[228:231], v[188:191], v[56:59], v[228:231]
    v_lshrrev_b32_e64 v9, 5, v0
    v_lshl_add_u32 v11, v9, 6, v11
    v_mfma_f32_16x16x32_bf16 v[228:231], v[184:187], v[60:63], v[228:231]
    s_lshr_b32 s33, s33, 1
    ds_read_b128 v[56:59], v30 offset:1024
    s_waitcnt lgkmcnt(5)
    v_mfma_f32_16x16x32_bf16 v[228:231], v[136:139], v[64:67], v[228:231]
    ds_read_b128 v[60:63], v30 offset:1152
    s_lshr_b32 s32, s32, 1
    v_mfma_f32_16x16x32_bf16 v[228:231], v[140:143], v[68:71], v[228:231]
    ds_read_b128 v[64:67], v30 offset:8064
    s_waitcnt lgkmcnt(5)
    v_mfma_f32_16x16x32_bf16 v[204:207], v[148:151], v[72:75], v[204:207]
    ds_read_b128 v[68:71], v30 offset:7936
    v_add_u32_e64 v11, s33, v11
    v_mfma_f32_16x16x32_bf16 v[204:207], v[144:147], v[76:79], v[204:207]
    buffer_load_dwordx4 a[8:11], v1, s[56:59], s85 offen offset:2048 sc1
    v_mfma_f32_16x16x32_bf16 v[216:219], v[152:155], v[76:79], v[216:219]
    v_add_u32 v12, s32, v11
    v_mov_b32 v32, v96
    v_mfma_f32_16x16x32_bf16 v[216:219], v[156:159], v[72:75], v[216:219]
    v_mov_b32 v33, v97
    v_mov_b32 v34, v98
    v_mfma_f32_16x16x32_bf16 v[228:231], v[180:183], v[72:75], v[228:231]
    buffer_load_dwordx4 a[12:15], v1, s[56:59], s85 offen offset:3072 sc1
    v_mfma_f32_16x16x32_bf16 v[228:231], v[176:179], v[76:79], v[228:231]
    s_add_u32 s85, s85, 4096
    ds_read_b128 v[72:75], v30 offset:6912
    s_waitcnt lgkmcnt(5)
    v_mfma_f32_16x16x32_bf16 v[228:231], v[144:147], v[48:51], v[228:231]
    ds_read_b128 v[76:79], v30 offset:7040
    v_mov_b32 v35, v99
    v_mfma_f32_16x16x32_bf16 v[228:231], v[148:151], v[52:55], v[228:231]
    ds_read_b128 v[48:51], v30 offset:7808
    s_waitcnt lgkmcnt(5)
    v_mfma_f32_16x16x32_bf16 v[216:219], v[128:131], v[60:63], v[216:219]
    ds_read_b128 v[52:55], v30 offset:7680
    v_mov_b32 v36, v100
    v_mfma_f32_16x16x32_bf16 v[216:219], v[132:135], v[56:59], v[216:219]
    buffer_load_dwordx4 a[16:19], v1, s[56:59], s85 offen offset:0 sc1
    v_mfma_f32_16x16x32_bf16 v[228:231], v[156:159], v[56:59], v[228:231]
    s_mul_i32 s85, s17, 5
    s_add_u32 s85, s85, s83
    v_mov_b32_e64 v37, v101
    v_mfma_f32_16x16x32_bf16 v[228:231], v[152:155], v[60:63], v[228:231]
    ds_read_b128 v[56:59], v30 offset:7168
    s_waitcnt lgkmcnt(5)
    v_mfma_f32_16x16x32_bf16 v[224:227], v[132:135], v[68:71], v[224:227]
    ds_read_b128 v[60:63], v30 offset:7296
    v_mov_b32 v220, 0
    v_mfma_f32_16x16x32_bf16 v[224:227], v[128:131], v[64:67], v[224:227]
    v_mov_b32 v221, 0
    v_mov_b32 v208, 0
    v_mfma_f32_16x16x32_bf16 v[236:239], v[152:155], v[64:67], v[236:239]
    v_mov_b32 v209, 0
    v_mov_b32 v196, 0
    v_mfma_f32_16x16x32_bf16 v[236:239], v[156:159], v[68:71], v[236:239]
    ds_read_b128 v[64:67], v30 offset:7552
    s_waitcnt lgkmcnt(5)
    v_mfma_f32_16x16x32_bf16 v[200:203], v[128:131], v[76:79], v[200:203]
    ds_read_b128 v[68:71], v30 offset:7424
    v_add_f32 v230, v230, v240
    v_mfma_f32_16x16x32_bf16 v[200:203], v[132:135], v[72:75], v[200:203]
    v_add_f32 v231, v231, v241
    v_mov_b32 v197, 0
    v_mfma_f32_16x16x32_bf16 v[212:215], v[156:159], v[72:75], v[212:215]
    buffer_load_dwordx4 a[20:23], v1, s[56:59], s85 offen offset:0 sc1
    v_mfma_f32_16x16x32_bf16 v[212:215], v[152:155], v[76:79], v[212:215]
    v_mov_b32 v38, v102
    v_mov_b32 v39, v103
    v_mfma_f32_16x16x32_bf16 v[224:227], v[160:163], v[76:79], v[224:227]
    buffer_load_dwordx4 a[24:27], v1, s[56:59], s85 offen offset:1024 sc1
    v_mfma_f32_16x16x32_bf16 v[224:227], v[164:167], v[72:75], v[224:227]
    v_mov_b32 v40, v104
    v_mov_b32 v41, v105
    v_mfma_f32_16x16x32_bf16 v[236:239], v[188:191], v[72:75], v[236:239]
    buffer_load_dwordx4 a[28:31], v1, s[56:59], s85 offen offset:2048 sc1
    v_mfma_f32_16x16x32_bf16 v[236:239], v[184:187], v[76:79], v[236:239]
    ds_read_b128 v[72:75], v30 offset:5760
    s_waitcnt lgkmcnt(5)
    v_mfma_f32_16x16x32_bf16 v[212:215], v[128:131], v[48:51], v[212:215]
    ds_read_b128 v[76:79], v30 offset:5632
    v_mov_b32 v42, v106
    v_mfma_f32_16x16x32_bf16 v[212:215], v[132:135], v[52:55], v[212:215]
    v_mov_b32_e64 v43, v107
    v_mfma_f32_16x16x32_bf16 v[224:227], v[140:143], v[52:55], v[224:227]
    buffer_load_dwordx4 a[32:35], v1, s[56:59], s85 offen offset:3072 sc1
    v_mfma_f32_16x16x32_bf16 v[224:227], v[136:139], v[48:51], v[224:227]
    s_add_u32 s85, s85, 4096
    v_mfma_f32_16x16x32_bf16 v[236:239], v[160:163], v[48:51], v[236:239]
    v_mfma_f32_16x16x32_bf16 v[236:239], v[164:167], v[52:55], v[236:239]
    ds_read_b128 v[48:51], v30 offset:4608
    s_waitcnt lgkmcnt(5)
    v_mfma_f32_16x16x32_bf16 v[212:215], v[148:151], v[56:59], v[212:215]
    ds_read_b128 v[52:55], v30 offset:4736
    v_mfma_f32_16x16x32_bf16 v[212:215], v[144:147], v[60:63], v[212:215]
    buffer_load_dwordx4 a[36:39], v1, s[56:59], s85 offen offset:0 sc1
    v_mfma_f32_16x16x32_bf16 v[224:227], v[152:155], v[60:63], v[224:227]
    s_mul_i32 s85, s18, 5
    s_add_u32 s85, s85, s83
    v_mfma_f32_16x16x32_bf16 v[224:227], v[156:159], v[56:59], v[224:227]
    v_mfma_f32_16x16x32_bf16 v[236:239], v[180:183], v[56:59], v[236:239]
    v_mfma_f32_16x16x32_bf16 v[236:239], v[176:179], v[60:63], v[236:239]
    ds_read_b128 v[56:59], v30 offset:5504
    s_waitcnt lgkmcnt(5)
    v_mfma_f32_16x16x32_bf16 v[212:215], v[136:139], v[64:67], v[212:215]
    ds_read_b128 v[60:63], v30 offset:5376
    v_mfma_f32_16x16x32_bf16 v[212:215], v[140:143], v[68:71], v[212:215]
    buffer_load_dwordx4 a[40:43], v1, s[56:59], s85 offen offset:0 sc1
    v_mfma_f32_16x16x32_bf16 v[224:227], v[148:151], v[68:71], v[224:227]
    v_mfma_f32_16x16x32_bf16 v[224:227], v[144:147], v[64:67], v[224:227]
    buffer_load_dwordx4 a[44:47], v1, s[56:59], s85 offen offset:1024 sc1
    v_mfma_f32_16x16x32_bf16 v[236:239], v[168:171], v[64:67], v[236:239]
    v_mfma_f32_16x16x32_bf16 v[236:239], v[172:175], v[68:71], v[236:239]
    ds_read_b128 v[64:67], v30 offset:4864
    s_waitcnt lgkmcnt(5)
    v_mfma_f32_16x16x32_bf16 v[218:221], v[132:135], v[76:79], v[218:221]
    ds_read_b128 v[68:71], v30 offset:4992
    v_mfma_f32_16x16x32_bf16 v[218:221], v[128:131], v[72:75], v[218:221]
    v_mfma_f32_16x16x32_bf16 v[230:233], v[152:155], v[72:75], v[230:233]
    buffer_load_dwordx4 a[48:51], v1, s[56:59], s85 offen offset:2048 sc1
    v_mfma_f32_16x16x32_bf16 v[230:233], v[156:159], v[76:79], v[230:233]
    ds_read_b128 v[72:75], v30 offset:5248
    s_waitcnt lgkmcnt(5)
    v_mfma_f32_16x16x32_bf16 v[194:197], v[128:131], v[52:55], v[194:197]
    ds_read_b128 v[76:79], v30 offset:5120
    v_mfma_f32_16x16x32_bf16 v[194:197], v[132:135], v[48:51], v[194:197]
    v_mfma_f32_16x16x32_bf16 v[206:209], v[156:159], v[48:51], v[206:209]
    buffer_load_dwordx4 a[52:55], v1, s[56:59], s85 offen offset:3072 sc1
    v_mfma_f32_16x16x32_bf16 v[206:209], v[152:155], v[52:55], v[206:209]
    s_add_u32 s85, s85, 4096
    v_mfma_f32_16x16x32_bf16 v[218:221], v[160:163], v[52:55], v[218:221]
    v_mfma_f32_16x16x32_bf16 v[218:221], v[164:167], v[48:51], v[218:221]
    v_mfma_f32_16x16x32_bf16 v[230:233], v[188:191], v[48:51], v[230:233]
    buffer_load_dwordx4 a[56:59], v1, s[56:59], s85 offen offset:0 sc1
    v_mfma_f32_16x16x32_bf16 v[230:233], v[184:187], v[52:55], v[230:233]
    s_mul_i32 s85, s19, 5
    s_add_u32 s85, s85, s83
    s_waitcnt lgkmcnt(4)
    v_mfma_f32_16x16x32_bf16 v[206:209], v[128:131], v[56:59], v[206:209]
    v_mfma_f32_16x16x32_bf16 v[206:209], v[132:135], v[60:63], v[206:209]
    v_mfma_f32_16x16x32_bf16 v[218:221], v[140:143], v[60:63], v[218:221]
    v_mfma_f32_16x16x32_bf16 v[218:221], v[136:139], v[56:59], v[218:221]
    buffer_load_dwordx4 a[60:63], v1, s[56:59], s85 offen offset:0 sc1
    v_mfma_f32_16x16x32_bf16 v[230:233], v[160:163], v[56:59], v[230:233]
    v_mfma_f32_16x16x32_bf16 v[230:233], v[164:167], v[60:63], v[230:233]
    s_waitcnt lgkmcnt(2)
    v_mfma_f32_16x16x32_bf16 v[206:209], v[148:151], v[64:67], v[206:209]
    v_mfma_f32_16x16x32_bf16 v[206:209], v[144:147], v[68:71], v[206:209]
    buffer_load_dwordx4 a[64:67], v1, s[56:59], s85 offen offset:1024 sc1
    v_mfma_f32_16x16x32_bf16 v[218:221], v[152:155], v[68:71], v[218:221]
    v_mfma_f32_16x16x32_bf16 v[218:221], v[156:159], v[64:67], v[218:221]
    v_mfma_f32_16x16x32_bf16 v[230:233], v[180:183], v[64:67], v[230:233]
    v_mfma_f32_16x16x32_bf16 v[230:233], v[176:179], v[68:71], v[230:233]
    s_waitcnt lgkmcnt(0)
    v_mfma_f32_16x16x32_bf16 v[206:209], v[136:139], v[72:75], v[206:209]
    buffer_load_dwordx4 a[68:71], v1, s[56:59], s85 offen offset:2048 sc1
    v_mfma_f32_16x16x32_bf16 v[206:209], v[140:143], v[76:79], v[206:209]
    v_mfma_f32_16x16x32_bf16 v[218:221], v[148:151], v[76:79], v[218:221]
    v_mfma_f32_16x16x32_bf16 v[218:221], v[144:147], v[72:75], v[218:221]
    v_mfma_f32_16x16x32_bf16 v[230:233], v[168:171], v[72:75], v[230:233]
    buffer_load_dwordx4 a[72:75], v1, s[56:59], s85 offen offset:3072 sc1
    v_mfma_f32_16x16x32_bf16 v[230:233], v[172:175], v[76:79], v[230:233]
    s_add_u32 s85, s85, 4096
    buffer_load_dwordx4 a[76:79], v1, s[56:59], s85 offen offset:0 sc1
    s_mul_i32 s85, s20, 5
    s_add_u32 s85, s85, s83
    buffer_load_dwordx4 a[80:83], v1, s[56:59], s85 offen offset:0 sc1
    buffer_load_dwordx4 a[84:87], v1, s[56:59], s85 offen offset:1024 sc1
    s_branch LS_finB
LS_h1B:
Lst_7004:
    s_cbranch_execz Lst_2799
    s_nop 0
    ds_read_b64_tr_b16 v[128:129], v29 offset:32
    ds_read_b64_tr_b16 v[130:131], v29 offset:0
    ds_read_b64_tr_b16 v[132:133], v29 offset:288
    ds_read_b64_tr_b16 v[134:135], v29 offset:256
    ds_read_b64_tr_b16 v[136:137], v29 offset:544
    ds_read_b64_tr_b16 v[138:139], v29 offset:512
    ds_read_b64_tr_b16 v[140:141], v29 offset:800
    ds_read_b64_tr_b16 v[142:143], v29 offset:768
    ds_read_b64_tr_b16 v[144:145], v29 offset:1056
    ds_read_b64_tr_b16 v[146:147], v29 offset:1024
    ds_read_b64_tr_b16 v[152:153], v29 offset:1568
    ds_read_b64_tr_b16 v[154:155], v29 offset:1536
    ds_read_b64_tr_b16 v[148:149], v29 offset:1312
    ds_read_b64_tr_b16 v[150:151], v29 offset:1280
    ds_read_b64_tr_b16 v[156:157], v29 offset:1824
    ds_read_b64_tr_b16 v[158:159], v29 offset:1792
    ds_read_b64_tr_b16 v[160:161], v29 offset:2080
    ds_read_b64_tr_b16 v[162:163], v29 offset:2048
    ds_read_b64_tr_b16 v[164:165], v29 offset:2336
    ds_read_b64_tr_b16 v[166:167], v29 offset:2304
    ds_read_b128 v[48:51], v30 offset:3968
    ds_read_b128 v[52:55], v30 offset:3840
    ds_read_b128 v[56:59], v30 offset:3712
    ds_read_b128 v[60:63], v30 offset:3584
    ds_read_b128 v[64:67], v30 offset:896
    ds_read_b128 v[68:71], v30 offset:768
    ds_read_b128 v[72:75], v30 offset:640
    ds_read_b128 v[76:79], v30 offset:512
    s_waitcnt lgkmcnt(6)
    v_mfma_f32_16x16x32_bf16 v[244:247], v[128:131], v[48:51], 0
    ds_read_b64_tr_b16 v[168:169], v29 offset:2592
    s_lshr_b32 s32, s3, 1
    v_mfma_f32_16x16x32_bf16 v[244:247], v[132:135], v[52:55], v[244:247]
    s_lshl_b32 s38, s15, 1
    ds_read_b64_tr_b16 v[170:171], v29 offset:2560
    s_waitcnt lgkmcnt(6)
    v_mfma_f32_16x16x32_bf16 v[240:243], v[132:135], v[60:63], 0
    s_add_u32 s38, s38, s32
    ds_read_b128 v[48:51], v30 offset:2688
    v_mov_b32 v214, 0
    v_mfma_f32_16x16x32_bf16 v[240:243], v[128:131], v[56:59], v[240:243]
    s_mul_i32 s38, s38, 4224
    ds_read_b64_tr_b16 v[172:173], v29 offset:2848
    v_mov_b32_e64 v215, 0
    v_mfma_f32_16x16x32_bf16 v[244:247], v[136:139], v[56:59], v[244:247]
    s_add_u32 s38, s38, 5259264
    ds_read_b64_tr_b16 v[174:175], v29 offset:2816
    v_mov_b32_e64 v202, 0
    v_mfma_f32_16x16x32_bf16 v[244:247], v[140:143], v[60:63], v[244:247]
    s_mul_i32 s32, s32, 8224
    ds_read_b128 v[52:55], v30 offset:2560
    s_waitcnt lgkmcnt(6)
    v_mfma_f32_16x16x32_bf16 v[216:219], v[148:151], v[68:71], 0
    s_and_b32 s33, s3, 1
    ds_read_b128 v[56:59], v30 offset:3456
    v_mov_b32_e64 v203, 0
Lst_7063:
    s_cbranch_execz Lst_2807
    s_nop 0
    v_mfma_f32_16x16x32_bf16 v[216:219], v[144:147], v[64:67], v[216:219]
    s_lshl_b32 s33, s33, 10
    ds_read_b128 v[60:63], v30 offset:3328
    v_mov_b32 v220, v242
    v_mfma_f32_16x16x32_bf16 v[228:231], v[152:155], v[64:67], 0
    s_add_u32 s32, s32, s33
    ds_read_b64_tr_b16 v[176:177], v29 offset:3104
    v_mov_b32 v221, v243
    v_mfma_f32_16x16x32_bf16 v[228:231], v[156:159], v[68:71], v[228:231]
    s_lshl_b32 s8, s15, 5
    ds_read_b64_tr_b16 v[178:179], v29 offset:3072
    v_mfma_f32_16x16x32_bf16 v[204:207], v[128:131], v[72:75], 0
    s_mul_i32 s9, s3, 663552
    ds_read_b128 v[64:67], v30 offset:2432
    v_mov_b32 v232, v246
    v_mfma_f32_16x16x32_bf16 v[204:207], v[132:135], v[76:79], v[204:207]
    s_add_u32 s8, s8, s9
    ds_read_b64_tr_b16 v[180:181], v29 offset:3360
    v_mov_b32 v233, v247
    v_mfma_f32_16x16x32_bf16 v[216:219], v[156:159], v[76:79], v[216:219]
    s_add_u32 s8, s8, 393248
    ds_read_b64_tr_b16 v[182:183], v29 offset:3328
    v_mov_b32_e64 v238, v246
    v_mfma_f32_16x16x32_bf16 v[216:219], v[152:155], v[72:75], v[216:219]
    s_add_u32 s9, s8, 331776
    ds_read_b128 v[68:71], v30 offset:2304
    v_mov_b32_e64 v239, v247
    v_mfma_f32_16x16x32_bf16 v[228:231], v[160:163], v[72:75], v[228:231]
    s_add_u32 s32, s32, 75904
    v_add_f32 v246, v246, v244
    v_add_f32 v247, v247, v245
    v_mfma_f32_16x16x32_bf16 v[228:231], v[164:167], v[76:79], v[228:231]
    ds_read_b128 v[72:75], v30 offset:1664
    s_waitcnt lgkmcnt(6)
    v_mfma_f32_16x16x32_bf16 v[198:201], v[132:135], v[52:55], 0
    ds_read_b128 v[76:79], v30 offset:1536
    v_mov_b32 v226, v242
    v_mfma_f32_16x16x32_bf16 v[198:201], v[128:131], v[48:51], v[198:201]
    v_mov_b32 v227, v243
    v_add_f32 v242, v242, v240
    v_mfma_f32_16x16x32_bf16 v[210:213], v[136:139], v[48:51], v[204:207]
    v_add_f32 v243, v243, v241
    v_lshrrev_b32 v31, 1, v0
    v_mfma_f32_16x16x32_bf16 v[210:213], v[140:143], v[52:55], v[210:213]
    v_mul_u32_u24 v31, 10336, v31
    v_lshl_add_u32 v31, v0, 4, v31
    v_mfma_f32_16x16x32_bf16 v[222:225], v[164:167], v[52:55], v[216:219]
    buffer_load_dwordx4 a[248:251], v31, s[56:59], s8 offen sc1
    v_mfma_f32_16x16x32_bf16 v[222:225], v[160:163], v[48:51], v[222:225]
    v_add_u32 v4, 16, v0
    v_subrev_u32 v5, 47, v0
    v_mfma_f32_16x16x32_bf16 v[234:237], v[168:171], v[48:51], v[228:231]
    v_cmp_lt_u32 s[36:37], 47, v0
    v_lshl_add_u32 v6, v0, 4, s32
    v_mfma_f32_16x16x32_bf16 v[234:237], v[172:175], v[52:55], v[234:237]
    ds_read_b128 v[48:51], v30 offset:0
    v_mfma_f32_16x16x32_bf16 v[222:225], v[140:143], v[60:63], v[222:225]
    ds_read_b128 v[52:55], v30 offset:128
    v_and_b32_e64 v11, 15, v0
    v_mfma_f32_16x16x32_bf16 v[222:225], v[136:139], v[56:59], v[222:225]
    buffer_load_dwordx4 a[252:255], v31, s[56:59], s9 offen sc1
    v_mfma_f32_16x16x32_bf16 v[234:237], v[144:147], v[56:59], v[234:237]
    s_mul_i32 s85, s16, 5
    s_add_u32 s85, s85, s83
    v_cndmask_b32 v4, v4, v5, s[36:37]
    v_mfma_f32_16x16x32_bf16 v[234:237], v[148:151], v[60:63], v[234:237]
    ds_read_b128 v[56:59], v30 offset:1408
    s_waitcnt lgkmcnt(5)
    v_mfma_f32_16x16x32_bf16 v[198:201], v[140:143], v[68:71], v[198:201]
    ds_read_b128 v[60:63], v30 offset:1280
    v_cmp_eq_u32 s[36:37], 63, v0
    v_mfma_f32_16x16x32_bf16 v[198:201], v[136:139], v[64:67], v[198:201]
    buffer_load_dwordx4 a[0:3], v1, s[56:59], s85 offen offset:0 sc1
    v_mfma_f32_16x16x32_bf16 v[210:213], v[144:147], v[64:67], v[210:213]
    v_lshlrev_b32 v11, 4, v11
    v_and_b32_e64 v9, 12, v0
    v_mfma_f32_16x16x32_bf16 v[210:213], v[148:151], v[68:71], v[210:213]
    v_lshl_add_u32 v11, v9, 4, v11
    v_bfe_u32 v9, v0, 4, 1
    v_mfma_f32_16x16x32_bf16 v[222:225], v[172:175], v[68:71], v[222:225]
    v_cndmask_b32 v4, v4, 64, s[36:37]
    v_lshl_add_u32 v4, v4, 4, s32
    v_mfma_f32_16x16x32_bf16 v[222:225], v[168:171], v[64:67], v[222:225]
    buffer_load_dwordx4 a[4:7], v1, s[56:59], s85 offen offset:1024 sc1
    v_mfma_f32_16x16x32_bf16 v[234:237], v[176:179], v[64:67], v[234:237]
    s_lshl_b32 s32, s33, 1
    s_sub_u32 s32, 3072, s32
    v_add_u32 v5, s32, v4
    v_mfma_f32_16x16x32_bf16 v[234:237], v[180:183], v[68:71], v[234:237]
    ds_read_b128 v[64:67], v30 offset:256
    s_waitcnt lgkmcnt(5)
    v_mfma_f32_16x16x32_bf16 v[228:231], v[128:131], v[72:75], v[228:231]
    ds_read_b128 v[68:71], v30 offset:384
    v_add_u32 v7, s32, v6
    v_mfma_f32_16x16x32_bf16 v[228:231], v[132:135], v[76:79], v[228:231]
    ds_read_b128 v[72:75], v30 offset:1152
    s_waitcnt lgkmcnt(5)
    v_mfma_f32_16x16x32_bf16 v[192:195], v[136:139], v[52:55], 0
    ds_read_b128 v[76:79], v30 offset:1024
    v_add_f32 v222, v222, v240
    v_mfma_f32_16x16x32_bf16 v[192:195], v[140:143], v[48:51], v[192:195]
    v_add_f32 v234, v234, v244
    v_add_f32 v235, v235, v245
    v_mfma_f32_16x16x32_bf16 v[204:207], v[148:151], v[48:51], v[204:207]
    v_add_f32 v236, v236, v246
    v_add_f32 v237, v237, v247
    v_mfma_f32_16x16x32_bf16 v[204:207], v[144:147], v[52:55], v[204:207]
    v_add_f32 v223, v223, v241
    v_add_f32 v224, v224, v242
    v_mfma_f32_16x16x32_bf16 v[216:219], v[168:171], v[52:55], v[216:219]
    v_add_f32_e64 v225, v225, v243
    v_lshl_add_u32 v11, v9, 11, v11
    v_mfma_f32_16x16x32_bf16 v[216:219], v[172:175], v[48:51], v[216:219]
    buffer_load_dwordx4 a[8:11], v1, s[56:59], s85 offen offset:2048 sc1
    v_mfma_f32_16x16x32_bf16 v[228:231], v[180:183], v[48:51], v[228:231]
    v_lshrrev_b32_e64 v9, 5, v0
    v_lshl_add_u32 v11, v9, 6, v11
    v_mfma_f32_16x16x32_bf16 v[228:231], v[176:179], v[52:55], v[228:231]
    s_lshr_b32 s33, s33, 1
    ds_read_b128 v[48:51], v30 offset:8064
    s_waitcnt lgkmcnt(5)
    v_mfma_f32_16x16x32_bf16 v[216:219], v[132:135], v[60:63], v[216:219]
    ds_read_b128 v[52:55], v30 offset:7936
    s_lshr_b32 s32, s32, 1
    v_mfma_f32_16x16x32_bf16 v[216:219], v[128:131], v[56:59], v[216:219]
    buffer_load_dwordx4 a[12:15], v1, s[56:59], s85 offen offset:3072 sc1
    v_mfma_f32_16x16x32_bf16 v[228:231], v[136:139], v[56:59], v[228:231]
    s_add_u32 s85, s85, 4096
    v_add_u32 v11, s33, v11
    v_add_u32_e64 v12, s32, v11
    v_mfma_f32_16x16x32_bf16 v[228:231], v[140:143], v[60:63], v[228:231]
    ds_read_b128 v[56:59], v30 offset:6912
    s_waitcnt lgkmcnt(5)
    v_mfma_f32_16x16x32_bf16 v[192:195], v[128:131], v[68:71], v[192:195]
    ds_read_b128 v[60:63], v30 offset:7040
    v_mov_b32 v32, v96
    v_mfma_f32_16x16x32_bf16 v[192:195], v[132:135], v[64:67], v[192:195]
    buffer_load_dwordx4 a[16:19], v1, s[56:59], s85 offen offset:0 sc1
    v_mfma_f32_16x16x32_bf16 v[204:207], v[140:143], v[64:67], v[204:207]
    s_mul_i32 s85, s17, 5
    s_add_u32 s85, s85, s83
    v_mov_b32_e64 v33, v97
    v_mfma_f32_16x16x32_bf16 v[204:207], v[136:139], v[68:71], v[204:207]
    buffer_load_dwordx4 a[20:23], v1, s[56:59], s85 offen offset:0 sc1
    v_mfma_f32_16x16x32_bf16 v[216:219], v[160:163], v[68:71], v[216:219]
    v_mov_b32 v34, v98
    v_mov_b32 v35, v99
    v_mfma_f32_16x16x32_bf16 v[216:219], v[164:167], v[64:67], v[216:219]
    buffer_load_dwordx4 a[24:27], v1, s[56:59], s85 offen offset:1024 sc1
    v_mfma_f32_16x16x32_bf16 v[228:231], v[172:175], v[64:67], v[228:231]
    v_mov_b32 v36, v100
    v_mov_b32 v37, v101
    v_mfma_f32_16x16x32_bf16 v[228:231], v[168:171], v[68:71], v[228:231]
    ds_read_b128 v[64:67], v30 offset:7808
    s_waitcnt lgkmcnt(5)
    v_mfma_f32_16x16x32_bf16 v[216:219], v[140:143], v[76:79], v[216:219]
    ds_read_b128 v[68:71], v30 offset:7680
    v_mov_b32 v38, v102
    v_mfma_f32_16x16x32_bf16 v[216:219], v[136:139], v[72:75], v[216:219]
    v_mov_b32 v39, v103
    v_mov_b32 v40, v104
    v_mfma_f32_16x16x32_bf16 v[228:231], v[144:147], v[72:75], v[228:231]
    buffer_load_dwordx4 a[28:31], v1, s[56:59], s85 offen offset:2048 sc1
    v_mfma_f32_16x16x32_bf16 v[228:231], v[148:151], v[76:79], v[228:231]
    ds_read_b128 v[72:75], v30 offset:7168
    s_waitcnt lgkmcnt(5)
    v_mfma_f32_16x16x32_bf16 v[224:227], v[140:143], v[52:55], v[224:227]
    ds_read_b128 v[76:79], v30 offset:7296
    v_mov_b32 v208, 0
    v_mfma_f32_16x16x32_bf16 v[224:227], v[136:139], v[48:51], v[224:227]
    v_add_f32 v218, v218, v240
    v_add_f32 v219, v219, v241
    v_mfma_f32_16x16x32_bf16 v[236:239], v[144:147], v[48:51], v[236:239]
    v_mov_b32 v209, 0
    v_mov_b32 v196, 0
    v_mfma_f32_16x16x32_bf16 v[236:239], v[148:151], v[52:55], v[236:239]
    ds_read_b128 v[48:51], v30 offset:7552
    s_waitcnt lgkmcnt(5)
    v_mfma_f32_16x16x32_bf16 v[200:203], v[136:139], v[60:63], v[200:203]
    ds_read_b128 v[52:55], v30 offset:7424
    v_add_f32 v230, v230, v244
    v_mfma_f32_16x16x32_bf16 v[200:203], v[140:143], v[56:59], v[200:203]
    v_add_f32 v231, v231, v245
    v_mov_b32 v197, 0
    v_mfma_f32_16x16x32_bf16 v[212:215], v[148:151], v[56:59], v[212:215]
    buffer_load_dwordx4 a[32:35], v1, s[56:59], s85 offen offset:3072 sc1
    v_mfma_f32_16x16x32_bf16 v[212:215], v[144:147], v[60:63], v[212:215]
    s_add_u32 s85, s85, 4096
    v_mov_b32 v41, v105
    v_mov_b32 v42, v106
    v_mfma_f32_16x16x32_bf16 v[224:227], v[168:171], v[60:63], v[224:227]
    buffer_load_dwordx4 a[36:39], v1, s[56:59], s85 offen offset:0 sc1
    v_mfma_f32_16x16x32_bf16 v[224:227], v[172:175], v[56:59], v[224:227]
    s_mul_i32 s85, s18, 5
    s_add_u32 s85, s85, s83
    v_mov_b32_e64 v43, v107
    v_mfma_f32_16x16x32_bf16 v[236:239], v[180:183], v[56:59], v[236:239]
    v_mfma_f32_16x16x32_bf16 v[236:239], v[176:179], v[60:63], v[236:239]
    ds_read_b128 v[56:59], v30 offset:5760
    s_waitcnt lgkmcnt(5)
    v_mfma_f32_16x16x32_bf16 v[224:227], v[148:151], v[68:71], v[224:227]
    ds_read_b128 v[60:63], v30 offset:5632
    v_mfma_f32_16x16x32_bf16 v[224:227], v[144:147], v[64:67], v[224:227]
    buffer_load_dwordx4 a[40:43], v1, s[56:59], s85 offen offset:0 sc1
    v_mfma_f32_16x16x32_bf16 v[236:239], v[152:155], v[64:67], v[236:239]
    v_mfma_f32_16x16x32_bf16 v[236:239], v[156:159], v[68:71], v[236:239]
    ds_read_b128 v[64:67], v30 offset:4608
    s_waitcnt lgkmcnt(5)
    v_mfma_f32_16x16x32_bf16 v[200:203], v[128:131], v[76:79], v[200:203]
    ds_read_b128 v[68:71], v30 offset:4736
    v_mfma_f32_16x16x32_bf16 v[200:203], v[132:135], v[72:75], v[200:203]
    buffer_load_dwordx4 a[44:47], v1, s[56:59], s85 offen offset:1024 sc1
    v_mfma_f32_16x16x32_bf16 v[212:215], v[140:143], v[72:75], v[212:215]
    v_mfma_f32_16x16x32_bf16 v[212:215], v[136:139], v[76:79], v[212:215]
    v_mfma_f32_16x16x32_bf16 v[224:227], v[160:163], v[76:79], v[224:227]
    buffer_load_dwordx4 a[48:51], v1, s[56:59], s85 offen offset:2048 sc1
    v_mfma_f32_16x16x32_bf16 v[224:227], v[164:167], v[72:75], v[224:227]
    v_mfma_f32_16x16x32_bf16 v[236:239], v[172:175], v[72:75], v[236:239]
    v_mfma_f32_16x16x32_bf16 v[236:239], v[168:171], v[76:79], v[236:239]
    ds_read_b128 v[72:75], v30 offset:5504
    s_waitcnt lgkmcnt(5)
    v_mfma_f32_16x16x32_bf16 v[212:215], v[128:131], v[48:51], v[212:215]
    ds_read_b128 v[76:79], v30 offset:5376
    v_mfma_f32_16x16x32_bf16 v[212:215], v[132:135], v[52:55], v[212:215]
    buffer_load_dwordx4 a[52:55], v1, s[56:59], s85 offen offset:3072 sc1
    v_mfma_f32_16x16x32_bf16 v[224:227], v[156:159], v[52:55], v[224:227]
    s_add_u32 s85, s85, 4096
    v_mfma_f32_16x16x32_bf16 v[224:227], v[152:155], v[48:51], v[224:227]
    v_mfma_f32_16x16x32_bf16 v[236:239], v[160:163], v[48:51], v[236:239]
    buffer_load_dwordx4 a[56:59], v1, s[56:59], s85 offen offset:0 sc1
    v_mfma_f32_16x16x32_bf16 v[236:239], v[164:167], v[52:55], v[236:239]
    s_mul_i32 s85, s19, 5
    ds_read_b128 v[48:51], v30 offset:4864
    s_waitcnt lgkmcnt(5)
    v_mfma_f32_16x16x32_bf16 v[218:221], v[140:143], v[60:63], v[218:221]
    ds_read_b128 v[52:55], v30 offset:4992
    s_add_u32 s85, s85, s83
    v_mfma_f32_16x16x32_bf16 v[218:221], v[136:139], v[56:59], v[218:221]
    v_mfma_f32_16x16x32_bf16 v[230:233], v[144:147], v[56:59], v[230:233]
    v_mfma_f32_16x16x32_bf16 v[230:233], v[148:151], v[60:63], v[230:233]
    ds_read_b128 v[56:59], v30 offset:5248
    s_waitcnt lgkmcnt(5)
    v_mfma_f32_16x16x32_bf16 v[194:197], v[136:139], v[68:71], v[194:197]
    ds_read_b128 v[60:63], v30 offset:5120
    v_mfma_f32_16x16x32_bf16 v[194:197], v[140:143], v[64:67], v[194:197]
    buffer_load_dwordx4 a[60:63], v1, s[56:59], s85 offen offset:0 sc1
    v_mfma_f32_16x16x32_bf16 v[206:209], v[148:151], v[64:67], v[206:209]
    v_mfma_f32_16x16x32_bf16 v[206:209], v[144:147], v[68:71], v[206:209]
    buffer_load_dwordx4 a[64:67], v1, s[56:59], s85 offen offset:1024 sc1
    v_mfma_f32_16x16x32_bf16 v[218:221], v[168:171], v[68:71], v[218:221]
    v_mfma_f32_16x16x32_bf16 v[218:221], v[172:175], v[64:67], v[218:221]
    v_mfma_f32_16x16x32_bf16 v[230:233], v[180:183], v[64:67], v[230:233]
    v_mfma_f32_16x16x32_bf16 v[230:233], v[176:179], v[68:71], v[230:233]
    s_waitcnt lgkmcnt(4)
    v_mfma_f32_16x16x32_bf16 v[218:221], v[148:151], v[76:79], v[218:221]
    buffer_load_dwordx4 a[68:71], v1, s[56:59], s85 offen offset:2048 sc1
    v_mfma_f32_16x16x32_bf16 v[218:221], v[144:147], v[72:75], v[218:221]
    v_mfma_f32_16x16x32_bf16 v[230:233], v[152:155], v[72:75], v[230:233]
    v_mfma_f32_16x16x32_bf16 v[230:233], v[156:159], v[76:79], v[230:233]
    s_waitcnt lgkmcnt(2)
    v_mfma_f32_16x16x32_bf16 v[194:197], v[128:131], v[52:55], v[194:197]
    buffer_load_dwordx4 a[72:75], v1, s[56:59], s85 offen offset:3072 sc1
    v_mfma_f32_16x16x32_bf16 v[194:197], v[132:135], v[48:51], v[194:197]
    s_add_u32 s85, s85, 4096
    v_mfma_f32_16x16x32_bf16 v[206:209], v[140:143], v[48:51], v[206:209]
    v_mfma_f32_16x16x32_bf16 v[206:209], v[136:139], v[52:55], v[206:209]
    v_mfma_f32_16x16x32_bf16 v[218:221], v[160:163], v[52:55], v[218:221]
    buffer_load_dwordx4 a[76:79], v1, s[56:59], s85 offen offset:0 sc1
    v_mfma_f32_16x16x32_bf16 v[218:221], v[164:167], v[48:51], v[218:221]
    s_mul_i32 s85, s20, 5
    s_add_u32 s85, s85, s83
    v_mfma_f32_16x16x32_bf16 v[230:233], v[172:175], v[48:51], v[230:233]
    v_mfma_f32_16x16x32_bf16 v[230:233], v[168:171], v[52:55], v[230:233]
    s_waitcnt lgkmcnt(0)
    v_mfma_f32_16x16x32_bf16 v[206:209], v[128:131], v[56:59], v[206:209]
    v_mfma_f32_16x16x32_bf16 v[206:209], v[132:135], v[60:63], v[206:209]
    buffer_load_dwordx4 a[80:83], v1, s[56:59], s85 offen offset:0 sc1
    v_mfma_f32_16x16x32_bf16 v[218:221], v[156:159], v[60:63], v[218:221]
    v_mfma_f32_16x16x32_bf16 v[218:221], v[152:155], v[56:59], v[218:221]
    v_mfma_f32_16x16x32_bf16 v[230:233], v[160:163], v[56:59], v[230:233]
    v_mfma_f32_16x16x32_bf16 v[230:233], v[164:167], v[60:63], v[230:233]
    buffer_load_dwordx4 a[84:87], v1, s[56:59], s85 offen offset:1024 sc1
LS_finB:
Lst_7348:
    s_cbranch_execz Lst_3032
    s_nop 0
    s_nop 7
    v_add_f32 v201, v201, v196
    s_mul_i32 s85, s20, 5
    v_add_f32 v202, v202, v197
    ds_write_b128 v4, v[200:203] offset:0
    v_add_f32 v213, v213, v208
    v_add_f32_e64 v214, v214, v209
    s_add_u32 s85, s85, s83
    ds_write_b128 v5, v[212:215] offset:0
    v_add_f32 v225, v225, v220
    v_add_f32 v226, v226, v221
    ds_write_b128 v4, v[224:227] offset:4096
    v_add_f32_e64 v237, v237, v232
    buffer_load_dwordx4 a[88:91], v1, s[56:59], s85 offen offset:2048 sc1
    v_add_f32_e64 v238, v238, v233
    ds_write_b128 v5, v[236:239] offset:4096
    v_add_f32 v193, v193, v198
    v_add_f32 v194, v194, v199
    buffer_load_dwordx4 a[92:95], v1, s[56:59], s85 offen offset:3072 sc1
    v_add_f32 v195, v195, v200
    v_add_f32 v205, v205, v210
    v_add_f32 v206, v206, v211
    v_add_f32 v207, v207, v212
    v_add_f32_e64 v217, v217, v222
    s_add_u32 s85, s85, 4096
    v_add_f32 v218, v218, v223
    v_add_f32 v219, v219, v224
    v_add_f32 v229, v229, v234
    v_add_f32 v230, v230, v235
    buffer_load_dwordx4 a[96:99], v1, s[56:59], s85 offen offset:0 sc1
    v_add_f32_e64 v231, v231, v236
    s_waitcnt lgkmcnt(0)
    s_barrier
    ds_read_b128 v[48:51], v6 offset:0
    ds_read_b128 v[56:59], v6 offset:4096
    s_mul_i32 s85, s21, 5
    ds_read_b128 v[52:55], v7 offset:0
    ds_read_b128 v[60:63], v7 offset:4096
    s_waitcnt vmcnt(25)
    ds_write_b128 v26, a[248:251]
    s_add_u32 s85, s85, s83
    ds_write_b128 v26, a[252:255] offset:512
    s_waitcnt lgkmcnt(3)
    v_add_f32 v192, v192, v49
    v_add_f32 v193, v193, v50
    v_add_f32_e64 v194, v194, v51
    buffer_load_dwordx4 a[100:103], v1, s[56:59], s85 offen offset:0 sc1
    v_cvt_pk_bf16_f32 v64, v192, v193
    v_cvt_pk_bf16_f32 v65, v194, v195
    s_waitcnt lgkmcnt(2)
    v_add_f32 v216, v216, v57
    buffer_load_dwordx4 a[104:107], v1, s[56:59], s85 offen offset:1024 sc1
    v_add_f32 v217, v217, v58
    v_add_f32 v218, v218, v59
    v_cvt_pk_bf16_f32 v66, v216, v217
    v_cvt_pk_bf16_f32 v67, v218, v219
    s_nop 0
    v_permlane16_swap_b32 v64, v66
    buffer_load_dwordx4 a[108:111], v1, s[56:59], s85 offen offset:2048 sc1
    v_permlane16_swap_b32 v65, v67
    buffer_store_dwordx4 v[64:67], v11, s[56:59], s38 offen sc1
    s_waitcnt lgkmcnt(1)
    v_add_f32_e64 v204, v204, v53
    buffer_load_dwordx4 a[112:115], v1, s[56:59], s85 offen offset:3072 sc1
    v_add_f32 v205, v205, v54
    v_add_f32 v206, v206, v55
    v_cvt_pk_bf16_f32 v68, v204, v205
    v_cvt_pk_bf16_f32 v69, v206, v207
    s_waitcnt lgkmcnt(0)
    s_add_u32 s85, s85, 4096
    v_add_f32 v228, v228, v61
    v_add_f32 v229, v229, v62
    v_add_f32 v230, v230, v63
    v_cvt_pk_bf16_f32 v70, v228, v229
    buffer_load_dwordx4 a[116:119], v1, s[56:59], s85 offen offset:0 sc1
    v_cvt_pk_bf16_f32 v71, v230, v231
    v_permlane16_swap_b32 v68, v70
    s_nop 0
    v_permlane16_swap_b32 v69, v71
    buffer_store_dwordx4 v[68:71], v12, s[56:59], s38 offen sc1
    s_add_u32 s15, s15, 1
    s_branch L_last
LS_sp:
    v_mov_b32 v32, v96
    v_mov_b32 v33, v97
    v_mov_b32 v34, v98
    v_mov_b32 v35, v99
    v_mov_b32 v36, v100
    v_mov_b32 v37, v101
    v_mov_b32 v38, v102
    v_mov_b32 v39, v103
    v_mov_b32 v40, v104
    v_mov_b32 v41, v105
    v_mov_b32 v42, v106
    v_mov_b32_e64 v43, v107
    s_mul_i32 s85, s16, 5
    s_add_u32 s85, s85, s83
    buffer_load_dwordx4 a[0:3], v1, s[56:59], s85 offen offset:0 sc1
    buffer_load_dwordx4 a[4:7], v1, s[56:59], s85 offen offset:1024 sc1
    buffer_load_dwordx4 a[8:11], v1, s[56:59], s85 offen offset:2048 sc1
    buffer_load_dwordx4 a[12:15], v1, s[56:59], s85 offen offset:3072 sc1
    s_add_u32 s85, s85, 4096
    buffer_load_dwordx4 a[16:19], v1, s[56:59], s85 offen offset:0 sc1
    s_mul_i32 s85, s17, 5
    s_add_u32 s85, s85, s83
    buffer_load_dwordx4 a[20:23], v1, s[56:59], s85 offen offset:0 sc1
    buffer_load_dwordx4 a[24:27], v1, s[56:59], s85 offen offset:1024 sc1
    buffer_load_dwordx4 a[28:31], v1, s[56:59], s85 offen offset:2048 sc1
    buffer_load_dwordx4 a[32:35], v1, s[56:59], s85 offen offset:3072 sc1
    s_add_u32 s85, s85, 4096
    buffer_load_dwordx4 a[36:39], v1, s[56:59], s85 offen offset:0 sc1
    s_mul_i32 s85, s18, 5
    s_add_u32 s85, s85, s83
    buffer_load_dwordx4 a[40:43], v1, s[56:59], s85 offen offset:0 sc1
    buffer_load_dwordx4 a[44:47], v1, s[56:59], s85 offen offset:1024 sc1
    buffer_load_dwordx4 a[48:51], v1, s[56:59], s85 offen offset:2048 sc1
    buffer_load_dwordx4 a[52:55], v1, s[56:59], s85 offen offset:3072 sc1
    s_add_u32 s85, s85, 4096
    buffer_load_dwordx4 a[56:59], v1, s[56:59], s85 offen offset:0 sc1
    s_mul_i32 s85, s19, 5
    s_add_u32 s85, s85, s83
    buffer_load_dwordx4 a[60:63], v1, s[56:59], s85 offen offset:0 sc1
    buffer_load_dwordx4 a[64:67], v1, s[56:59], s85 offen offset:1024 sc1
    buffer_load_dwordx4 a[68:71], v1, s[56:59], s85 offen offset:2048 sc1
    buffer_load_dwordx4 a[72:75], v1, s[56:59], s85 offen offset:3072 sc1
    s_add_u32 s85, s85, 4096
    buffer_load_dwordx4 a[76:79], v1, s[56:59], s85 offen offset:0 sc1
    s_mul_i32 s85, s20, 5
    s_add_u32 s85, s85, s83
    buffer_load_dwordx4 a[80:83], v1, s[56:59], s85 offen offset:0 sc1
    buffer_load_dwordx4 a[84:87], v1, s[56:59], s85 offen offset:1024 sc1
    buffer_load_dwordx4 a[88:91], v1, s[56:59], s85 offen offset:2048 sc1
    buffer_load_dwordx4 a[92:95], v1, s[56:59], s85 offen offset:3072 sc1
    s_add_u32 s85, s85, 4096
    buffer_load_dwordx4 a[96:99], v1, s[56:59], s85 offen offset:0 sc1
    s_mul_i32 s85, s21, 5
    s_add_u32 s85, s85, s83
    buffer_load_dwordx4 a[100:103], v1, s[56:59], s85 offen offset:0 sc1
    buffer_load_dwordx4 a[104:107], v1, s[56:59], s85 offen offset:1024 sc1
    buffer_load_dwordx4 a[108:111], v1, s[56:59], s85 offen offset:2048 sc1
    buffer_load_dwordx4 a[112:115], v1, s[56:59], s85 offen offset:3072 sc1
    s_add_u32 s85, s85, 4096
    buffer_load_dwordx4 a[116:119], v1, s[56:59], s85 offen offset:0 sc1
    s_branch L_last
L_Send:
Lslow_1:
    s_cmp_eq_u32 s100, 0
    s_cbranch_scc1 Lback_2
    s_sub_u32 s100, s100, 1
    s_sleep 8
    buffer_load_dword v18, v19, s[56:59], 0 offen sc1
    s_waitcnt vmcnt(0)
    v_cmp_ne_u32_e64 vcc, s7, v18
    s_cbranch_vccnz Lslow_1
    s_branch Lback_2
Lslow_3:
    s_cmp_eq_u32 s100, 0
    s_cbranch_scc1 Lback_4
    s_sub_u32 s100, s100, 1
    s_sleep 8
    buffer_load_dword v13, v14, s[56:59], 0 offen sc1
    s_waitcnt vmcnt(0)
    v_cmp_ne_u32 vcc, s7, v13
    s_cbranch_vccnz Lslow_3
    s_branch Lback_4
Lslow_5:
    s_cmp_eq_u32 s100, 0
    s_cbranch_scc1 Lback_6
    s_sub_u32 s100, s100, 1
    s_sleep 8
    buffer_load_dword v13, v14, s[56:59], 0 offen sc1
    s_waitcnt vmcnt(0)
    v_cmp_ne_u32 vcc, s7, v13
    s_cbranch_vccnz Lslow_5
    s_branch Lback_6
Lslow_7:
    s_cmp_eq_u32 s100, 0
    s_cbranch_scc1 Lback_8
    s_sub_u32 s100, s100, 1
    s_sleep 12
    buffer_load_dword v6, v4, s[56:59], 0 offen sc1
    s_waitcnt vmcnt(0)
    v_cmp_ne_u32 vcc, s7, v6
    s_cbranch_vccnz Lslow_7
    s_branch Lback_8
Lslow_14:
    s_cmp_eq_u32 s100, 0
    s_cbranch_scc1 Lback_15
    s_sub_u32 s100, s100, 1
    s_sleep 8
    buffer_load_dword v2, v3, s[56:59], 0 offen sc1
    s_waitcnt vmcnt(0)
    v_cmp_ne_u32 vcc, s7, v2
    s_cbranch_vccnz Lslow_14
    s_branch Lback_15
Lslow_18:
    s_cmp_eq_u32 s100, 0
    s_cbranch_scc1 Lback_19
    s_sub_u32 s100, s100, 1
    s_sleep 8
    buffer_load_dword v2, v3, s[56:59], 0 offen sc1
    s_waitcnt vmcnt(0)
    v_cmp_ne_u32 vcc, s7, v2
    s_cbranch_vccnz Lslow_18
    s_branch Lback_19
Lslow_20:
    s_cmp_eq_u32 s100, 0
    s_cbranch_scc1 Lback_21
    s_sub_u32 s100, s100, 1
    s_sleep 16
    buffer_load_dword v18, v19, s[56:59], 0 offen sc1
    s_waitcnt vmcnt(0)
    v_cmp_ne_u32 vcc, s7, v18
    s_cbranch_vccnz Lslow_20
    s_branch Lback_21
.section .rodata,"a"
.p2align 6
.amdhsa_kernel recurrent_scan__ssm_conv_s4d__glu_gated_glu__prompt_kernel
  .amdhsa_next_free_vgpr 512
  .amdhsa_next_free_sgpr 102
  .amdhsa_accum_offset 256
  .amdhsa_group_segment_fixed_size 0
  .amdhsa_kernarg_size 112
  .amdhsa_user_sgpr_count 2
  .amdhsa_user_sgpr_kernarg_segment_ptr 1
  .amdhsa_system_sgpr_workgroup_id_x 1
  .amdhsa_float_denorm_mode_32 3
.end_amdhsa_kernel
```
